```python
import torch

def _softmax(x, axis=-1):
    return torch.softmax(x, dim=axis)
def _gelu(x):
    return torch.nn.functional.gelu(x, approximate="tanh")
def _silu(x):
    return torch.nn.functional.silu(x)
def _sigmoid(x):
    return torch.sigmoid(x)
def _layernorm(x, axis=-1, eps=1e-5):
    m = x.mean(dim=axis, keepdim=True)
    v = x.var(dim=axis, keepdim=True, unbiased=False)
    return (x - m) / torch.sqrt(v + eps)
def _scatter_add(tgt, idx, src, axis=0):
    return tgt.clone().index_add_(axis, idx, src)
def _segment_sum(src, seg, n):
    out = torch.zeros((n,) + src.shape[1:], dtype=src.dtype)
    return out.index_add_(0, seg, src)
def _pad(x, pw):
    flat = tuple(v for pair in reversed(pw) for v in pair)
    return torch.nn.functional.pad(x, flat)

kernel_name = 'recurrent_scan__spectral_fnet__moe_arch_mod__prompt'

def setup_inputs():

    _w = (lambda a: (lambda t: t.to(torch.bfloat16) if t.is_floating_point() else t)(torch.as_tensor(a)))
    def _A_setup():
        B, S, D = 1, 2048, 1024
        ns = torch.arange(S)[:, None] * torch.arange(S)[None, :]
        nd = torch.arange(D)[:, None] * torch.arange(D)[None, :]
        Ws_re = torch.cos(-2.0 * torch.pi * ns / S).to(float)
        Ws_im = torch.sin(-2.0 * torch.pi * ns / S).to(float)
        Wd_re = torch.cos(-2.0 * torch.pi * nd / D).to(float)
        Wd_im = torch.sin(-2.0 * torch.pi * nd / D).to(float)
        return {
            "x": _w((lambda *s: torch.randn(*s, dtype=torch.bfloat16) * 0.05)(B, S, D)),
            "dft_seq_re": _w(Ws_re),
            "dft_seq_im": _w(Ws_im),
            "dft_hid_re": _w(Wd_re),
            "dft_hid_im": _w(Wd_im),
        }
    _A_in = _A_setup()

    def _B_setup():
        B, S, D, F, C = 1, 2048, 1024, 3584, 1
        return {
            "x": _w((lambda *s: torch.randn(*s, dtype=torch.bfloat16) * 0.05)(B, S, D)),
            "w_r": _w((lambda *s: torch.randn(*s, dtype=torch.bfloat16) * 0.05)(D)),
            "w_gate": _w((lambda *s: torch.randn(*s, dtype=torch.bfloat16) * 0.05)(D, F)),
            "w_up": _w((lambda *s: torch.randn(*s, dtype=torch.bfloat16) * 0.05)(D, F)),
            "w_down": _w((lambda *s: torch.randn(*s, dtype=torch.bfloat16) * 0.05)(F, D)),
        }
    _B_in = _B_setup()

    return {
        "A_x": _A_in["x"],
        "A_dft_seq_re": _A_in["dft_seq_re"],
        "A_dft_seq_im": _A_in["dft_seq_im"],
        "A_dft_hid_re": _A_in["dft_hid_re"],
        "A_dft_hid_im": _A_in["dft_hid_im"],
        "B_x": _B_in["x"],
        "B_w_r": _B_in["w_r"],
        "B_w_gate": _B_in["w_gate"],
        "B_w_up": _B_in["w_up"],
        "B_w_down": _B_in["w_down"],
    }

def reference(A_x, A_dft_seq_re, A_dft_seq_im, A_dft_hid_re, A_dft_hid_im, B_x, B_w_r, B_w_gate, B_w_up, B_w_down):
    def _A_ref(x, dft_seq_re, dft_seq_im, dft_hid_re, dft_hid_im):
        a = torch.einsum("bsd,ed->bse", x, dft_hid_re)
        b = torch.einsum("bsd,ed->bse", x, dft_hid_im)
        y = torch.einsum("ts,bse->bte", dft_seq_re, a) - torch.einsum("ts,bse->bte", dft_seq_im, b)
        return y

    def _B_ref(x, w_r, w_gate, w_up, w_down):
        B, S, D = x.shape
        C = 1
        r = x @ w_r
        idx = torch.argsort(-r, axis=-1)[:, :C]
        idx_e = (lambda x, n, axis: torch.repeat_interleave(x, n, dim=axis))(idx.reshape(B, C, 1), D, axis=2)
        x_sel = (lambda x, i, axis: torch.take_along_dim(x, i, dim=axis))(x, idx_e, axis=1)
        g = _silu(x_sel @ w_gate)
        u = x_sel @ w_up
        y = (g * u) @ w_down
        r_sel = _sigmoid((lambda x, i, axis: torch.take_along_dim(x, i, dim=axis))(r, idx, axis=1))
        y = y * r_sel.reshape(B, C, 1)
        b_off = (torch.arange(B) * S).reshape(B, 1)
        flat_idx = (idx + b_off).reshape(B * C)
        zero = (x * 0.0).reshape(B * S, D)
        upd = _scatter_add(zero, flat_idx, y.reshape(B * C, D), axis=0)
        return x + upd.reshape(B, S, D)

    x = A_x
    xn = _layernorm(x, axis=-1)
    s = _A_ref(xn, A_dft_seq_re, A_dft_seq_im, A_dft_hid_re, A_dft_hid_im)
    g = _silu(_B_ref(xn, B_w_r, B_w_gate, B_w_up, B_w_down))
    return x + s * g
```

```asm
; @launch grid=(480,1,1) block=(512,1,1) lds=67072
.amdgcn_target "amdgcn-amd-amdhsa--gfx950"
.text
.globl recurrent_scan__spectral_fnet__moe_arch_mod__prompt_kernel
.p2align 8
.type recurrent_scan__spectral_fnet__moe_arch_mod__prompt_kernel,@function
recurrent_scan__spectral_fnet__moe_arch_mod__prompt_kernel:
    s_cmp_ge_u32 s2, 480
    s_cbranch_scc1 L_end
    s_load_dwordx2 s[4:5], s[0:1], 0
    s_load_dwordx2 s[10:11], s[0:1], 96
    s_load_dwordx8 s[36:43], s[0:1], 48
    s_load_dwordx2 s[8:9], s[0:1], 80
    v_lshrrev_b32 v1, 6, v0
    v_and_b32 v2, 63, v0
    v_readfirstlane_b32 s3, v1
    v_and_b32 v3, 15, v0
    v_lshrrev_b32 v4, 4, v2
    s_cmp_ge_u32 s2, 256
    s_cbranch_scc1 M_first
    s_cmp_ge_u32 s3, 1
    s_cbranch_scc1 L_nopf
    s_getpc_b64 s[6:7]
L_pc:
    s_mov_b32 m0, 66816
    s_bfe_u32 s34, s2, 0x20003
    s_mul_i32 s34, s34, 4096
    v_lshl_add_u32 v8, v0, 7, s34
    v_min_u32 v8, L_end-L_pc, v8
    v_mov_b32 v9, s7
    v_add_co_u32 v8, vcc, s6, v8
    s_nop 1
    v_addc_co_u32 v9, vcc, 0, v9, vcc
    s_mov_b64 exec, 0xffffffff
    global_load_lds_dword v[8:9], off
    s_mov_b64 exec, -1
L_nopf:
    s_cmp_ge_u32 s2, 256
    s_cbranch_scc1 M_first
    s_and_b32 s28, s2, 7
    s_bfe_u32 s44, s2, 0x10003
    s_lshr_b32 s45, s2, 4
    s_xor_b32 s30, s45, 15
    s_lshl3_add_u32 s30, s30, s28
    s_cmp_eq_u32 s30, 0
    s_cselect_b32 s46, 1, 0
    s_cmp_eq_u32 s2, 248
    s_cselect_b32 s30, 128, s30
    s_lshl_b32 s31, s3, 8
    s_add_u32 s31, s31, s30
    s_sub_u32 s32, 0, s31
    s_and_b32 s32, s32, 2047
    s_cmp_eq_u32 s44, 0
    s_cselect_b32 s47, s31, s32
    s_cselect_b32 s48, s32, s31
    s_lshl_b32 s49, s47, 11
    s_lshl_b32 s48, s48, 11
    v_lshrrev_b32 v5, 3, v2
    v_and_b32 v5, 2, v5
    v_xor_b32 v5, v5, v2
    v_lshlrev_b32 v5, 4, v5
    s_lshl_b32 s53, s3, 12
    s_mov_b32 s14, 4194304
    s_mov_b32 s15, 0x20000
    s_mov_b32 s18, 2048
    s_mov_b32 s19, 0x20000
    s_mov_b32 m0, 41216
    s_cmp_lg_u32 s3, 0
    s_waitcnt lgkmcnt(0)
    s_mov_b64 s[12:13], s[4:5]
    s_load_dword s33, s[10:11], 0
    s_cbranch_scc1 F_nowr
    s_mov_b64 s[16:17], s[36:37]
    buffer_load_dwordx4 v5, s[16:19], 0 offen lds
    buffer_load_dwordx4 v5, s[16:19], 0 offen offset:1024 lds
F_nowr:
    s_mov_b32 m0, s53
    s_mov_b64 s[24:25], s[10:11]
    buffer_load_dwordx4 v5, s[12:15], s49 offen lds
    buffer_load_dwordx4 v5, s[12:15], s49 offen offset:1024 lds
    s_branch F_go
M_first:
    s_cmp_lg_u32 s3, 0
    s_cbranch_scc1 M_entry
    s_setprio 3
    s_lshr_b32 s29, s2, 1
    s_xor_b32 s29, s29, s2
    s_and_b32 s29, s29, 8
    s_mul_i32 s29, s29, 3
    s_xor_b32 s28, s2, s29
    s_bitset0_b32 s28, 8
    v_mul_u32_u24 v8, 7168, v4
    v_lshlrev_b32 v9, 1, v4
    v_xor_b32 v9, v9, v3
    v_lshl_add_u32 v8, v9, 4, v8
    s_and_b32 s34, s28, 7
    s_mulk_i32 s34, 3584
    s_lshr_b32 s35, s28, 3
    s_add_u32 s34, s34, s35
    s_lshl_b32 s34, s34, 8
    s_mov_b32 s14, 7340032
    s_mov_b32 s15, 0x20000
    s_movk_i32 s46, 1280
    s_mov_b32 s45, s34
    s_waitcnt lgkmcnt(0)
    s_mov_b64 s[12:13], s[38:39]
M_burst:
    s_mov_b32 m0, s46
    s_addk_i32 s46, 1024
    buffer_load_dwordx4 v8, s[12:15], s45 offen nt lds
    s_addk_i32 s45, 28672
    v_xor_b32 v8, 128, v8
    s_cmpk_lt_u32 s46, 13568
    s_cbranch_scc1 M_burst
    s_branch M_loader2
F_go:
    s_mov_b32 s26, 268435456
    s_mov_b32 s27, 0x20000
    v_lshlrev_b32 v7, 2, v0
    s_lshl_b32 s34, s2, 11
    s_add_u32 s34, s34, 262144
    v_mov_b32 v6, -1
    buffer_store_dword v6, v7, s[24:27], s34 offen sc1
    v_lshlrev_b32 v126, 4, v2
    s_and_b32 s34, s3, 1
    s_lshr_b32 s35, s3, 1
    v_lshl_add_u32 v119, s34, 3, v126
    s_cmp_eq_u32 s35, 3
    s_cbranch_scc1 F_jobr8
    s_lshl4_add_u32 s54, s44, 1
    s_cmp_eq_u32 s35, 2
    s_cselect_b32 s54, 0, s54
    s_cselect_b32 s57, 4096, 0
    s_cmp_eq_u32 s35, 1
    s_cselect_b32 s55, 0x3a800000, 0
    s_cselect_b32 s58, s46, 0
    s_cselect_b32 s57, 7168, s57
    s_cselect_b32 s55, s55, 0x3d000000
    s_lshl_b32 s34, s34, 4
    v_lshl_add_u32 v109, v4, 2, s34
    v_cvt_f32_u32 v109, v109
    v_add_u32 v119, s57, v119
F_job:
    v_add_u32 v116, s54, v3
    v_cvt_f32_u32 v116, v116
    v_mul_f32 v116, s55, v116
    v_mul_f32 v117, v116, v109
    v_cos_f32 v76, v117
    v_sin_f32 v80, v117
    v_add_f32 v117, v117, v116
    v_cos_f32 v77, v117
    v_sin_f32 v81, v117
    v_add_f32 v117, v117, v116
    v_cos_f32 v78, v117
    v_sin_f32 v82, v117
    v_add_f32 v117, v117, v116
    v_cos_f32 v79, v117
    v_sin_f32 v83, v117
    s_cmp_eq_u32 s35, 0
    s_cbranch_scc1 F_jobf1
    v_cvt_pk_f16_f32 v84, v76, v77
    v_cvt_pk_f16_f32 v85, v78, v79
    v_cvt_pk_f16_f32 v86, v80, v81
    v_cvt_pk_f16_f32 v87, v82, v83
    v_xor_b32 v88, 0x80008000, v86
    v_xor_b32 v89, 0x80008000, v87
    ds_write2st64_b64 v119, v[84:85], v[86:87] offset0:85 offset1:87
    ds_write_b64 v119, v[88:89] offset:45568
    s_cmp_eq_u32 s58, 0
    s_cbranch_scc1 F_jobd
    s_mov_b32 s58, 0
    s_xor_b32 s54, s54, 16
    v_add_u32 v119, 3072, v119
    s_branch F_job
F_jobf1:
    v_cvt_pk_bf16_f32 v84, v76, v77
    v_cvt_pk_bf16_f32 v85, v78, v79
    v_cvt_pk_bf16_f32 v86, -v80, -v81
    v_cvt_pk_bf16_f32 v87, -v82, -v83
    ds_write2st64_b64 v119, v[84:85], v[86:87] offset0:85 offset1:87
    s_branch F_jobd
F_jobr8:
    v_and_b32 v118, 7, v3
    v_cvt_f32_u32 v118, v118
    v_mul_f32 v118, 0x3e000000, v118
    v_and_b32 v117, 1, v4
    v_lshl_add_u32 v117, v117, 1, s34
    v_cvt_f32_u32 v117, v117
    v_mul_f32 v117, v117, v118
    v_add_f32 v117, v117, v117
    v_add_f32 v118, v117, v118
    v_cos_f32 v76, v117
    v_sin_f32 v77, v117
    v_cos_f32 v78, v118
    v_sin_f32 v79, v118
    v_lshrrev_b32 v116, 2, v2
    v_xor_b32 v116, v116, v2
    v_bfe_u32 v116, v116, 3, 1
    v_add_u32 v116, -1, v116
    s_lshl_b32 s34, s44, 31
    v_cvt_pk_f16_f32 v84, v76, v77
    v_cvt_pk_f16_f32 v86, -v77, v76
    v_cvt_pk_f16_f32 v85, v78, v79
    v_cvt_pk_f16_f32 v87, -v79, v78
    v_bitop3_b32 v84, v84, s34, v116 bitop3:0x28
    v_bitop3_b32 v85, v85, s34, v116 bitop3:0x28
    v_bitop3_b32 v86, v86, s34, v116 bitop3:0x28
    v_bitop3_b32 v87, v87, s34, v116 bitop3:0x28
    ds_write2st64_b64 v119, v[84:85], v[86:87] offset0:89 offset1:91
F_jobd:
    s_and_b32 s51, s47, 7
    v_mov_b32 v108, 0
    s_bfe_u32 s34, s47, 0x40003
    v_mov_b32 v109, 0
    s_lshl4_add_u32 s51, s51, s34
    v_mov_b32 v110, 0
    s_lshr_b32 s34, s47, 7
    v_mov_b32 v111, 0
    s_lshl4_add_u32 s51, s51, s34
    v_mov_b32 v7, 56832
    s_lshl3_add_u32 s51, s51, 24576
    ds_write_b128 v7, v[108:111]
    s_lshl_b32 s52, s46, 23
    v_and_b32 v96, 60, v2
    s_sub_u32 s52, 0x3e000000, s52
    v_and_b32 v97, 3, v2
    s_mov_b32 s60, 0x80000000
    v_lshl_add_u32 v96, v96, 1, v97
    s_mov_b32 s61, 0xfffff800
    v_bfe_u32 v97, v2, 4, 1
    s_mov_b32 s71, 0
    v_lshl_add_u32 v96, v97, 2, v96
    v_lshlrev_b32 v96, 3, v96
    v_xor_b32 v97, 32, v96
    v_add_u32 v92, s53, v96
    v_xor_b32 v93, 32, v92
    v_mov_b32 v68, 0x3f803f80
    v_mov_b32 v69, 0x3f803f80
    v_mov_b32 v70, 0x3f803f80
    v_mov_b32 v71, 0x3f803f80
    v_mov_b32 v125, s47
    v_mov_b32 v118, 1
    v_mov_b32 v119, 0
    s_waitcnt vmcnt(3) lgkmcnt(0)
    s_barrier
    ds_read_b64_tr_b16 v[24:25], v96 offset:41216
    ds_read_b64_tr_b16 v[26:27], v96 offset:42240
    ds_read_b64_tr_b16 v[28:29], v97 offset:41216
    ds_read_b64_tr_b16 v[30:31], v97 offset:42240
    ds_read_b128 v[32:35], v126 offset:43520
    ds_read_b128 v[36:39], v126 offset:44544
    ds_read_b128 v[40:43], v126 offset:45568
    ds_read_b128 v[44:47], v126 offset:46592
    ds_read_b128 v[48:51], v126 offset:47616
    ds_read_b128 v[52:55], v126 offset:48640
    ds_read_b128 v[56:59], v126 offset:49664
    ds_read_b128 v[60:63], v126 offset:50688
    ds_read_b128 v[64:67], v126 offset:51712
    s_mul_i32 s33, s33, 0x9e3779b1
    s_add_u32 s33, s33, 0x7f4a7c15
    s_mov_b32 s63, 0x3a800000
    v_mov_b32 v117, s33
    s_waitcnt lgkmcnt(9)
    v_mfma_f32_16x16x32_bf16 v[100:103], v[68:71], v[24:27], 0
    v_mfma_f32_16x16x32_bf16 v[100:103], v[68:71], v[28:31], v[100:103]
    s_nop 7
    v_add_f32_dpp v100, v100, v100 row_ror:8 row_mask:0xf bank_mask:0xf
    s_nop 1
    v_add_f32_dpp v100, v100, v100 row_ror:4 row_mask:0xf bank_mask:0xf
    s_nop 1
    v_add_f32_dpp v100, v100, v100 row_ror:2 row_mask:0xf bank_mask:0xf
    s_nop 1
    v_add_f32_dpp v100, v100, v100 row_ror:1 row_mask:0xf bank_mask:0xf
    s_setprio 2
    s_waitcnt vmcnt(1) lgkmcnt(0)
    s_add_u32 m0, s53, 2048
    s_nop 0
    buffer_load_dwordx4 v5, s[12:15], s48 offen lds
    buffer_load_dwordx4 v5, s[12:15], s48 offen offset:1024 lds
    ds_read_b64_tr_b16 v[8:9], v92 offset:0
    ds_read_b64_tr_b16 v[10:11], v92 offset:1024
    ds_read_b64_tr_b16 v[12:13], v93 offset:0
    ds_read_b64_tr_b16 v[14:15], v93 offset:1024
    s_waitcnt lgkmcnt(2)
    v_mfma_f32_16x16x32_bf16 v[104:107], v[68:71], v[8:11], 0
    v_dot2_f32_bf16 v110, v8, v24, v110
    v_dot2_f32_bf16 v108, v8, v8, v108
    v_dot2_f32_bf16 v110, v9, v25, v110
    v_dot2_f32_bf16 v108, v9, v9, v108
    v_dot2_f32_bf16 v110, v10, v26, v110
    v_dot2_f32_bf16 v108, v10, v10, v108
    v_dot2_f32_bf16 v110, v11, v27, v110
    v_dot2_f32_bf16 v108, v11, v11, v108
    s_waitcnt lgkmcnt(0)
    v_mfma_f32_16x16x32_bf16 v[104:107], v[68:71], v[12:15], v[104:107]
    v_dot2_f32_bf16 v110, v12, v28, v110
    v_dot2_f32_bf16 v108, v12, v12, v108
    v_dot2_f32_bf16 v110, v13, v29, v110
    v_dot2_f32_bf16 v108, v13, v13, v108
    v_dot2_f32_bf16 v110, v14, v30, v110
    v_dot2_f32_bf16 v108, v14, v14, v108
    v_dot2_f32_bf16 v110, v15, v31, v110
    v_dot2_f32_bf16 v108, v15, v15, v108
    v_add_f32_dpp v104, v104, v104 row_ror:8 row_mask:0xf bank_mask:0xf
    s_nop 1
    v_permlane32_swap_b32 v108, v110
    v_add_f32_dpp v104, v104, v104 row_ror:4 row_mask:0xf bank_mask:0xf
    v_add_f32 v108, v108, v110
    s_nop 0
    v_add_f32_dpp v104, v104, v104 row_ror:2 row_mask:0xf bank_mask:0xf
    v_add_f32_dpp v108, v108, v108 row_ror:8 row_mask:0xf bank_mask:0xf
    s_nop 0
    v_add_f32_dpp v104, v104, v104 row_ror:1 row_mask:0xf bank_mask:0xf
    v_add_f32_dpp v108, v108, v108 row_ror:4 row_mask:0xf bank_mask:0xf
    v_mul_f32 v112, 0x3a800000, v104
    s_nop 0
    v_add_f32_dpp v108, v108, v108 row_ror:2 row_mask:0xf bank_mask:0xf
    v_mul_f32 v113, -v112, v112
    s_nop 0
    v_add_f32_dpp v108, v108, v108 row_ror:1 row_mask:0xf bank_mask:0xf
    v_mul_f32 v110, v112, v100
    s_nop 0
    v_add_f32_dpp v108, v108, v108 row_bcast:15 row_mask:0xa bank_mask:0xf
    s_nop 0
    v_readlane_b32 s34, v108, 48
    v_fmamk_f32 v108, v108, 0x3a800000, v113
    v_max_f32 v108, 0, v108
    v_add_f32 v111, 0x3727c5ac, v108
    v_rsq_f32 v111, v111
    v_sub_f32 v110, s34, v110
    v_mul_f32 v110, v110, v111
    v_ashrrev_i32 v115, 31, v110
    v_bitop3_b32 v115, v110, v115, s60 bitop3:0x1e
    v_and_or_b32 v115, v115, s61, v125
    s_mov_b64 exec, 0x10000
    s_waitcnt vmcnt(2)
    ds_max_u32 v7, v115
    ds_add_rtn_u32 v118, v7, v118 offset:8
    v_cvt_pk_bf16_f32 v116, v112, v108
    buffer_store_dwordx2 v[116:117], v119, s[24:27], s51 offen sc1
    s_mov_b64 exec, -1
    ds_read_b32 v114, v7
    v_mul_f32 v111, s52, v111
    v_mul_f32 v113, v112, v111
    v_readlane_b32 s54, v111, 16
    v_readlane_b32 s70, v113, 16
    v_mfma_f32_16x16x32_bf16 v[76:79], v[8:11], v[32:35], 0
    v_mfma_f32_16x16x32_bf16 v[80:83], v[12:15], v[32:35], 0
    v_mfma_f32_16x16x32_bf16 v[84:87], v[8:11], v[36:39], 0
    v_mfma_f32_16x16x32_bf16 v[88:91], v[12:15], v[36:39], 0
    s_waitcnt lgkmcnt(0)
    v_readlane_b32 s34, v118, 16
    s_nop 0
    s_cmp_lg_u32 s34, 7
    s_cbranch_scc0 F_key
F_nokey:
    s_setprio 0
    s_lshr_b32 s58, s3, 2
    v_xor_b32 v94, 0x3d8, v92
    s_lshl4_add_u32 s58, s3, s58
    v_xor_b32 v95, 0x3f8, v92
    s_lshl_b32 s58, s58, 6
    v_and_b32 v72, 0x3d8, v96
    s_and_b32 s59, s3, 3
    v_sub_u32 v72, 1024, v72
    s_lshl3_add_u32 s59, s3, s59
    v_add_u32 v73, -32, v72
    s_lshl_b32 s59, s59, 2
    v_lshrrev_b32 v74, 3, v72
    s_and_b32 s34, s30, 15
    v_lshrrev_b32 v75, 3, v73
    s_sub_u32 s35, 16, s34
    v_bitop3_b32 v72, v72, v74, 32 bitop3:0x78
    s_and_b32 s50, s34, 7
    v_bitop3_b32 v73, v73, v75, 32 bitop3:0x78
    s_cmp_gt_u32 s34, 8
    v_add_u32 v72, s53, v72
    s_cselect_b32 s50, s35, s50
    v_add_u32 v73, s53, v73
    s_and_b32 s34, s34, 8
    v_xor_b32 v74, 1024, v72
    s_lshl4_add_u32 s50, s50, s34
    v_bfe_u32 v120, v3, 1, 2
    s_lshr_b32 s34, s30, 4
    v_xor_b32 v120, v120, v4
    s_add_u32 s50, s50, s34
    v_lshl_add_u32 v120, v3, 2, v120
    s_cmp_eq_u32 s30, 128
    v_lshl_add_u32 v120, v120, 4, s58
    s_cselect_b32 s50, 128, s50
    v_xor_b32 v121, s59, v3
    s_lshl1_add_u32 s29, s50, s44
    v_lshrrev_b32 v16, 1, v4
    s_mul_i32 s50, s29, 8320
    v_lshl_add_u32 v121, v16, 4, v121
    s_lshl_b32 s34, s3, 10
    v_and_b32 v16, 1, v4
    s_add_u32 s50, s50, s34
    v_mul_u32_u24 v16, 1040, v16
    s_add_u32 s50, s50, 1048576
    v_add_lshl_u32 v121, v121, v16, 2
    s_and_b32 s29, s29, 255
    v_and_b32 v17, 7, v3
    s_lshl2_add_u32 s29, s29, 40960
    v_lshrrev_b32 v16, 3, v3
    s_cmp_eq_u32 s44, 0
    v_mul_u32_u24 v122, 128, v17
    s_cselect_b32 s35, 0, 0xc2000000
    v_lshl_add_u32 v122, v16, 6, v122
    v_lshl_add_u32 v122, v4, 4, v122
    v_add_u32 v124, 1, v3
    v_bfe_i32 v124, v124, 4, 1
    v_and_b32 v124, s35, v124
    s_cmp_lg_u32 s71, 0
    s_cbranch_scc1 F_wkey
    s_waitcnt vmcnt(1)
F_wkey_r:
    ds_read_b64_tr_b16 v[24:25], v94 offset:3072
    ds_read_b64_tr_b16 v[26:27], v94 offset:2048
    ds_read_b64_tr_b16 v[28:29], v95 offset:3072
    ds_read_b64_tr_b16 v[30:31], v95 offset:2048
    ds_read_b64_tr_b16 v[16:17], v74 offset:2048
    ds_read_b64_tr_b16 v[18:19], v72 offset:2048
    ds_read_b64_tr_b16 v[20:21], v73 offset:3072
    ds_read_b64_tr_b16 v[22:23], v73 offset:2048
    s_waitcnt lgkmcnt(6)
    v_mfma_f32_16x16x32_bf16 v[104:107], v[68:71], v[24:27], 0
    v_dot2_f32_bf16 v109, v24, v24, v109
    v_dot2_f32_bf16 v109, v25, v25, v109
    v_dot2_f32_bf16 v109, v26, v26, v109
    v_dot2_f32_bf16 v109, v27, v27, v109
    s_waitcnt lgkmcnt(4)
    v_mfma_f32_16x16x32_bf16 v[104:107], v[68:71], v[28:31], v[104:107]
    v_dot2_f32_bf16 v109, v28, v28, v109
    v_dot2_f32_bf16 v109, v29, v29, v109
    v_dot2_f32_bf16 v109, v30, v30, v109
    v_dot2_f32_bf16 v109, v31, v31, v109
    s_mov_b32 exec_lo, 0xeeeeeeee
    s_mov_b32 exec_hi, 0xeeeeeeee
    s_waitcnt lgkmcnt(0)
    v_mov_b32_dpp v16, v24 quad_perm:[0,3,2,1] row_mask:0xf bank_mask:0xf
    v_mov_b32_dpp v17, v25 quad_perm:[0,3,2,1] row_mask:0xf bank_mask:0xf
    v_mov_b32_dpp v18, v26 quad_perm:[0,3,2,1] row_mask:0xf bank_mask:0xf
    v_mov_b32_dpp v19, v27 quad_perm:[0,3,2,1] row_mask:0xf bank_mask:0xf
    v_mov_b32_dpp v20, v28 quad_perm:[0,3,2,1] row_mask:0xf bank_mask:0xf
    v_mov_b32_dpp v21, v29 quad_perm:[0,3,2,1] row_mask:0xf bank_mask:0xf
    v_mov_b32_dpp v22, v30 quad_perm:[0,3,2,1] row_mask:0xf bank_mask:0xf
    v_mov_b32_dpp v23, v31 quad_perm:[0,3,2,1] row_mask:0xf bank_mask:0xf
    s_mov_b64 exec, -1
    v_add_f32_dpp v112, v104, v104 row_ror:8 row_mask:0xf bank_mask:0xf
    v_add_f32_dpp v109, v109, v109 row_ror:8 row_mask:0xf bank_mask:0xf
    v_mfma_f32_16x16x32_bf16 v[92:95], v[16:19], v[32:35], 0
    v_add_f32_dpp v112, v112, v112 row_ror:4 row_mask:0xf bank_mask:0xf
    v_add_f32_dpp v109, v109, v109 row_ror:4 row_mask:0xf bank_mask:0xf
    v_mfma_f32_16x16x32_bf16 v[96:99], v[20:23], v[32:35], 0
    v_add_f32_dpp v112, v112, v112 row_ror:2 row_mask:0xf bank_mask:0xf
    v_add_f32_dpp v109, v109, v109 row_ror:2 row_mask:0xf bank_mask:0xf
    v_mfma_f32_16x16x32_bf16 v[100:103], v[16:19], v[36:39], 0
    v_add_f32_dpp v112, v112, v112 row_ror:1 row_mask:0xf bank_mask:0xf
    v_add_f32_dpp v109, v109, v109 row_ror:1 row_mask:0xf bank_mask:0xf
    v_mfma_f32_16x16x32_bf16 v[104:107], v[20:23], v[36:39], 0
    v_mul_f32 v112, 0x3a800000, v112
    v_add_f32_dpp v109, v109, v109 row_bcast:15 row_mask:0xa bank_mask:0xf
    v_fmaak_f32 v113, v112, v112, 0xb727c5ac
    v_mul_f32 v116, s70, v124
    v_add_f32_dpp v109, v109, v109 row_bcast:31 row_mask:0xc bank_mask:0xf
    v_fma_f32 v109, v109, s63, -v113
    v_max_f32 v109, 0x3727c5ac, v109
    v_rsq_f32 v109, v109
    v_pk_mul_f32 v[84:85], v[84:85], s[54:55] op_sel:[0,0] op_sel_hi:[1,0]
    v_mul_f32 v109, s52, v109
    v_pk_mul_f32 v[86:87], v[86:87], s[54:55] op_sel:[0,0] op_sel_hi:[1,0]
    v_readlane_b32 s55, v109, 48
    s_nop 1
    v_pk_mul_f32 v[88:89], v[88:89], s[54:55] op_sel:[0,0] op_sel_hi:[1,0]
    v_pk_mul_f32 v[90:91], v[90:91], s[54:55] op_sel:[0,0] op_sel_hi:[1,0]
    v_mul_f32 v112, s55, v112
    v_fmac_f32 v116, v112, v124
F_pass:
    v_pk_fma_f32 v[76:77], v[76:77], s[54:55], v[116:117] op_sel:[0,0,0] op_sel_hi:[1,0,0]
    v_pk_fma_f32 v[78:79], v[78:79], s[54:55], v[116:117] op_sel:[0,0,0] op_sel_hi:[1,0,0]
    v_pk_fma_f32 v[80:81], v[80:81], s[54:55], v[116:117] op_sel:[0,0,0] op_sel_hi:[1,0,0]
    v_pk_fma_f32 v[82:83], v[82:83], s[54:55], v[116:117] op_sel:[0,0,0] op_sel_hi:[1,0,0]
    v_pk_fma_f32 v[76:77], v[92:93], s[54:55], v[76:77] op_sel:[0,1,0] op_sel_hi:[1,1,1]
    v_pk_fma_f32 v[78:79], v[94:95], s[54:55], v[78:79] op_sel:[0,1,0] op_sel_hi:[1,1,1]
    v_pk_fma_f32 v[80:81], v[96:97], s[54:55], v[80:81] op_sel:[0,1,0] op_sel_hi:[1,1,1]
    v_pk_fma_f32 v[82:83], v[98:99], s[54:55], v[82:83] op_sel:[0,1,0] op_sel_hi:[1,1,1]
    v_pk_fma_f32 v[84:85], v[100:101], s[54:55], v[84:85] op_sel:[0,1,0] op_sel_hi:[1,1,1]
    v_pk_fma_f32 v[86:87], v[102:103], s[54:55], v[86:87] op_sel:[0,1,0] op_sel_hi:[1,1,1]
    v_pk_fma_f32 v[88:89], v[104:105], s[54:55], v[88:89] op_sel:[0,1,0] op_sel_hi:[1,1,1]
    v_pk_fma_f32 v[90:91], v[106:107], s[54:55], v[90:91] op_sel:[0,1,0] op_sel_hi:[1,1,1]
    v_cvt_pk_f16_f32 v24, v76, v77
    v_cvt_pk_f16_f32 v25, v78, v79
    v_cvt_pk_f16_f32 v26, v80, v81
    v_cvt_pk_f16_f32 v27, v82, v83
    v_cvt_pk_f16_f32 v28, v84, v85
    v_cvt_pk_f16_f32 v29, v86, v87
    v_cvt_pk_f16_f32 v30, v88, v89
    v_cvt_pk_f16_f32 v31, v90, v91
    v_pk_mul_f16 v68, v24, v60
    v_pk_mul_f16 v69, v25, v61
    v_pk_mul_f16 v70, v26, v62
    v_pk_mul_f16 v71, v27, v63
    v_pk_fma_f16 v68, v28, v64, v68
    v_pk_fma_f16 v69, v29, v65, v69
    v_pk_fma_f16 v70, v30, v66, v70
    v_pk_fma_f16 v71, v31, v67, v71
    v_pk_mul_f16 v72, v28, v60
    v_pk_mul_f16 v73, v29, v61
    v_pk_mul_f16 v74, v30, v62
    v_pk_mul_f16 v75, v31, v63
    v_mfma_f32_16x16x32_f16 v[92:95], v[68:71], v[48:51], 0
    v_mfma_f32_16x16x32_f16 v[96:99], v[68:71], v[56:59], 0
    v_pk_fma_f16 v72, v24, v64, v72 neg_lo:[1,0,0] neg_hi:[1,0,0]
    v_pk_fma_f16 v73, v25, v65, v73 neg_lo:[1,0,0] neg_hi:[1,0,0]
    v_pk_fma_f16 v74, v26, v66, v74 neg_lo:[1,0,0] neg_hi:[1,0,0]
    v_pk_fma_f16 v75, v27, v67, v75 neg_lo:[1,0,0] neg_hi:[1,0,0]
    s_nop 1
    v_mfma_f32_16x16x32_f16 v[92:95], v[72:75], v[52:55], v[92:95]
    v_mfma_f32_16x16x32_f16 v[96:99], v[72:75], v[48:51], v[96:99]
    s_nop 7
    v_cvt_pk_f16_f32 v24, v92, v96
    v_cvt_pk_f16_f32 v25, v93, v97
    v_cvt_pk_f16_f32 v26, v94, v98
    v_cvt_pk_f16_f32 v27, v95, v99
    ds_write_b128 v120, v[24:27] offset:32768
    s_waitcnt lgkmcnt(0)
    s_barrier
    ds_read2st64_b32 v[28:29], v121 offset0:128 offset1:132
    ds_read2st64_b32 v[30:31], v121 offset0:136 offset1:140
    s_waitcnt lgkmcnt(0)
    v_mfma_f32_16x16x32_f16 v[100:103], v[28:31], v[40:43], 0
    v_mfma_f32_16x16x32_f16 v[104:107], v[28:31], v[44:47], 0
    s_nop 7
    v_cvt_pk_f16_f32 v68, v100, v104
    v_cvt_pk_f16_f32 v69, v101, v105
    v_cvt_pk_f16_f32 v70, v102, v106
    v_cvt_pk_f16_f32 v71, v103, v107
    buffer_store_dwordx4 v[68:71], v122, s[24:27], s50 offen sc1
    s_cmp_lg_u32 s46, 0
    s_cbranch_scc1 F_second
    s_mov_b32 s34, 0x71605432
    v_bfe_u32 v6, v2, 2, 2
    s_mov_b32 s35, 0x98fedcba
    v_lshl_add_u32 v6, v6, 2, v4
    s_lshl_b32 s56, s45, 2
    v_and_b32 v1, 3, v2
    s_lshr_b64 s[34:35], s[34:35], s56
    v_lshlrev_b32 v1, 4, v1
    s_and_b32 s34, s34, 15
    v_lshl_add_u32 v6, v6, 18, v1
    s_xor_b32 s45, s45, 8
    v_lshrrev_b32 v108, 3, v3
    s_cmp_eq_u32 s44, 0
    v_and_b32 v109, 7, v3
    s_cselect_b32 s45, s45, s34
    v_lshlrev_b32 v123, 14, v108
    s_sub_u32 s34, 0, s28
    v_lshl_add_u32 v123, v4, 20, v123
    s_and_b32 s34, s34, 7
    v_lshl_add_u32 v123, v109, 3, v123
    s_lshr_b32 s35, s45, 1
    s_cmp_lt_u32 s35, s44
    s_cselect_b32 s28, s34, s28
    s_sub_u32 s34, 0, s28
    s_and_b32 s34, s34, 7
    s_sub_u32 s35, 31, s45
    s_cmp_eq_u32 s44, 0
    s_cselect_b32 s56, s28, s34
    s_cselect_b32 s57, s45, s35
    s_lshl4_add_u32 s64, s3, s56
    s_lshl_b32 s64, s64, 11
    s_lshl_b32 s34, s57, 6
    s_add_u32 s64, s64, s34
    s_add_u32 s65, s64, 262144
    s_add_u32 s66, s64, 524288
    s_add_u32 s67, s64, 786432
    s_mov_b64 s[20:21], s[8:9]
    s_mov_b32 s22, 4194304
    s_mov_b32 s23, 0x20000
    s_mov_b32 s16, 0
    s_lshr_b32 s34, s57, 1
    s_lshl4_add_u32 s34, s56, s34
    s_cmp_eq_u32 s34, 63
    s_cselect_b32 s46, 3, 0
    s_lshr_b32 s34, s3, 1
    s_lshl2_add_u32 s34, s46, s34
    s_cmp_lg_u32 s34, 0
    s_cbranch_scc1 F_xp0
    s_mov_b32 m0, s53
    s_add_u32 s35, s64, 16384
    buffer_load_dwordx4 v6, s[12:15], s64 offen lds
    s_add_u32 m0, s53, 1152
    s_add_u32 s35, s64, 16384
    buffer_load_dwordx4 v6, s[12:15], s35 offen lds
F_xp0:
    v_and_b32 v110, 31, v2
    v_lshrrev_b32 v111, 5, v2
    s_lshl_b32 s61, s44, 31
    s_xor_b32 s60, s61, 0x3a000000
    v_lshrrev_b32 v112, 1, v110
    v_lshl_add_u32 v112, v112, 3, s56
    v_cvt_f32_u32 v112, v112
    v_mul_f32 v112, s60, v112
    v_and_b32 v113, 1, v110
    v_cvt_f32_u32 v114, v113
    s_sub_u32 s58, 16, s3
    s_cmp_eq_u32 s3, 0
    s_cselect_b32 s34, 0, 0x3e800000
    s_cselect_b32 s35, 0, -1
    s_cselect_b32 s58, 8, s58
    v_mul_f32 v114, s34, v114
    v_mul_f32 v117, 0x42000000, v112
    v_lshl_add_u32 v116, v111, 4, s3
    v_cvt_f32_u32 v116, v116
    v_fma_f32 v116, v116, v112, v114
    v_cos_f32 v108, v116
    v_sin_f32 v109, v116
    v_add_f32 v116, v116, v117
    v_cvt_pk_f16_f32 v32, v108, v109
    v_cos_f32 v108, v116
    v_sin_f32 v109, v116
    v_add_f32 v116, v116, v117
    v_cvt_pk_f16_f32 v33, v108, v109
    v_cos_f32 v108, v116
    v_sin_f32 v109, v116
    v_add_f32 v116, v116, v117
    v_cvt_pk_f16_f32 v34, v108, v109
    v_cos_f32 v108, v116
    v_sin_f32 v109, v116
    v_add_f32 v116, v116, v117
    v_cvt_pk_f16_f32 v35, v108, v109
    v_mov_b32 v48, s33
    v_lshlrev_b32 v49, 10, v2
    s_lshl2_add_u32 s34, s46, s3
    s_cmp_ge_u32 s34, 4
    s_cbranch_scc1 F_x5a
    s_lshr_b32 s34, s3, 1
    s_lshl2_add_u32 s34, s46, s34
    s_cmp_lg_u32 s34, 1
    s_cbranch_scc1 F_xp1
    s_mov_b32 m0, s53
    s_add_u32 s35, s64, 16384
    buffer_load_dwordx4 v6, s[12:15], s64 offen lds
    s_add_u32 m0, s53, 1152
    s_add_u32 s35, s64, 16384
    buffer_load_dwordx4 v6, s[12:15], s35 offen lds
F_xp1:
    s_waitcnt vmcnt(2)
    s_branch F_x5b
F_x5a:
    s_waitcnt vmcnt(0)
F_x5b:
    s_cmp_lg_u32 s3, 7
    s_barrier
    s_cbranch_scc1 F_noflag
    s_mov_b32 exec_lo, 0xffffffff
    s_mov_b32 exec_hi, 0
    buffer_store_dword v48, v49, s[24:27], s29 offen sc1
    s_mov_b64 exec, -1
F_noflag:
    s_lshr_b32 s34, s3, s46
    s_cmp_lt_u32 s34, 4
    s_cbranch_scc1 F_x5c
    s_lshr_b32 s34, s3, 1
    s_lshl2_add_u32 s34, s46, s34
    s_cmp_lg_u32 s34, 2
    s_cbranch_scc1 F_xp2
    s_mov_b32 m0, s53
    s_add_u32 s35, s64, 16384
    buffer_load_dwordx4 v6, s[12:15], s64 offen lds
    s_add_u32 m0, s53, 1152
    s_add_u32 s35, s64, 16384
    buffer_load_dwordx4 v6, s[12:15], s35 offen lds
F_xp2:
F_x5c:
    v_lshrrev_b32 v118, 3, v3
    v_lshlrev_b32 v124, 7, v118
    v_lshl_add_u32 v124, v4, 5, v124
    s_lshl3_add_u32 s59, s56, s3
    s_lshl_b32 s59, s59, 8
    s_add_u32 s59, s59, 24576
    s_mov_b32 s62, 0
F_stats:
    buffer_load_dwordx4 v[24:27], v124, s[24:27], s59 offen sc1
    buffer_load_dwordx4 v[28:31], v124, s[24:27], s59 offen offset:16 sc1
    s_cmp_lg_u32 s62, 0
    s_cbranch_scc1 F_stats_w
F_stats_i:
    v_lshl_add_u32 v116, v111, 4, s58
    v_cvt_f32_u32 v116, v116
    v_fma_f32 v116, v116, v112, -v114
    v_cos_f32 v108, v116
    v_sin_f32 v109, v116
    v_add_f32 v116, v116, v117
    v_cvt_pk_f16_f32 v36, v108, v109
    v_cos_f32 v108, v116
    v_sin_f32 v109, v116
    v_add_f32 v116, v116, v117
    v_cvt_pk_f16_f32 v37, v108, v109
    v_cos_f32 v108, v116
    v_sin_f32 v109, v116
    v_add_f32 v116, v116, v117
    v_cvt_pk_f16_f32 v38, v108, v109
    v_cos_f32 v108, v116
    v_sin_f32 v109, v116
    v_add_f32 v116, v116, v117
    v_cvt_pk_f16_f32 v39, v108, v109
    s_cmp_lg_u32 s3, 0
    s_cbranch_scc1 F_now0
    v_mul_f32 v116, 0x43000000, v112
    v_cos_f32 v108, v116
    v_sin_f32 v109, v116
    v_add_u32 v115, -1, v113
    v_and_b32 v32, v32, v115
    v_bfi_b32 v36, v115, 0, v36
    v_and_b32 v33, v33, v115
    v_bfi_b32 v37, v115, 0, v37
    v_and_b32 v34, v34, v115
    v_bfi_b32 v38, v115, 0, v38
    v_and_b32 v35, v35, v115
    v_bfi_b32 v39, v115, 0, v39
    v_or_b32 v115, v113, v111
    v_add_u32 v115, -1, v115
    v_cvt_pk_f16_f32 v40, v108, v109
    v_and_b32 v40, v40, v115
    v_mov_b32 v41, 0
    v_mov_b32 v57, 0
    v_mov_b32 v42, 0
    v_mov_b32 v58, 0
    v_mov_b32 v43, 0
    v_mov_b32 v59, 0
F_now0:
    s_lshr_b32 s34, s3, 1
    s_lshl2_add_u32 s34, s46, s34
    s_cmp_lg_u32 s34, 3
    s_cbranch_scc1 F_xp3
    s_mov_b32 m0, s53
    s_add_u32 s35, s64, 16384
    buffer_load_dwordx4 v6, s[12:15], s64 offen lds
    s_add_u32 m0, s53, 1152
    s_add_u32 s35, s64, 16384
    buffer_load_dwordx4 v6, s[12:15], s35 offen lds
F_xp3:
    s_xor_b32 s60, s61, 0x3d800000
    v_cvt_f32_u32 v117, v3
    v_mul_f32 v117, s60, v117
    v_lshlrev_b32 v116, 1, v4
    v_cvt_f32_u32 v116, v116
    v_mul_f32 v116, v116, v117
    v_add_f32 v117, v116, v117
    v_cos_f32 v108, v116
    v_sin_f32 v109, v116
    v_cos_f32 v114, v117
    v_sin_f32 v115, v117
    v_cvt_pk_f16_f32 v44, v108, v109
    s_mov_b32 s34, 0x3c003c00
    v_cvt_pk_f16_f32 v45, v114, v115
    s_mov_b64 exec, 0xffff
    v_lshl_or_b32 v44, v3, 31, s34
    s_mov_b64 exec, -1
    v_lshl_add_u32 v122, s3, 1, v118
    v_mul_u32_u24 v122, 1280, v122
    v_mul_u32_u24 v108, 272, v4
    v_and_b32 v109, 7, v3
    v_lshlrev_b32 v109, 5, v109
    v_add3_u32 v122, v122, v108, v109
    s_lshr_b32 s34, s3, 1
    s_mul_i32 s34, s34, 272
    s_and_b32 s35, s3, 1
    s_lshl2_add_u32 s34, s35, s34
    v_mul_u32_u24 v121, 2560, v111
    v_lshl_add_u32 v121, v110, 3, v121
    v_add_u32 v121, s34, v121
    s_cmp_eq_u32 s44, 0
    s_cselect_b32 s34, 0, 31
    s_cselect_b32 s35, -1, 0
    s_lshl_b32 s60, s45, 5
    s_add_u32 s35, s35, s60
    v_xor_b32 v108, s34, v110
    v_add_u32 v108, s35, v108
    v_max_i32 v108, 0, v108
    v_bfe_u32 v125, v108, 4, 1
    v_mul_u32_u24 v125, 8320, v125
    v_lshrrev_b32 v109, 6, v108
    v_lshl_add_u32 v125, v109, 10, v125
    v_bfe_u32 v109, v108, 5, 1
    v_lshl_add_u32 v125, v109, 6, v125
    v_and_b32 v108, 15, v108
    v_lshl_add_u32 v125, v108, 2, v125
    v_mul_u32_u24 v120, 16640, v111
    v_add_u32 v120, v120, v125
    s_lshl_b32 s58, s28, 7
    s_add_u32 s58, s58, 1048576
    s_add_u32 s60, s58, 2129920
    s_mul_i32 s34, s3, 266240
    s_add_u32 s58, s58, s34
    s_lshl4_add_u32 s47, s3, s56
    s_lshl_b32 s48, s57, 7
    s_add_u32 s49, s48, 491520
    s_lshl1_add_u32 s48, s48, 753664
    s_add_u32 s52, s48, 128
    s_and_b32 s34, s2, 31
    s_lshl3_add_u32 s34, s34, s3
    s_lshl_b32 s34, s34, 7
    s_add_u32 s34, s34, 40960
    s_add_u32 s42, s10, s34
    s_addc_u32 s43, s11, 0
    s_mov_b32 s40, s33
    s_mov_b32 s41, s33
    s_and_b32 s63, s2, 31
    s_lshl_b32 s63, s63, 7
    s_add_u32 s63, s63, 4096
    v_mul_u32_u24 v108, 1152, v118
    v_lshl_add_u32 v108, v4, 6, v108
    v_and_b32 v109, 7, v3
    v_lshlrev_b32 v109, 3, v109
    v_add3_u32 v108, v108, v109, s53
    s_cmp_eq_u32 s46, 3
    s_cbranch_scc1 F_poll
    s_waitcnt vmcnt(0)
F_xt:
    ds_read_b64 v[8:9], v108 offset:0
    ds_read_b64 v[10:11], v108 offset:256
    ds_read_b64 v[12:13], v108 offset:512
    ds_read_b64 v[14:15], v108 offset:768
    s_waitcnt lgkmcnt(3)
    v_lshlrev_b32 v60, 16, v8
    v_and_b32 v64, 0xffff0000, v8
    v_lshlrev_b32 v68, 16, v9
    v_and_b32 v72, 0xffff0000, v9
    s_waitcnt lgkmcnt(2)
    v_lshlrev_b32 v61, 16, v10
    v_and_b32 v65, 0xffff0000, v10
    v_lshlrev_b32 v69, 16, v11
    v_and_b32 v73, 0xffff0000, v11
    s_waitcnt lgkmcnt(1)
    v_lshlrev_b32 v62, 16, v12
    v_and_b32 v66, 0xffff0000, v12
    v_lshlrev_b32 v70, 16, v13
    v_and_b32 v74, 0xffff0000, v13
    s_waitcnt lgkmcnt(0)
    v_lshlrev_b32 v63, 16, v14
    v_and_b32 v67, 0xffff0000, v14
    v_lshlrev_b32 v71, 16, v15
    v_and_b32 v75, 0xffff0000, v15
F_stats_w:
    s_waitcnt vmcnt(0)
F_stats_c:
    v_xor_b32 v108, s33, v25
    v_xor_b32 v109, s33, v27
    v_xor_b32 v110, s33, v29
    v_xor_b32 v111, s33, v31
    v_or3_b32 v108, v108, v109, v110
    v_or_b32 v108, v108, v111
    v_cmp_ne_u32 vcc, 0, v108
    s_add_u32 s62, s62, 1
    s_cbranch_vccz F_stats_d
    s_sleep 4
    s_cmp_lt_u32 s62, 200000
    s_cbranch_scc1 F_stats
F_stats_d:
    s_cmp_lt_u32 s2, 224
    s_cbranch_scc1 F_npf2
    s_cmp_gt_u32 s3, 1
    s_cbranch_scc1 F_npf2
    s_getpc_b64 s[6:7]
L_pc2:
    s_mov_b32 m0, 66816
    v_lshlrev_b32 v110, 7, v0
    v_min_u32 v110, L_end-L_pc2, v110
    v_mov_b32 v111, s7
    v_add_co_u32 v110, vcc, s6, v110
    s_nop 1
    v_addc_co_u32 v111, vcc, 0, v111, vcc
    global_load_lds_dword v[110:111], off sc1
F_npf2:
    s_cmp_eq_u32 s46, 2
    s_cbranch_scc1 F_npre
    s_load_dwordx16 s[68:83], s[42:43], 0 glc
    s_load_dwordx16 s[84:99], s[42:43], 64 glc
F_npre:
    s_mov_b32 s34, 0xbe38aa3b
    v_mov_b32 v108, 0x3427c5ac
    v_and_b32 v16, 0xffff0000, v24
    v_fmamk_f32 v16, v16, 0x3c800000, v108
    v_and_b32 v17, 0xffff0000, v26
    v_fmamk_f32 v17, v17, 0x3c800000, v108
    v_and_b32 v18, 0xffff0000, v28
    v_fmamk_f32 v18, v18, 0x3c800000, v108
    v_and_b32 v19, 0xffff0000, v30
    v_fmamk_f32 v19, v19, 0x3c800000, v108
    v_rsq_f32 v16, v16
    v_lshlrev_b32 v20, 16, v24
    v_rsq_f32 v17, v17
    v_lshlrev_b32 v21, 16, v26
    v_rsq_f32 v18, v18
    v_lshlrev_b32 v22, 16, v28
    v_rsq_f32 v19, v19
    v_lshlrev_b32 v23, 16, v30
    v_pk_mul_f32 v[20:21], v[20:21], v[16:17] neg_lo:[1,0] neg_hi:[1,0]
    v_pk_mul_f32 v[22:23], v[22:23], v[18:19] neg_lo:[1,0] neg_hi:[1,0]
    v_pk_mul_f32 v[24:25], v[16:17], s[34:35] op_sel:[0,0] op_sel_hi:[1,0]
    v_pk_mul_f32 v[26:27], v[18:19], s[34:35] op_sel:[0,0] op_sel_hi:[1,0]
    v_pk_mul_f32 v[28:29], v[20:21], s[34:35] op_sel:[0,0] op_sel_hi:[1,0]
    v_pk_mul_f32 v[30:31], v[22:23], s[34:35] op_sel:[0,0] op_sel_hi:[1,0]
    v_pk_fma_f32 v[92:93], v[60:61], v[24:25], v[28:29]
    v_pk_fma_f32 v[94:95], v[62:63], v[26:27], v[30:31]
    v_pk_fma_f32 v[96:97], v[64:65], v[24:25], v[28:29]
    v_pk_fma_f32 v[98:99], v[66:67], v[26:27], v[30:31]
    v_pk_fma_f32 v[100:101], v[68:69], v[24:25], v[28:29]
    v_pk_fma_f32 v[102:103], v[70:71], v[26:27], v[30:31]
    v_pk_fma_f32 v[104:105], v[72:73], v[24:25], v[28:29]
    v_pk_fma_f32 v[106:107], v[74:75], v[26:27], v[30:31]
    v_exp_f32 v92, v92
    v_exp_f32 v93, v93
    v_pk_fma_f32 v[76:77], v[60:61], v[16:17], v[20:21]
    v_exp_f32 v94, v94
    v_exp_f32 v95, v95
    v_pk_fma_f32 v[78:79], v[62:63], v[18:19], v[22:23]
    v_exp_f32 v96, v96
    v_exp_f32 v97, v97
    v_pk_fma_f32 v[80:81], v[64:65], v[16:17], v[20:21]
    v_exp_f32 v98, v98
    v_exp_f32 v99, v99
    v_pk_fma_f32 v[82:83], v[66:67], v[18:19], v[22:23]
    v_exp_f32 v100, v100
    v_exp_f32 v101, v101
    v_pk_fma_f32 v[84:85], v[68:69], v[16:17], v[20:21]
    v_exp_f32 v102, v102
    v_exp_f32 v103, v103
    v_pk_fma_f32 v[86:87], v[70:71], v[18:19], v[22:23]
    v_exp_f32 v104, v104
    v_exp_f32 v105, v105
    v_pk_fma_f32 v[88:89], v[72:73], v[16:17], v[20:21]
    v_exp_f32 v106, v106
    v_exp_f32 v107, v107
    v_pk_fma_f32 v[90:91], v[74:75], v[18:19], v[22:23]
    s_mov_b32 s62, 0
    s_cmp_lg_u32 s46, 2
    s_cbranch_scc1 F_poll_w
F_mid:
    v_pk_add_f32 v[92:93], v[92:93], 1.0 op_sel_hi:[1,0]
    v_pk_add_f32 v[94:95], v[94:95], 1.0 op_sel_hi:[1,0]
    v_pk_add_f32 v[96:97], v[96:97], 1.0 op_sel_hi:[1,0]
    v_pk_add_f32 v[98:99], v[98:99], 1.0 op_sel_hi:[1,0]
    v_pk_add_f32 v[100:101], v[100:101], 1.0 op_sel_hi:[1,0]
    v_pk_add_f32 v[102:103], v[102:103], 1.0 op_sel_hi:[1,0]
    v_pk_add_f32 v[104:105], v[104:105], 1.0 op_sel_hi:[1,0]
    v_pk_add_f32 v[106:107], v[106:107], 1.0 op_sel_hi:[1,0]
    v_rcp_f32 v92, v92
    v_rcp_f32 v93, v93
    v_rcp_f32 v94, v94
    v_rcp_f32 v95, v95
    v_rcp_f32 v96, v96
    v_rcp_f32 v97, v97
    v_rcp_f32 v98, v98
    v_rcp_f32 v99, v99
    v_rcp_f32 v100, v100
    v_rcp_f32 v101, v101
    v_rcp_f32 v102, v102
    v_rcp_f32 v103, v103
    v_rcp_f32 v104, v104
    v_rcp_f32 v105, v105
    v_rcp_f32 v106, v106
    v_rcp_f32 v107, v107
    v_pk_mul_f32 v[76:77], v[76:77], v[92:93]
    v_pk_mul_f32 v[78:79], v[78:79], v[94:95]
    v_pk_mul_f32 v[80:81], v[80:81], v[96:97]
    v_pk_mul_f32 v[82:83], v[82:83], v[98:99]
    v_pk_mul_f32 v[84:85], v[84:85], v[100:101]
    v_pk_mul_f32 v[86:87], v[86:87], v[102:103]
    v_pk_mul_f32 v[88:89], v[88:89], v[104:105]
    v_pk_mul_f32 v[90:91], v[90:91], v[106:107]
    s_mov_b32 s62, 0
    s_cmp_eq_u32 s46, 2
    s_cbranch_scc1 F_fetched
    s_branch F_poll_w
F_poll:
    s_load_dwordx16 s[68:83], s[42:43], 0 glc
    s_load_dwordx16 s[84:99], s[42:43], 64 glc
F_poll_w:
    s_waitcnt lgkmcnt(0)
    s_xor_b64 s[68:69], s[68:69], s[40:41]
    s_xor_b64 s[70:71], s[70:71], s[40:41]
    s_or_b64 s[68:69], s[68:69], s[70:71]
    s_xor_b64 s[72:73], s[72:73], s[40:41]
    s_or_b64 s[68:69], s[68:69], s[72:73]
    s_xor_b64 s[74:75], s[74:75], s[40:41]
    s_or_b64 s[68:69], s[68:69], s[74:75]
    s_xor_b64 s[76:77], s[76:77], s[40:41]
    s_or_b64 s[68:69], s[68:69], s[76:77]
    s_xor_b64 s[78:79], s[78:79], s[40:41]
    s_or_b64 s[68:69], s[68:69], s[78:79]
    s_xor_b64 s[80:81], s[80:81], s[40:41]
    s_or_b64 s[68:69], s[68:69], s[80:81]
    s_xor_b64 s[82:83], s[82:83], s[40:41]
    s_or_b64 s[68:69], s[68:69], s[82:83]
    s_xor_b64 s[84:85], s[84:85], s[40:41]
    s_or_b64 s[68:69], s[68:69], s[84:85]
    s_xor_b64 s[86:87], s[86:87], s[40:41]
    s_or_b64 s[68:69], s[68:69], s[86:87]
    s_xor_b64 s[88:89], s[88:89], s[40:41]
    s_or_b64 s[68:69], s[68:69], s[88:89]
    s_xor_b64 s[90:91], s[90:91], s[40:41]
    s_or_b64 s[68:69], s[68:69], s[90:91]
    s_xor_b64 s[92:93], s[92:93], s[40:41]
    s_or_b64 s[68:69], s[68:69], s[92:93]
    s_xor_b64 s[94:95], s[94:95], s[40:41]
    s_or_b64 s[68:69], s[68:69], s[94:95]
    s_xor_b64 s[96:97], s[96:97], s[40:41]
    s_or_b64 s[68:69], s[68:69], s[96:97]
    s_xor_b64 s[98:99], s[98:99], s[40:41]
    s_or_b64 s[68:69], s[68:69], s[98:99]
    s_cbranch_scc0 F_rel
    s_cmp_lg_u32 s46, 0
    s_cbranch_scc1 F_poll_n
    s_mov_b32 s46, 1
    s_load_dwordx16 s[68:83], s[42:43], 0 glc
    s_load_dwordx16 s[84:99], s[42:43], 64 glc
    s_branch F_mid
F_poll_n:
    s_add_u32 s62, s62, 1
    s_sleep 5
    s_cmp_lt_u32 s62, 200000
    s_cbranch_scc1 F_poll
F_rel:
    s_cmp_lg_u32 s46, 3
    s_cbranch_scc1 F_nlx
    s_mov_b32 m0, s53
    s_add_u32 s35, s64, 16384
    buffer_load_dwordx4 v6, s[12:15], s64 offen lds
    s_add_u32 m0, s53, 1152
    s_add_u32 s35, s64, 16384
    buffer_load_dwordx4 v6, s[12:15], s35 offen lds
F_nlx:
    buffer_load_dword v48, v120, s[24:27], s58 offen sc1
    s_add_u32 s58, s58, 33280
    buffer_load_dword v49, v120, s[24:27], s58 offen sc1
    s_add_u32 s58, s58, 33280
    buffer_load_dword v50, v120, s[24:27], s58 offen sc1
    s_add_u32 s58, s58, 33280
    buffer_load_dword v51, v120, s[24:27], s58 offen sc1
    s_add_u32 s58, s58, 33280
    buffer_load_dword v52, v120, s[24:27], s58 offen sc1
    s_add_u32 s58, s58, 33280
    buffer_load_dword v53, v120, s[24:27], s58 offen sc1
    s_add_u32 s58, s58, 33280
    buffer_load_dword v54, v120, s[24:27], s58 offen sc1
    s_add_u32 s58, s58, 33280
    buffer_load_dword v55, v120, s[24:27], s58 offen sc1
    s_load_dwordx2 s[36:37], s[10:11], s63
    s_cmp_lg_u32 s3, 0
    s_cbranch_scc1 F_novx
    buffer_load_dword v56, v125, s[24:27], s60 offen sc1
F_novx:
    s_cmp_eq_u32 s46, 3
    s_cbranch_scc1 F_lx
    s_cmp_eq_u32 s46, 0
    s_mov_b32 s46, 2
    s_cbranch_scc1 F_mid
F_fetched:
    s_cmp_lg_u32 s3, 0
    s_cbranch_scc1 F_A
    s_waitcnt vmcnt(0)
    v_mfma_f32_32x32x16_f16 v[92:107], v[40:43], v[56:59], 0
    v_mfma_f32_32x32x16_f16 v[92:107], v[32:35], v[48:51], v[92:107]
    s_branch F_A2
F_A:
    s_waitcnt vmcnt(4)
    v_mfma_f32_32x32x16_f16 v[92:107], v[32:35], v[48:51], 0
    s_waitcnt vmcnt(0)
F_A2:
    v_mfma_f32_32x32x16_f16 v[92:107], v[36:39], v[52:55], v[92:107]
    s_waitcnt lgkmcnt(0)
    s_and_b32 s34, s36, 0x77
    s_cmp_eq_u32 s34, s47
    s_cbranch_scc1 F_eh
F_eh_r:
    s_nop 7
    v_cvt_pk_f16_f32 v48, v92, v93
    v_cvt_pk_f16_f32 v49, v94, v95
    ds_write2st64_b32 v121, v48, v49 offset0:128 offset1:133
    v_cvt_pk_f16_f32 v50, v96, v97
    v_cvt_pk_f16_f32 v51, v98, v99
    ds_write2st64_b32 v121, v50, v51 offset0:148 offset1:153
    v_cvt_pk_f16_f32 v52, v100, v101
    v_cvt_pk_f16_f32 v53, v102, v103
    ds_write2st64_b32 v121, v52, v53 offset0:168 offset1:173
    v_cvt_pk_f16_f32 v54, v104, v105
    v_cvt_pk_f16_f32 v55, v106, v107
    ds_write2st64_b32 v121, v54, v55 offset0:188 offset1:193
    s_waitcnt lgkmcnt(0)
    s_barrier
    ds_read_b128 v[48:51], v122 offset:32768
    ds_read_b128 v[52:55], v122 offset:32784
    s_waitcnt lgkmcnt(1)
    v_mfma_f32_16x16x16_f16 v[92:95], v[44:45], v[48:49], 0
    v_mfma_f32_16x16x16_f16 v[96:99], v[44:45], v[50:51], 0
    s_waitcnt lgkmcnt(0)
    v_mfma_f32_16x16x16_f16 v[100:103], v[44:45], v[52:53], 0
    v_mfma_f32_16x16x16_f16 v[104:107], v[44:45], v[54:55], 0
    s_and_b32 s34, s36, 0x77
    s_cmp_lg_u32 s34, s47
    s_cbranch_scc1 F_noh
    s_mul_i32 s50, s33, 28
    s_sub_u32 s50, s50, s68
    s_sub_u32 s50, s50, s69
    s_sub_u32 s50, s50, s70
    s_sub_u32 s50, s50, s71
    s_sub_u32 s50, s50, s72
    s_sub_u32 s50, s50, s73
    s_sub_u32 s50, s50, s74
    s_sub_u32 s50, s50, s75
    s_sub_u32 s50, s50, s76
    s_sub_u32 s50, s50, s77
    s_sub_u32 s50, s50, s78
    s_sub_u32 s50, s50, s79
    s_sub_u32 s50, s50, s80
    s_sub_u32 s50, s50, s81
    s_sub_u32 s50, s50, s84
    s_sub_u32 s50, s50, s85
    s_sub_u32 s50, s50, s86
    s_sub_u32 s50, s50, s87
    s_sub_u32 s50, s50, s88
    s_sub_u32 s50, s50, s89
    s_sub_u32 s50, s50, s90
    s_sub_u32 s50, s50, s91
    s_sub_u32 s50, s50, s92
    s_sub_u32 s50, s50, s93
    s_sub_u32 s50, s50, s94
    s_sub_u32 s50, s50, s95
    s_sub_u32 s50, s50, s96
    s_sub_u32 s50, s50, s97
    s_cmp_eq_u32 s50, 0
    s_cbranch_scc1 F_own
    s_load_dwordx16 s[68:83], s[10:11], s48 glc
    s_load_dwordx16 s[84:99], s[10:11], s52 glc
F_noh:
    s_cmp_eq_u32 s57, 0
    s_cbranch_scc1 F_zero
F_nz:
    v_pk_fma_f32 v[60:61], v[92:93], v[76:77], v[60:61]
    v_pk_fma_f32 v[64:65], v[96:97], v[80:81], v[64:65]
    v_pk_fma_f32 v[68:69], v[100:101], v[84:85], v[68:69]
    v_pk_fma_f32 v[72:73], v[104:105], v[88:89], v[72:73]
    v_cvt_pk_bf16_f32 v32, v60, v64
    v_cvt_pk_bf16_f32 v33, v68, v72
    buffer_store_dwordx2 v[32:33], v123, s[20:23], s64 offen nt
    v_cvt_pk_bf16_f32 v34, v61, v65
    v_cvt_pk_bf16_f32 v35, v69, v73
    buffer_store_dwordx2 v[34:35], v123, s[20:23], s65 offen nt
    v_pk_fma_f32 v[62:63], v[94:95], v[78:79], v[62:63]
    v_pk_fma_f32 v[66:67], v[98:99], v[82:83], v[66:67]
    v_pk_fma_f32 v[70:71], v[102:103], v[86:87], v[70:71]
    v_pk_fma_f32 v[74:75], v[106:107], v[90:91], v[74:75]
    v_cvt_pk_bf16_f32 v36, v62, v66
    v_cvt_pk_bf16_f32 v37, v70, v74
    buffer_store_dwordx2 v[36:37], v123, s[20:23], s66 offen nt
    v_cvt_pk_bf16_f32 v38, v63, v67
    v_cvt_pk_bf16_f32 v39, v71, v75
    buffer_store_dwordx2 v[38:39], v123, s[20:23], s67 offen nt
    s_mov_b32 s62, 0
    s_cmp_lg_u32 s16, 0
    s_cbranch_scc1 F_own2
F_res:
    s_cmp_eq_u32 s37, s33
    s_cbranch_scc1 F_res_d
    s_load_dwordx2 s[36:37], s[10:11], s63 glc
    s_add_u32 s62, s62, 1
    s_cmp_lt_u32 s62, 200000
    s_waitcnt lgkmcnt(0)
    s_cbranch_scc1 F_res
F_res_d:
    s_and_b32 s34, s36, 0x77
    s_cmp_lg_u32 s34, s47
    s_cbranch_scc1 L_fin
    v_lshrrev_b32 v108, 3, v2
    v_lshlrev_b32 v108, 12, v108
    v_and_b32 v109, 0x70, v126
    v_add_u32 v108, v108, v109
    s_cmp_eq_u32 s50, 0
    s_cbranch_scc1 F_n2_d
    s_mul_i32 s50, s33, 28
    s_mov_b32 s62, 0
F_n2:
    s_waitcnt lgkmcnt(0)
    s_add_u32 s84, s84, s68
    s_add_u32 s84, s84, s69
    s_add_u32 s84, s84, s70
    s_add_u32 s84, s84, s71
    s_add_u32 s84, s84, s72
    s_add_u32 s84, s84, s73
    s_add_u32 s84, s84, s74
    s_add_u32 s84, s84, s75
    s_add_u32 s84, s84, s76
    s_add_u32 s84, s84, s77
    s_add_u32 s84, s84, s78
    s_add_u32 s84, s84, s79
    s_add_u32 s84, s84, s80
    s_add_u32 s84, s84, s81
    s_add_u32 s84, s84, s85
    s_add_u32 s84, s84, s86
    s_add_u32 s84, s84, s87
    s_add_u32 s84, s84, s88
    s_add_u32 s84, s84, s89
    s_add_u32 s84, s84, s90
    s_add_u32 s84, s84, s91
    s_add_u32 s84, s84, s92
    s_add_u32 s84, s84, s93
    s_add_u32 s84, s84, s94
    s_add_u32 s84, s84, s95
    s_add_u32 s84, s84, s96
    s_add_u32 s84, s84, s97
    s_cmp_eq_u32 s84, s50
    s_cbranch_scc1 F_n2_d
    s_load_dwordx16 s[68:83], s[10:11], s48 glc
    s_load_dwordx16 s[84:99], s[10:11], s52 glc
    s_add_u32 s62, s62, 1
    s_cmp_lt_u32 s62, 200000
    s_cbranch_scc1 F_n2
F_n2_d:
    s_mov_b32 s62, 0
F_h2:
    s_mov_b32 s34, s49
    buffer_load_dwordx4 v[8:11], v108, s[24:27], s34 offen sc1
    s_add_u32 s34, s34, 32768
    buffer_load_dwordx4 v[12:15], v108, s[24:27], s34 offen sc1
    s_add_u32 s34, s34, 32768
    buffer_load_dwordx4 v[24:27], v108, s[24:27], s34 offen sc1
    s_add_u32 s34, s34, 32768
    buffer_load_dwordx4 v[28:31], v108, s[24:27], s34 offen sc1
    s_add_u32 s34, s34, 32768
    buffer_load_dwordx4 v[48:51], v108, s[24:27], s34 offen sc1
    s_add_u32 s34, s34, 32768
    buffer_load_dwordx4 v[52:55], v108, s[24:27], s34 offen sc1
    s_add_u32 s34, s34, 32768
    buffer_load_dwordx4 v[56:59], v108, s[24:27], s34 offen sc1
    s_cmp_lg_u32 s62, 0
    s_cbranch_scc1 F_h2_w
F_own2:
    s_bfe_u32 s38, s36, 0x20007
    s_bfe_u32 s39, s36, 0x20009
    s_bfe_u32 s51, s36, 0x10003
    s_set_gpr_idx_on s38, 1
    v_mov_b32 v40, v92
    v_mov_b32 v41, v96
    v_mov_b32 v42, v100
    v_mov_b32 v43, v104
    v_mov_b32 v44, v16
    v_mov_b32 v45, v20
    s_set_gpr_idx_off
    s_lshl1_add_u32 s34, s39, s51
    s_lshl_b32 s44, s34, 3
    v_add_u32 v114, s53, v126
    ds_write_b128 v114, v[40:43] offset:2560
    v_and_b32 v113, 7, v2
    v_lshl_add_u32 v113, v113, 2, v4
    s_lshl4_add_u32 s34, s44, s53
    v_lshl_add_u32 v112, v113, 2, s34
    ds_read_b32 v112, v112 offset:2560
    s_lshl2_add_u32 s34, s38, s39
    s_lshl_b32 s34, s34, 6
    s_mul_i32 s35, s51, 1152
    s_add_u32 s34, s34, s35
    s_add_u32 s34, s34, s53
    v_lshlrev_b32 v113, 1, v113
    v_add_u32 v110, s34, v113
    ds_read_u16 v110, v110
    v_readlane_b32 s45, v44, s44
    v_readlane_b32 s46, v45, s44
    s_and_b32 s34, s36, 0xfffff800
    s_ashr_i32 s35, s34, 31
    s_orn2_b32 s35, 0x80000000, s35
    s_xor_b32 s34, s34, s35
    v_mov_b32 v109, 0xbfb8aa3b
    v_mul_f32 v109, s34, v109
    v_exp_f32 v109, v109
    s_waitcnt lgkmcnt(0)
    v_lshlrev_b32 v110, 16, v110
    v_mov_b32 v111, s46
    v_add_f32 v109, 1.0, v109
    v_rcp_f32 v109, v109
    v_fmac_f32 v111, s45, v110
    v_mul_f32 v109, 0x41000000, v109
    s_and_b32 s38, s36, 2047
    s_lshl_b32 s38, s38, 11
    s_lshl_b32 s34, s57, 6
    s_add_u32 s38, s38, s34
    s_cmp_eq_u32 s16, 0
    s_cbranch_scc1 F_h2_w
    s_waitcnt vmcnt(4)
    v_pk_add_f32 v[88:89], v[8:9], v[12:13]
    v_pk_add_f32 v[90:91], v[10:11], v[14:15]
    v_pk_add_f32 v[88:89], v[88:89], v[24:25]
    v_pk_add_f32 v[90:91], v[90:91], v[26:27]
    v_pk_add_f32 v[88:89], v[88:89], v[28:29]
    v_pk_add_f32 v[90:91], v[90:91], v[30:31]
    v_pk_add_f32 v[88:89], v[88:89], v[48:49]
    v_pk_add_f32 v[90:91], v[90:91], v[50:51]
    v_pk_add_f32 v[88:89], v[88:89], v[52:53]
    v_pk_add_f32 v[90:91], v[90:91], v[54:55]
    v_pk_add_f32 v[88:89], v[88:89], v[56:57]
    v_pk_add_f32 v[90:91], v[90:91], v[58:59]
    s_nop 0
    v_permlane16_swap_b32 v88, v89
    v_permlane16_swap_b32 v90, v91
    v_add_f32 v88, v88, v89
    v_add_f32 v90, v90, v91
    s_nop 1
    v_permlane32_swap_b32 v88, v90
    v_add_f32 v88, v88, v90
    s_nop 1
    v_add_f32_dpp v88, v88, v88 row_ror:8 row_mask:0xf bank_mask:0xf
    v_cmp_u_f32 vcc, v88, v88
    v_fma_f32 v88, v88, v109, v111
    s_cbranch_vccz F_h2_d
    s_branch F_h2_x
F_h2_w:
    s_waitcnt vmcnt(5)
    v_pk_add_f32 v[88:89], v[8:9], v[12:13]
    v_pk_add_f32 v[90:91], v[10:11], v[14:15]
    s_waitcnt vmcnt(4)
    v_pk_add_f32 v[88:89], v[88:89], v[24:25]
    v_pk_add_f32 v[90:91], v[90:91], v[26:27]
    s_waitcnt vmcnt(3)
    v_pk_add_f32 v[88:89], v[88:89], v[28:29]
    v_pk_add_f32 v[90:91], v[90:91], v[30:31]
    s_waitcnt vmcnt(2)
    v_pk_add_f32 v[88:89], v[88:89], v[48:49]
    v_pk_add_f32 v[90:91], v[90:91], v[50:51]
    s_waitcnt vmcnt(1)
    v_pk_add_f32 v[88:89], v[88:89], v[52:53]
    v_pk_add_f32 v[90:91], v[90:91], v[54:55]
    s_waitcnt vmcnt(0)
    v_pk_add_f32 v[88:89], v[88:89], v[56:57]
    v_pk_add_f32 v[90:91], v[90:91], v[58:59]
    s_nop 0
    v_permlane16_swap_b32 v88, v89
    v_permlane16_swap_b32 v90, v91
    v_add_f32 v88, v88, v89
    v_add_f32 v90, v90, v91
    s_nop 1
    v_permlane32_swap_b32 v88, v90
    v_add_f32 v88, v88, v90
    s_nop 1
    v_add_f32_dpp v88, v88, v88 row_ror:8 row_mask:0xf bank_mask:0xf
    v_cmp_u_f32 vcc, v88, v88
    v_fma_f32 v88, v88, v109, v111
    s_cbranch_vccnz F_h2_x
F_h2_d:
    v_mul_f32 v89, 0xbe38aa3b, v88
    v_exp_f32 v89, v89
    v_mul_f32 v88, v88, v112
    v_add_f32 v89, 1.0, v89
    v_rcp_f32 v89, v89
    s_mov_b32 exec_lo, 0x00ff00ff
    s_mov_b32 exec_hi, 0x00ff00ff
    v_fmac_f32 v110, v88, v89
    v_cvt_pk_bf16_f32 v110, v110, v110
    buffer_store_short v110, v113, s[20:23], s38 offen nt
    s_cmp_lg_u32 s57, 0
    s_cbranch_scc1 L_fin
    s_mov_b64 exec, 1
    v_mov_b32 v108, 0
    v_mov_b32 v109, s33
    buffer_store_dword v109, v108, s[24:27], 0 offen
    s_branch L_fin
F_lx:
    s_mov_b32 s46, 2
    s_mov_b32 s62, 0
    s_waitcnt vmcnt(8) lgkmcnt(0)
    s_branch F_xt
F_own:
    s_cmp_lg_u32 s37, s33
    s_cbranch_scc1 F_noh
    v_lshrrev_b32 v108, 3, v2
    v_lshlrev_b32 v108, 12, v108
    v_and_b32 v109, 0x70, v126
    v_add_u32 v108, v108, v109
    s_mov_b32 s34, s49
    buffer_load_dwordx4 v[8:11], v108, s[24:27], s34 offen sc1
    s_add_u32 s34, s34, 32768
    buffer_load_dwordx4 v[12:15], v108, s[24:27], s34 offen sc1
    s_add_u32 s34, s34, 32768
    buffer_load_dwordx4 v[24:27], v108, s[24:27], s34 offen sc1
    s_add_u32 s34, s34, 32768
    buffer_load_dwordx4 v[28:31], v108, s[24:27], s34 offen sc1
    s_add_u32 s34, s34, 32768
    buffer_load_dwordx4 v[48:51], v108, s[24:27], s34 offen sc1
    s_add_u32 s34, s34, 32768
    buffer_load_dwordx4 v[52:55], v108, s[24:27], s34 offen sc1
    s_add_u32 s34, s34, 32768
    buffer_load_dwordx4 v[56:59], v108, s[24:27], s34 offen sc1
    s_mov_b32 s16, 1
    s_branch F_noh
F_eh:
    s_load_dwordx16 s[68:83], s[10:11], s48 glc
    s_load_dwordx16 s[84:99], s[10:11], s52 glc
    s_branch F_eh_r
F_h2_x:
    v_max3_u32 v89, v8, v9, v10
    v_max3_u32 v89, v89, v11, v12
    v_max3_u32 v89, v89, v13, v14
    v_max3_u32 v89, v89, v15, v24
    v_max3_u32 v89, v89, v25, v26
    v_max3_u32 v89, v89, v27, v28
    v_max3_u32 v89, v89, v29, v30
    v_max3_u32 v89, v89, v31, v48
    v_max3_u32 v89, v89, v49, v50
    v_max3_u32 v89, v89, v51, v52
    v_max3_u32 v89, v89, v53, v54
    v_max3_u32 v89, v89, v55, v56
    v_max3_u32 v89, v89, v57, v58
    v_max_u32 v89, v89, v59
    v_cmp_eq_u32 vcc, -1, v89
    s_add_u32 s62, s62, 1
    s_cbranch_vccz F_h2_d
    s_cmp_lt_u32 s62, 200000
    s_cbranch_scc1 F_h2
    s_branch F_h2_d
F_zero:
    s_mov_b32 exec_lo, 0x01010101
    s_mov_b32 exec_hi, 0x01010101
    s_nop 2
    v_mov_b32 v92, 0
    v_mov_b32 v93, 0
    v_mov_b32 v94, 0
    v_mov_b32 v95, 0
    s_mov_b64 exec, -1
    s_branch F_nz
F_second:
    ds_read_b128 v[60:63], v126 offset:53760
    ds_read_b128 v[64:67], v126 offset:54784
    s_mov_b32 s46, 0
    s_mul_i32 s34, s44, 16640
    s_add_u32 s50, s50, 8320
    s_sub_u32 s50, s50, s34
    v_add_u32 v113, 1, v3
    v_bfe_i32 v113, v113, 4, 1
    v_and_b32 v113, 0xc2000000, v113
    v_xor_b32 v124, v113, v124
    v_xor_b32 v32, 0x80000000, v32
    v_xor_b32 v33, 0x80000000, v33
    v_xor_b32 v34, 0x80000000, v34
    v_xor_b32 v35, 0x80000000, v35
    v_xor_b32 v36, 0x80000000, v36
    v_xor_b32 v37, 0x80000000, v37
    v_xor_b32 v38, 0x80000000, v38
    v_xor_b32 v39, 0x80000000, v39
    v_mul_f32 v116, s70, v124
    v_fmac_f32 v116, v112, v124
    v_mfma_f32_16x16x32_bf16 v[76:79], v[8:11], v[32:35], 0
    v_mfma_f32_16x16x32_bf16 v[80:83], v[12:15], v[32:35], 0
    v_mfma_f32_16x16x32_bf16 v[84:87], v[8:11], v[36:39], 0
    v_mfma_f32_16x16x32_bf16 v[88:91], v[12:15], v[36:39], 0
    v_mfma_f32_16x16x32_bf16 v[92:95], v[16:19], v[32:35], 0
    v_mfma_f32_16x16x32_bf16 v[96:99], v[20:23], v[32:35], 0
    v_mfma_f32_16x16x32_bf16 v[100:103], v[16:19], v[36:39], 0
    v_mfma_f32_16x16x32_bf16 v[104:107], v[20:23], v[36:39], 0
    s_nop 2
    v_pk_mul_f32 v[84:85], v[84:85], s[54:55] op_sel:[0,0] op_sel_hi:[1,0]
    v_pk_mul_f32 v[86:87], v[86:87], s[54:55] op_sel:[0,0] op_sel_hi:[1,0]
    v_pk_mul_f32 v[88:89], v[88:89], s[54:55] op_sel:[0,0] op_sel_hi:[1,0]
    v_pk_mul_f32 v[90:91], v[90:91], s[54:55] op_sel:[0,0] op_sel_hi:[1,0]
    s_waitcnt lgkmcnt(0)
    s_barrier
    s_branch F_pass
F_key:
    v_mov_b32 v115, s33
    v_lshlrev_b32 v108, 11, v2
    s_lshl3_add_u32 s35, s2, 8192
    s_mov_b32 exec_lo, 0xff
    s_mov_b32 exec_hi, 0x0
    buffer_store_dwordx2 v[114:115], v108, s[24:27], s35 offen sc1
    s_mov_b64 exec, -1
    s_mov_b32 s71, 1
    s_branch F_nokey
F_wkey:
    s_waitcnt vmcnt(2)
    s_branch F_wkey_r
M_entry:
    s_sub_u32 s28, s2, 256
    s_lshr_b32 s29, s28, 1
    s_xor_b32 s29, s29, s28
    s_and_b32 s29, s29, 8
    s_mul_i32 s29, s29, 3
    s_xor_b32 s28, s28, s29
    s_lshr_b32 s29, s28, 2
    s_and_b32 s30, s28, 3
    s_xor_b32 s30, s30, 1
    s_setprio 3
    v_mov_b32 v7, 1152
    s_mov_b32 s26, 268435456
    s_mov_b32 s27, 0x20000
    v_mov_b32 v8, 0
    v_mov_b32 v9, 0
    v_mov_b32 v10, 0
    v_mov_b32 v11, 0
    v_mov_b32 v114, 0
    ds_write_b128 v7, v[8:11]
    ds_write_b128 v7, v[8:11] offset:16
    ds_write_b128 v7, v[8:11] offset:32
    v_mov_b32 v8, 0x3f803f80
    v_mov_b32 v9, 0x3f803f80
    v_lshlrev_b32 v10, 3, v2
    ds_write_b64 v10, v[8:9] offset:512
    s_waitcnt lgkmcnt(0)
    s_load_dword s16, s[10:11], 0
    s_mul_i32 s12, s3, 320
    s_min_u32 s12, s12, 2048
    s_add_u32 s18, s12, 7872
    s_and_b32 s13, s28, 7
    s_lshl_b32 s13, s13, 11
    s_add_u32 s12, s12, s13
    s_add_u32 s12, s12, 7872
    s_add_u32 s12, s10, s12
    s_addc_u32 s13, s11, 0
    s_barrier
    s_waitcnt lgkmcnt(0)
    s_mul_i32 s16, s16, 0x9e3779b1
    s_add_u32 s16, s16, 0x7f4a7c15
    s_mul_i32 s15, s16, 40
    s_mov_b32 s17, 0
    s_sub_u32 s31, s3, 2
    s_cmp_lt_u32 s31, 4
    s_cbranch_scc1 M_pre
    v_mov_b32 v8, 1152
    s_mov_b32 s62, 0
M_pg:
    ds_read_b32 v9, v8
    s_waitcnt lgkmcnt(0)
    v_cmp_gt_u32 vcc, 8, v9
    s_add_u32 s62, s62, 1
    s_cbranch_vccz M_pg_d
    s_sleep 1
    s_cmp_lt_u32 s62, 1000000
    s_cbranch_scc1 M_pg
M_pg_d:
    s_branch M_scan0
M_pre:
    s_and_b32 s46, s28, 7
    s_lshl2_add_u32 s6, s46, s31
    s_lshl_b32 s6, s6, 6
    s_lshr_b32 s44, s28, 3
    s_lshr_b32 s34, s31, 1
    s_lshl1_add_u32 s44, s44, s34
    s_lshl4_add_u32 s44, s44, s46
    s_and_b32 s34, s31, 1
    s_lshl1_add_u32 s44, s44, s34
    s_lshl_b32 s44, s44, 7
    v_lshrrev_b32 v114, 5, v2
    v_mul_u32_u24 v114, 0x4800, v114
    v_xor_b32 v114, s44, v114
    v_and_b32 v115, 31, v2
    v_lshl_add_u32 v114, v115, 2, v114
    s_mov_b32 s44, 262144
    s_lshl2_add_u32 s45, s29, s30
    s_lshl_b32 s45, s45, 10
    s_lshl_b32 s34, s31, 8
    s_add_u32 s45, s45, s34
    s_add_u32 s45, s45, 491520
    s_lshl_b32 s34, s31, 6
    v_lshl_add_u32 v113, v2, 2, s34
    s_mov_b32 s7, s45
    v_bfe_u32 v8, v2, 2, 2
    v_lshl_add_u32 v9, v4, 2, v8
    v_and_b32 v10, 7, v9
    v_lshlrev_b32 v10, 1, v10
    v_bfe_u32 v11, v2, 1, 1
    s_lshl_b32 s34, s31, 2
    v_or_b32 v12, s34, v11
    v_xor_b32 v12, v12, v10
    v_lshlrev_b32 v12, 4, v12
    v_lshl_add_u32 v12, v9, 8, v12
    v_and_b32 v13, 1, v2
    v_lshl_add_u32 v12, v13, 3, v12
    v_xor_b32 v126, 32, v12
    s_lshl_b32 s34, s31, 3
    v_or_b32 v120, s34, v11
    v_xor_b32 v120, v120, v10
    v_lshlrev_b32 v120, 4, v120
    v_lshl_add_u32 v120, v9, 9, v120
    v_lshl_add_u32 v120, v13, 3, v120
    v_xor_b32 v121, 32, v120
    v_xor_b32 v122, 64, v120
    v_xor_b32 v123, 96, v120
    v_lshlrev_b32 v14, 4, v4
    v_and_b32 v15, 1, v2
    v_lshl_add_u32 v15, v15, 9, v14
    v_mov_b32 v8, 1152
    s_mov_b32 s62, 0
M_wg6:
    ds_read_b32 v9, v8
    s_waitcnt lgkmcnt(0)
    v_cmp_gt_u32 vcc, 6, v9
    s_add_u32 s62, s62, 1
    s_cbranch_vccz M_wg6_d
    s_sleep 1
    s_cmp_lt_u32 s62, 1000000
    s_cbranch_scc1 M_wg6
M_wg6_d:
    ds_read_b64_tr_b16 v[16:17], v12 offset:1280
    ds_read_b64_tr_b16 v[18:19], v12 offset:5376
    ds_read_b64_tr_b16 v[32:33], v126 offset:1280
    ds_read_b64_tr_b16 v[34:35], v126 offset:5376
    ds_read_b64_tr_b16 v[20:21], v12 offset:9472
    ds_read_b64_tr_b16 v[22:23], v12 offset:13568
    ds_read_b64_tr_b16 v[36:37], v126 offset:9472
    ds_read_b64_tr_b16 v[38:39], v126 offset:13568
    ds_read_b64_tr_b16 v[24:25], v12 offset:17664
    ds_read_b64_tr_b16 v[26:27], v12 offset:21760
    ds_read_b64_tr_b16 v[40:41], v126 offset:17664
    ds_read_b64_tr_b16 v[42:43], v126 offset:21760
    v_mov_b32 v8, 1
    s_waitcnt lgkmcnt(0)
    s_mov_b64 exec, 1
    ds_add_u32 v7, v8 offset:4
    s_mov_b64 exec, -1
    v_mov_b32 v8, 1152
    s_mov_b32 s62, 0
M_wg:
    ds_read_b32 v9, v8
    s_waitcnt lgkmcnt(0)
    v_cmp_gt_u32 vcc, 8, v9
    s_add_u32 s62, s62, 1
    s_cbranch_vccz M_wg_d
    s_sleep 1
    s_cmp_lt_u32 s62, 1000000
    s_cbranch_scc1 M_wg
M_wg_d:
    ds_read_b64_tr_b16 v[28:29], v12 offset:25856
    ds_read_b64_tr_b16 v[30:31], v12 offset:29952
    ds_read_b64_tr_b16 v[44:45], v126 offset:25856
    ds_read_b64_tr_b16 v[46:47], v126 offset:29952
M_scan0:
    s_lshl_b32 s15, s16, 3
    s_mov_b32 s19, 0
    v_mov_b32 v10, 0
    s_load_dwordx16 s[20:35], s[12:13], 0
    s_load_dwordx16 s[36:51], s[12:13], 64
    s_load_dwordx16 s[52:67], s[12:13], 128
    s_load_dwordx16 s[68:83], s[12:13], 192
    s_load_dwordx16 s[84:99], s[12:13], 256
    v_mov_b32 v8, 1
    s_mov_b64 exec, 1
    s_waitcnt lgkmcnt(0)
    ds_add_u32 v7, v8 offset:24
    s_mov_b64 exec, -1
    s_branch M_scan1
M_scan:
    s_waitcnt lgkmcnt(0)
M_scan1:
    s_add_u32 s14, s21, s23
    s_add_u32 s14, s14, s25
    s_add_u32 s14, s14, s27
    s_add_u32 s14, s14, s29
    s_add_u32 s14, s14, s31
    s_add_u32 s14, s14, s33
    s_add_u32 s14, s14, s35
    s_cmp_lg_u32 s14, s15
    s_cbranch_scc1 M_sec0
    v_max_u32 v10, s20, v10
    v_max_u32 v10, s22, v10
    v_max_u32 v10, s24, v10
    v_max_u32 v10, s26, v10
    v_max_u32 v10, s28, v10
    v_max_u32 v10, s30, v10
    v_max_u32 v10, s32, v10
    v_max_u32 v10, s34, v10
    s_bitset1_b32 s19, 0
    s_mov_b32 s21, 0
M_sec0:
    s_add_u32 s14, s37, s39
    s_add_u32 s14, s14, s41
    s_add_u32 s14, s14, s43
    s_add_u32 s14, s14, s45
    s_add_u32 s14, s14, s47
    s_add_u32 s14, s14, s49
    s_add_u32 s14, s14, s51
    s_cmp_lg_u32 s14, s15
    s_cbranch_scc1 M_sec1
    v_max_u32 v10, s36, v10
    v_max_u32 v10, s38, v10
    v_max_u32 v10, s40, v10
    v_max_u32 v10, s42, v10
    v_max_u32 v10, s44, v10
    v_max_u32 v10, s46, v10
    v_max_u32 v10, s48, v10
    v_max_u32 v10, s50, v10
    s_bitset1_b32 s19, 1
    s_mov_b32 s37, 0
M_sec1:
    s_add_u32 s14, s53, s55
    s_add_u32 s14, s14, s57
    s_add_u32 s14, s14, s59
    s_add_u32 s14, s14, s61
    s_add_u32 s14, s14, s63
    s_add_u32 s14, s14, s65
    s_add_u32 s14, s14, s67
    s_cmp_lg_u32 s14, s15
    s_cbranch_scc1 M_sec2
    v_max_u32 v10, s52, v10
    v_max_u32 v10, s54, v10
    v_max_u32 v10, s56, v10
    v_max_u32 v10, s58, v10
    v_max_u32 v10, s60, v10
    v_max_u32 v10, s62, v10
    v_max_u32 v10, s64, v10
    v_max_u32 v10, s66, v10
    s_bitset1_b32 s19, 2
    s_mov_b32 s53, 0
M_sec2:
    s_add_u32 s14, s69, s71
    s_add_u32 s14, s14, s73
    s_add_u32 s14, s14, s75
    s_add_u32 s14, s14, s77
    s_add_u32 s14, s14, s79
    s_add_u32 s14, s14, s81
    s_add_u32 s14, s14, s83
    s_cmp_lg_u32 s14, s15
    s_cbranch_scc1 M_sec3
    v_max_u32 v10, s68, v10
    v_max_u32 v10, s70, v10
    v_max_u32 v10, s72, v10
    v_max_u32 v10, s74, v10
    v_max_u32 v10, s76, v10
    v_max_u32 v10, s78, v10
    v_max_u32 v10, s80, v10
    v_max_u32 v10, s82, v10
    s_bitset1_b32 s19, 3
    s_mov_b32 s69, 0
M_sec3:
    s_add_u32 s14, s85, s87
    s_add_u32 s14, s14, s89
    s_add_u32 s14, s14, s91
    s_add_u32 s14, s14, s93
    s_add_u32 s14, s14, s95
    s_add_u32 s14, s14, s97
    s_add_u32 s14, s14, s99
    s_cmp_lg_u32 s14, s15
    s_cbranch_scc1 M_sec4
    v_max_u32 v10, s84, v10
    v_max_u32 v10, s86, v10
    v_max_u32 v10, s88, v10
    v_max_u32 v10, s90, v10
    v_max_u32 v10, s92, v10
    v_max_u32 v10, s94, v10
    v_max_u32 v10, s96, v10
    v_max_u32 v10, s98, v10
    s_bitset1_b32 s19, 4
    s_mov_b32 s85, 0
M_sec4:
    s_cmp_eq_u32 s19, 31
    s_cbranch_scc1 M_scan_d
    s_add_u32 s17, s17, 1
    s_add_u32 s14, s2, s17
    s_and_b32 s14, s14, 7
    s_lshl_b32 s14, s14, 11
    s_add_u32 s14, s14, s18
    s_add_u32 s12, s10, s14
    s_addc_u32 s13, s11, 0
    s_sleep 2
    s_cmp_ge_u32 s17, 8
    s_cbranch_scc1 M_scan_u
    s_bitcmp1_b32 s19, 0
    s_cbranch_scc1 M_rla0
    s_load_dwordx16 s[20:35], s[12:13], 0
M_rla0:
    s_bitcmp1_b32 s19, 1
    s_cbranch_scc1 M_rla1
    s_load_dwordx16 s[36:51], s[12:13], 64
M_rla1:
    s_bitcmp1_b32 s19, 2
    s_cbranch_scc1 M_rla2
    s_load_dwordx16 s[52:67], s[12:13], 128
M_rla2:
    s_bitcmp1_b32 s19, 3
    s_cbranch_scc1 M_rla3
    s_load_dwordx16 s[68:83], s[12:13], 192
M_rla3:
    s_bitcmp1_b32 s19, 4
    s_cbranch_scc1 M_rla4
    s_load_dwordx16 s[84:99], s[12:13], 256
M_rla4:
    s_branch M_scan
M_scan_u:
    s_bitcmp1_b32 s19, 0
    s_cbranch_scc1 M_rlb0
    s_load_dwordx16 s[20:35], s[12:13], 0 glc
M_rlb0:
    s_bitcmp1_b32 s19, 1
    s_cbranch_scc1 M_rlb1
    s_load_dwordx16 s[36:51], s[12:13], 64 glc
M_rlb1:
    s_bitcmp1_b32 s19, 2
    s_cbranch_scc1 M_rlb2
    s_load_dwordx16 s[52:67], s[12:13], 128 glc
M_rlb2:
    s_bitcmp1_b32 s19, 3
    s_cbranch_scc1 M_rlb3
    s_load_dwordx16 s[68:83], s[12:13], 192 glc
M_rlb3:
    s_bitcmp1_b32 s19, 4
    s_cbranch_scc1 M_rlb4
    s_load_dwordx16 s[84:99], s[12:13], 256 glc
M_rlb4:
    s_cmp_lt_u32 s17, 200000
    s_cbranch_scc1 M_scan
    s_waitcnt lgkmcnt(0)
M_scan_d:
    v_mov_b32 v8, 1
    s_mov_b64 exec, 1
    ds_max_u32 v7, v10 offset:16
    ds_add_u32 v7, v8 offset:20
    s_mov_b64 exec, -1
    s_sub_u32 s31, s3, 2
    s_cmp_lt_u32 s31, 4
    s_cbranch_scc1 M_comp
    s_mov_b32 s33, s16
    s_sub_u32 s28, s2, 256
    s_lshr_b32 s29, s28, 1
    s_xor_b32 s29, s29, s28
    s_and_b32 s29, s29, 8
    s_mul_i32 s29, s29, 3
    s_xor_b32 s28, s28, s29
    s_lshr_b32 s29, s28, 2
    s_and_b32 s30, s28, 3
    s_xor_b32 s30, s30, 1
    s_mov_b64 s[24:25], s[10:11]
    s_mov_b32 s26, 268435456
    s_mov_b32 s27, 0x20000
    s_cmp_ge_u32 s3, 6
    s_cbranch_scc1 M_agent
    s_cmp_ge_u32 s3, 6
    s_cbranch_scc1 L_fin
    s_cmp_eq_u32 s3, 1
    s_branch M_poller
M_agent:
    s_and_b32 s47, s28, 7
    s_lshl_b32 s47, s47, 8
    s_mov_b32 s49, 0
    s_mov_b32 s62, 0
M_ag:
    ds_read_b64 v[8:9], v7 offset:16
    s_waitcnt lgkmcnt(0)
    v_readfirstlane_b32 s48, v8
    v_readfirstlane_b32 s46, v9
    s_nop 0
    s_cmp_ge_u32 s46, 7
    s_cbranch_scc1 L_fin
    s_cmp_eq_u32 s48, s49
    s_cbranch_scc1 M_ag_n
    s_mov_b32 s49, s48
    s_and_b32 s34, s48, 2047
    s_lshl_b32 s34, s34, 11
    s_add_u32 s34, s34, s47
    s_load_dword s54, s[4:5], s34
    s_add_u32 s34, s34, 64
    s_load_dword s55, s[4:5], s34
    s_add_u32 s34, s34, 64
    s_load_dword s56, s[4:5], s34
    s_add_u32 s34, s34, 64
    s_load_dword s57, s[4:5], s34
    s_and_b32 s50, s48, 7
    s_bfe_u32 s34, s48, 0x40003
    s_lshl4_add_u32 s50, s50, s34
    s_bfe_u32 s34, s48, 0x40007
    s_lshl4_add_u32 s50, s50, s34
    s_lshl3_add_u32 s50, s50, 24576
    s_load_dwordx2 s[52:53], s[10:11], s50
M_ag_n:
    s_add_u32 s62, s62, 1
    s_cmp_lt_u32 s62, 1000000
    s_cbranch_scc1 M_ag
    s_branch L_fin
M_loader2:
    v_mov_b32 v7, 1152
    s_mov_b32 s26, 268435456
    s_mov_b32 s27, 0x20000
    v_xor_b32 v18, 128, v8
    s_lshr_b32 s29, s28, 2
    s_and_b32 s30, s28, 3
    s_xor_b32 s30, s30, 1
    s_mov_b64 s[24:25], s[10:11]
    s_mov_b32 s16, s40
    s_and_b32 s17, s41, 0xffff
    s_mov_b32 s18, 7340032
    s_mov_b32 s19, 0x20000
    s_mov_b32 s47, 3
    s_barrier
M_ld3:
    s_mov_b32 m0, s46
    s_add_u32 s46, s46, 1024
    buffer_load_dwordx4 v8, s[12:15], s45 offen nt lds
    s_add_u32 s45, s45, 28672
    s_waitcnt vmcnt(12)
    s_mov_b32 m0, s46
    s_add_u32 s46, s46, 1024
    buffer_load_dwordx4 v18, s[12:15], s45 offen nt lds
    s_add_u32 s45, s45, 28672
    s_waitcnt vmcnt(12)
    s_mov_b32 m0, s46
    s_add_u32 s46, s46, 1024
    buffer_load_dwordx4 v8, s[12:15], s45 offen nt lds
    s_add_u32 s45, s45, 28672
    s_waitcnt vmcnt(12)
    s_mov_b32 m0, s46
    s_add_u32 s46, s46, 1024
    buffer_load_dwordx4 v18, s[12:15], s45 offen nt lds
    s_add_u32 s45, s45, 28672
    s_waitcnt vmcnt(12)
    s_add_u32 s47, s47, 1
    s_getreg_b32 s35, hwreg(HW_REG_IB_STS)
    s_bfe_u32 s48, s35, 0x20016
    s_and_b32 s35, s35, 15
    s_lshl4_add_u32 s35, s48, s35
    s_add_u32 s35, s35, 3
    s_lshr_b32 s35, s35, 2
    s_sub_u32 s35, s47, s35
    v_mov_b32 v16, s35
    s_mov_b64 exec, 1
    ds_max_i32 v7, v16
    s_mov_b64 exec, -1
    s_cmp_lt_u32 s47, 5
    s_cbranch_scc1 M_ld3
M_ld5:
    s_mov_b32 m0, s46
    s_add_u32 s46, s46, 1024
    buffer_load_dwordx4 v8, s[12:15], s45 offen nt lds
    s_add_u32 s45, s45, 28672
    s_waitcnt vmcnt(28)
    s_mov_b32 m0, s46
    s_add_u32 s46, s46, 1024
    buffer_load_dwordx4 v18, s[12:15], s45 offen nt lds
    s_add_u32 s45, s45, 28672
    s_waitcnt vmcnt(28)
    s_mov_b32 m0, s46
    s_add_u32 s46, s46, 1024
    buffer_load_dwordx4 v8, s[12:15], s45 offen nt lds
    s_add_u32 s45, s45, 28672
    s_waitcnt vmcnt(28)
    s_mov_b32 m0, s46
    s_add_u32 s46, s46, 1024
    buffer_load_dwordx4 v18, s[12:15], s45 offen nt lds
    s_add_u32 s45, s45, 28672
    s_waitcnt vmcnt(28)
    s_add_u32 s47, s47, 1
    s_getreg_b32 s35, hwreg(HW_REG_IB_STS)
    s_bfe_u32 s48, s35, 0x20016
    s_and_b32 s35, s35, 15
    s_lshl4_add_u32 s35, s48, s35
    s_add_u32 s35, s35, 3
    s_lshr_b32 s35, s35, 2
    s_sub_u32 s35, s47, s35
    v_mov_b32 v16, s35
    s_mov_b64 exec, 1
    ds_max_i32 v7, v16
    s_mov_b64 exec, -1
    s_cmp_lt_u32 s47, 8
    s_cbranch_scc1 M_ld5
    s_mov_b32 s20, s42
    s_and_b32 s21, s43, 0xffff
    s_mov_b32 s22, 7340032
    s_mov_b32 s23, 0x20000
    v_lshrrev_b32 v9, 5, v2
    v_and_b32 v10, 31, v2
    v_add_u32 v11, 0, v9
    v_lshlrev_b32 v12, 1, v11
    v_xor_b32 v12, v12, v10
    v_lshlrev_b32 v12, 4, v12
    v_lshl_add_u32 v12, v11, 11, v12
    v_add_u32 v11, 2, v9
    v_lshlrev_b32 v13, 1, v11
    v_xor_b32 v13, v13, v10
    v_lshlrev_b32 v13, 4, v13
    v_lshl_add_u32 v13, v11, 11, v13
    v_add_u32 v11, 4, v9
    v_lshlrev_b32 v14, 1, v11
    v_xor_b32 v14, v14, v10
    v_lshlrev_b32 v14, 4, v14
    v_lshl_add_u32 v14, v11, 11, v14
    v_add_u32 v11, 6, v9
    v_lshlrev_b32 v15, 1, v11
    v_xor_b32 v15, v15, v10
    v_lshlrev_b32 v15, 4, v15
    v_lshl_add_u32 v15, v11, 11, v15
    s_lshl_b32 s44, s29, 17
    s_lshl_b32 s35, s30, 9
    s_add_u32 s44, s44, s35
    s_mov_b32 s46, 34048
    s_xor_b32 s45, s34, 512
M_ld8:
    s_mov_b32 m0, s46
    s_add_u32 s46, s46, 1024
    buffer_load_dwordx4 v8, s[16:19], s45 offen nt lds
    s_add_u32 s45, s45, 28672
    s_waitcnt vmcnt(28)
    s_mov_b32 m0, s46
    s_add_u32 s46, s46, 1024
    buffer_load_dwordx4 v18, s[16:19], s45 offen nt lds
    s_add_u32 s45, s45, 28672
    s_waitcnt vmcnt(28)
    s_mov_b32 m0, s46
    s_add_u32 s46, s46, 1024
    buffer_load_dwordx4 v8, s[16:19], s45 offen nt lds
    s_add_u32 s45, s45, 28672
    s_waitcnt vmcnt(28)
    s_mov_b32 m0, s46
    s_add_u32 s46, s46, 1024
    buffer_load_dwordx4 v18, s[16:19], s45 offen nt lds
    s_add_u32 s45, s45, 28672
    s_waitcnt vmcnt(28)
    s_add_u32 s47, s47, 1
    s_getreg_b32 s35, hwreg(HW_REG_IB_STS)
    s_bfe_u32 s48, s35, 0x20016
    s_and_b32 s35, s35, 15
    s_lshl4_add_u32 s35, s48, s35
    s_add_u32 s35, s35, 3
    s_lshr_b32 s35, s35, 2
    s_sub_u32 s35, s47, s35
    v_mov_b32 v16, s35
    s_mov_b64 exec, 1
    ds_max_i32 v7, v16
    s_mov_b64 exec, -1
    s_cmp_lt_u32 s47, 16
    s_cbranch_scc1 M_ld8
    v_mov_b32 v20, 1156
    s_mov_b32 s62, 0
M_wgc:
    ds_read_b32 v21, v20
    s_waitcnt lgkmcnt(0)
    v_cmp_gt_u32 vcc, 4, v21
    s_add_u32 s62, s62, 1
    s_cbranch_vccz M_wgc_d
    s_sleep 1
    s_cmp_lt_u32 s62, 1000000
    s_cbranch_scc1 M_wgc
M_wgc_d:
    s_mov_b32 s46, 1280
M_ld16:
    s_mov_b32 m0, s46
    s_add_u32 s46, s46, 1024
    buffer_load_dwordx4 v12, s[20:23], s44 offen nt lds
    s_waitcnt vmcnt(28)
    s_mov_b32 m0, s46
    s_add_u32 s46, s46, 1024
    buffer_load_dwordx4 v13, s[20:23], s44 offen nt lds
    s_waitcnt vmcnt(28)
    s_mov_b32 m0, s46
    s_add_u32 s46, s46, 1024
    buffer_load_dwordx4 v14, s[20:23], s44 offen nt lds
    s_waitcnt vmcnt(28)
    s_mov_b32 m0, s46
    s_add_u32 s46, s46, 1024
    buffer_load_dwordx4 v15, s[20:23], s44 offen nt lds
    s_waitcnt vmcnt(28)
    s_add_u32 s44, s44, 16384
    s_add_u32 s47, s47, 1
    s_getreg_b32 s35, hwreg(HW_REG_IB_STS)
    s_bfe_u32 s48, s35, 0x20016
    s_and_b32 s35, s35, 15
    s_lshl4_add_u32 s35, s48, s35
    s_add_u32 s35, s35, 3
    s_lshr_b32 s35, s35, 2
    s_sub_u32 s35, s47, s35
    v_mov_b32 v16, s35
    s_mov_b64 exec, 1
    ds_max_i32 v7, v16
    s_mov_b64 exec, -1
    s_cmp_lt_u32 s47, 22
    s_cbranch_scc1 M_ld16
    v_mov_b32 v20, 1176
    s_mov_b32 s62, 0
M_wgd:
    ds_read_b32 v21, v20
    s_waitcnt lgkmcnt(0)
    v_cmp_gt_u32 vcc, 7, v21
    s_add_u32 s62, s62, 1
    s_cbranch_vccz M_wgd_d
    s_sleep 1
    s_cmp_lt_u32 s62, 1000000
    s_cbranch_scc1 M_wgd
M_wgd_d:
M_ld22:
    s_mov_b32 m0, s46
    s_add_u32 s46, s46, 1024
    buffer_load_dwordx4 v12, s[20:23], s44 offen nt lds
    s_waitcnt vmcnt(28)
    s_mov_b32 m0, s46
    s_add_u32 s46, s46, 1024
    buffer_load_dwordx4 v13, s[20:23], s44 offen nt lds
    s_waitcnt vmcnt(28)
    s_mov_b32 m0, s46
    s_add_u32 s46, s46, 1024
    buffer_load_dwordx4 v14, s[20:23], s44 offen nt lds
    s_waitcnt vmcnt(28)
    s_mov_b32 m0, s46
    s_add_u32 s46, s46, 1024
    buffer_load_dwordx4 v15, s[20:23], s44 offen nt lds
    s_waitcnt vmcnt(28)
    s_add_u32 s44, s44, 16384
    s_add_u32 s47, s47, 1
    s_getreg_b32 s35, hwreg(HW_REG_IB_STS)
    s_bfe_u32 s48, s35, 0x20016
    s_and_b32 s35, s35, 15
    s_lshl4_add_u32 s35, s48, s35
    s_add_u32 s35, s35, 3
    s_lshr_b32 s35, s35, 2
    s_sub_u32 s35, s47, s35
    v_mov_b32 v16, s35
    s_mov_b64 exec, 1
    ds_max_i32 v7, v16
    s_mov_b64 exec, -1
    s_cmp_lt_u32 s47, 24
    s_cbranch_scc1 M_ld22
    s_mov_b64 exec, 1
    v_mov_b32 v16, 18
    s_waitcnt vmcnt(24)
    ds_max_i32 v7, v16
    v_mov_b32 v16, 19
    s_waitcnt vmcnt(20)
    ds_max_i32 v7, v16
    v_mov_b32 v16, 20
    s_waitcnt vmcnt(16)
    ds_max_i32 v7, v16
    v_mov_b32 v16, 21
    s_waitcnt vmcnt(12)
    ds_max_i32 v7, v16
    v_mov_b32 v16, 22
    s_waitcnt vmcnt(8)
    ds_max_i32 v7, v16
    v_mov_b32 v16, 23
    s_waitcnt vmcnt(4)
    ds_max_i32 v7, v16
    v_mov_b32 v16, 24
    s_waitcnt vmcnt(0)
    ds_write_b32 v7, v16
    s_waitcnt lgkmcnt(0)
    s_barrier
    s_branch L_fin
M_comp:
    s_mov_b32 s62, 0
M_box:
    ds_read_b64 v[8:9], v7 offset:16
    s_waitcnt lgkmcnt(0)
    v_cmp_gt_u32 vcc, 7, v9
    s_add_u32 s62, s62, 1
    s_cbranch_vccz M_box_d
    s_cmp_lt_u32 s62, 1000000
    s_cbranch_scc1 M_box
M_box_d:
    v_readfirstlane_b32 s48, v8
    s_nop 0
    s_and_b32 s34, s48, 2047
    s_lshl_b32 s34, s34, 11
    s_add_u32 s34, s34, s6
    s_load_dwordx16 s[64:79], s[4:5], s34
    s_and_b32 s50, s48, 7
    s_bfe_u32 s34, s48, 0x40003
    s_lshl4_add_u32 s50, s50, s34
    s_bfe_u32 s34, s48, 0x40007
    s_lshl4_add_u32 s50, s50, s34
    s_lshl3_add_u32 s50, s50, 24576
    s_load_dwordx2 s[52:53], s[10:11], s50
    s_mov_b32 s33, s16
    s_mov_b64 s[24:25], s[10:11]
    s_mov_b32 s26, 268435456
    s_mov_b32 s27, 0x20000
    s_mov_b32 s44, 262144
    s_mov_b32 s45, s7
    v_mov_b32 v8, 1
    s_waitcnt lgkmcnt(0)
    v_writelane_b32 v11, s64, 0
    v_writelane_b32 v11, s65, 1
    v_writelane_b32 v11, s66, 4
    v_writelane_b32 v11, s67, 5
    v_writelane_b32 v11, s68, 8
    v_writelane_b32 v11, s69, 9
    v_writelane_b32 v11, s70, 12
    v_writelane_b32 v11, s71, 13
    v_writelane_b32 v11, s72, 2
    v_writelane_b32 v11, s73, 3
    v_writelane_b32 v11, s74, 6
    v_writelane_b32 v11, s75, 7
    v_writelane_b32 v11, s76, 10
    v_writelane_b32 v11, s77, 11
    v_writelane_b32 v11, s78, 14
    v_writelane_b32 v11, s79, 15
    s_mov_b64 exec, 0xffff
    ds_write_b32 v113, v11 offset:0
    s_mov_b64 exec, 1
    ds_add_u32 v7, v8 offset:8
    s_mov_b64 exec, -1
    s_mov_b32 s62, 0
M_wx:
    ds_read_b128 v[8:11], v7
    s_waitcnt lgkmcnt(0)
    v_cmp_gt_u32 vcc, 4, v10
    s_add_u32 s62, s62, 1
    s_cbranch_vccz M_wx_d
    s_cmp_lt_u32 s62, 1000000
    s_cbranch_scc1 M_wx
M_wx_d:
    ds_read_b128 v[80:83], v15 offset:0
    ds_read_b128 v[84:87], v15 offset:64
    ds_read_b128 v[88:91], v15 offset:128
    ds_read_b128 v[92:95], v15 offset:192
    v_readfirstlane_b32 s56, v8
    s_nop 0
    s_cmp_ge_u32 s56, 10
    s_cbranch_scc1 M_wu0_k
    s_mov_b32 s62, 0
M_wu0:
    ds_read_b32 v8, v7
    s_waitcnt lgkmcnt(0)
    v_cmp_gt_u32 vcc, 10, v8
    s_add_u32 s62, s62, 1
    s_cbranch_vccz M_wu0_d
    s_sleep 1
    s_cmp_lt_u32 s62, 1000000
    s_cbranch_scc1 M_wu0
M_wu0_d:
    v_readfirstlane_b32 s56, v8
M_wu0_k:
    ds_read_b64_tr_b16 v[48:49], v12 offset:34048
    ds_read_b64_tr_b16 v[50:51], v12 offset:38144
    ds_read_b64_tr_b16 v[64:65], v126 offset:34048
    ds_read_b64_tr_b16 v[66:67], v126 offset:38144
    s_waitcnt lgkmcnt(4)
    v_mfma_f32_16x16x32_bf16 v[96:99], v[80:83], v[16:19], 0
    v_mfma_f32_16x16x32_bf16 v[104:107], v[80:83], v[32:35], 0
    v_mfma_f32_16x16x32_bf16 v[96:99], v[84:87], v[20:23], v[96:99]
    v_mfma_f32_16x16x32_bf16 v[104:107], v[84:87], v[36:39], v[104:107]
    v_mfma_f32_16x16x32_bf16 v[96:99], v[88:91], v[24:27], v[96:99]
    v_mfma_f32_16x16x32_bf16 v[104:107], v[88:91], v[40:43], v[104:107]
    v_mfma_f32_16x16x32_bf16 v[96:99], v[92:95], v[28:31], v[96:99]
    v_mfma_f32_16x16x32_bf16 v[104:107], v[92:95], v[44:47], v[104:107]
    s_mov_b32 s62, 0
M_sta:
    s_cmp_eq_u32 s53, s33
    s_cbranch_scc1 M_sta_d
    s_load_dwordx2 s[52:53], s[10:11], s50 glc
    s_add_u32 s62, s62, 1
    s_cmp_lt_u32 s62, 200000
    s_waitcnt lgkmcnt(0)
    s_cbranch_scc1 M_sta
M_sta_d:
    s_lshl_b32 s54, s52, 16
    s_and_b32 s52, s52, 0xffff0000
    v_mov_b32 v124, 0x3727c5ac
    v_add_f32 v124, s52, v124
    v_cvt_pk_bf16_f32 v124, v124, v124
    v_lshlrev_b32 v124, 16, v124
    v_sqrt_f32 v124, v124
    s_nop 0
    v_cvt_pk_bf16_f32 v124, v124, v124
    v_lshlrev_b32 v124, 16, v124
    v_rcp_f32 v124, v124
    s_cmp_ge_u32 s56, 12
    s_cbranch_scc1 M_wu1_k
    s_mov_b32 s62, 0
M_wu1:
    ds_read_b32 v8, v7
    s_waitcnt lgkmcnt(0)
    v_cmp_gt_u32 vcc, 12, v8
    s_add_u32 s62, s62, 1
    s_cbranch_vccz M_wu1_d
    s_sleep 1
    s_cmp_lt_u32 s62, 1000000
    s_cbranch_scc1 M_wu1
M_wu1_d:
    v_readfirstlane_b32 s56, v8
M_wu1_k:
    ds_read_b64_tr_b16 v[52:53], v12 offset:42240
    ds_read_b64_tr_b16 v[54:55], v12 offset:46336
    ds_read_b64_tr_b16 v[68:69], v126 offset:42240
    ds_read_b64_tr_b16 v[70:71], v126 offset:46336
    s_waitcnt lgkmcnt(4)
    v_mfma_f32_16x16x32_bf16 v[100:103], v[80:83], v[48:51], 0
    v_mfma_f32_16x16x32_bf16 v[108:111], v[80:83], v[64:67], 0
    s_cmp_ge_u32 s56, 14
    s_cbranch_scc1 M_wu2_k
    s_mov_b32 s62, 0
M_wu2:
    ds_read_b32 v8, v7
    s_waitcnt lgkmcnt(0)
    v_cmp_gt_u32 vcc, 14, v8
    s_add_u32 s62, s62, 1
    s_cbranch_vccz M_wu2_d
    s_sleep 1
    s_cmp_lt_u32 s62, 1000000
    s_cbranch_scc1 M_wu2
M_wu2_d:
    v_readfirstlane_b32 s56, v8
M_wu2_k:
    ds_read_b64_tr_b16 v[56:57], v12 offset:50432
    ds_read_b64_tr_b16 v[58:59], v12 offset:54528
    ds_read_b64_tr_b16 v[72:73], v126 offset:50432
    ds_read_b64_tr_b16 v[74:75], v126 offset:54528
    s_waitcnt lgkmcnt(4)
    v_mfma_f32_16x16x32_bf16 v[100:103], v[84:87], v[52:55], v[100:103]
    v_mfma_f32_16x16x32_bf16 v[108:111], v[84:87], v[68:71], v[108:111]
    s_cmp_ge_u32 s56, 16
    s_cbranch_scc1 M_wu3_k
    s_mov_b32 s62, 0
M_wu3:
    ds_read_b32 v8, v7
    s_waitcnt lgkmcnt(0)
    v_cmp_gt_u32 vcc, 16, v8
    s_add_u32 s62, s62, 1
    s_cbranch_vccz M_wu3_d
    s_cmp_lt_u32 s62, 1000000
    s_cbranch_scc1 M_wu3
M_wu3_d:
    v_readfirstlane_b32 s56, v8
M_wu3_k:
    ds_read_b64_tr_b16 v[60:61], v12 offset:58624
    ds_read_b64_tr_b16 v[62:63], v12 offset:62720
    ds_read_b64_tr_b16 v[76:77], v126 offset:58624
    ds_read_b64_tr_b16 v[78:79], v126 offset:62720
    s_waitcnt lgkmcnt(4)
    v_mfma_f32_16x16x32_bf16 v[100:103], v[88:91], v[56:59], v[100:103]
    v_mfma_f32_16x16x32_bf16 v[108:111], v[88:91], v[72:75], v[108:111]
    s_waitcnt lgkmcnt(2)
    v_mfma_f32_16x16x32_bf16 v[100:103], v[92:95], v[60:63], v[100:103]
    s_waitcnt lgkmcnt(0)
    v_mfma_f32_16x16x32_bf16 v[108:111], v[92:95], v[76:79], v[108:111]
    v_mov_b32 v9, 1
    v_mov_b32_dpp v96, v104 quad_perm:[0,1,2,3] row_mask:0x2 bank_mask:0xf
    v_mov_b32_dpp v97, v105 quad_perm:[0,1,2,3] row_mask:0x2 bank_mask:0xf
    s_nop 2
    v_mov_b32_dpp v96, v100 quad_perm:[0,1,2,3] row_mask:0x4 bank_mask:0xf
    v_mov_b32_dpp v97, v101 quad_perm:[0,1,2,3] row_mask:0x4 bank_mask:0xf
    s_nop 0
    v_mov_b32_dpp v96, v108 quad_perm:[0,1,2,3] row_mask:0x8 bank_mask:0xf
    v_mov_b32_dpp v97, v109 quad_perm:[0,1,2,3] row_mask:0x8 bank_mask:0xf
    v_fma_f32 v96, -v97, s54, v96
    v_mul_f32 v96, v96, v124
    buffer_store_dword v96, v114, s[24:27], s44 offen sc1
    s_mov_b64 exec, 1
    ds_add_u32 v7, v9 offset:12
    s_mov_b64 exec, -1
    v_mov_b32 v8, 1152
    s_mov_b32 s62, 0
M_wd0:
    ds_read_b32 v9, v8
    s_waitcnt lgkmcnt(0)
    v_cmp_gt_u32 vcc, 20, v9
    s_add_u32 s62, s62, 1
    s_cbranch_vccz M_wd0_d
    s_sleep 1
    s_cmp_lt_u32 s62, 1000000
    s_cbranch_scc1 M_wd0
M_wd0_d:
    ds_read_b64_tr_b16 v[16:17], v120 offset:1280
    ds_read_b64_tr_b16 v[18:19], v120 offset:9472
    ds_read_b64_tr_b16 v[24:25], v121 offset:1280
    ds_read_b64_tr_b16 v[26:27], v121 offset:9472
    ds_read_b64_tr_b16 v[32:33], v122 offset:1280
    ds_read_b64_tr_b16 v[34:35], v122 offset:9472
    ds_read_b64_tr_b16 v[40:41], v123 offset:1280
    ds_read_b64_tr_b16 v[42:43], v123 offset:9472
    v_mov_b32 v8, 1152
    s_mov_b32 s62, 0
M_wd1:
    ds_read_b32 v9, v8
    s_waitcnt lgkmcnt(0)
    v_cmp_gt_u32 vcc, 24, v9
    s_add_u32 s62, s62, 1
    s_cbranch_vccz M_wd1_d
    s_cmp_lt_u32 s62, 1000000
    s_cbranch_scc1 M_wd1
M_wd1_d:
    ds_read_b64_tr_b16 v[20:21], v120 offset:17664
    ds_read_b64_tr_b16 v[22:23], v120 offset:25856
    ds_read_b64_tr_b16 v[28:29], v121 offset:17664
    ds_read_b64_tr_b16 v[30:31], v121 offset:25856
    ds_read_b64_tr_b16 v[36:37], v122 offset:17664
    ds_read_b64_tr_b16 v[38:39], v122 offset:25856
    ds_read_b64_tr_b16 v[44:45], v123 offset:17664
    s_waitcnt lgkmcnt(4)
    ds_read_b64_tr_b16 v[46:47], v123 offset:25856
    v_lshlrev_b32 v8, 2, v2
    s_waitcnt lgkmcnt(0)
    s_barrier
    ds_read_b128 v[80:83], v14 offset:1024
    ds_read_b128 v[84:87], v14 offset:1088
    s_waitcnt lgkmcnt(1)
    v_mfma_f32_16x16x32_bf16 v[48:51], v[80:83], v[16:19], 0
    v_mfma_f32_16x16x32_bf16 v[52:55], v[80:83], v[24:27], 0
    v_mfma_f32_16x16x32_bf16 v[56:59], v[80:83], v[32:35], 0
    v_mfma_f32_16x16x32_bf16 v[60:63], v[80:83], v[40:43], 0
    s_waitcnt lgkmcnt(0)
    v_mfma_f32_16x16x32_bf16 v[48:51], v[84:87], v[20:23], v[48:51]
    v_mfma_f32_16x16x32_bf16 v[52:55], v[84:87], v[28:31], v[52:55]
    v_mfma_f32_16x16x32_bf16 v[56:59], v[84:87], v[36:39], v[56:59]
    v_mfma_f32_16x16x32_bf16 v[60:63], v[84:87], v[44:47], v[60:63]
    s_nop 5
    v_mov_b32_dpp v48, v52 quad_perm:[0,1,2,3] row_mask:0x2 bank_mask:0xf
    s_nop 1
    v_mov_b32_dpp v48, v56 quad_perm:[0,1,2,3] row_mask:0x4 bank_mask:0xf
    s_nop 1
    v_mov_b32_dpp v48, v60 quad_perm:[0,1,2,3] row_mask:0x8 bank_mask:0xf
    buffer_store_dword v48, v8, s[24:27], s45 offen sc1
    s_branch L_fin
M_poller:
    s_cmp_ge_u32 s28, 64
    s_cbranch_scc1 M_nores
    s_mov_b32 s62, 0
M_pbox:
    ds_read_b64 v[8:9], v7 offset:16
    s_waitcnt lgkmcnt(0)
    v_cmp_gt_u32 vcc, 7, v9
    s_add_u32 s62, s62, 1
    s_cbranch_vccz M_pbox_d
    s_cmp_lt_u32 s62, 1000000
    s_cbranch_scc1 M_pbox
M_pbox_d:
    v_readfirstlane_b32 s48, v8
    v_mov_b32 v9, s33
    v_mov_b32 v10, 0
    s_lshr_b32 s34, s28, 5
    s_add_u32 s34, s34, s28
    s_and_b32 s34, s34, 31
    s_lshl_b32 s34, s34, 7
    s_add_u32 s34, s34, 4096
    s_mov_b64 exec, 1
    buffer_store_dwordx2 v[8:9], v10, s[24:27], s34 offen sc1
    s_mov_b64 exec, -1
M_nores:
    v_lshlrev_b32 v9, 4, v2
    v_and_b32 v12, 8, v2
    v_lshl_add_u32 v12, v12, 2, v4
    v_and_b32 v11, 3, v2
    v_lshl_add_u32 v12, v11, 3, v12
    v_and_b32 v11, 4, v2
    v_add_lshl_u32 v12, v12, v11, 1
    s_lshl_b32 s44, s29, 12
    s_add_u32 s44, s44, 262144
    s_lshl_b32 s46, s28, 7
    s_add_u32 s46, s46, 720896
    s_lshl_b32 s47, s33, 4
    s_lshr_b32 s35, s28, 3
    s_cmp_ge_u32 s35, 14
    s_cselect_b32 s34, 18, 0
    s_add_u32 s35, s35, s34
    s_and_b32 s34, s28, 7
    s_lshl_b32 s34, s34, 8
    s_add_u32 s34, s34, s35
    s_lshl2_add_u32 s55, s34, 753664
    v_lshlrev_b32 v40, 8, v2
    v_mov_b32 v41, s33
    s_and_b32 s34, s28, 0xe8
    s_lshl_b32 s34, s34, 5
    s_bfe_u32 s35, s28, 0x10004
    s_lshl3_add_u32 s34, s35, s34
    s_and_b32 s35, s28, 7
    s_add_u32 s34, s34, s35
    s_lshl2_add_u32 s54, s34, 720896
    v_and_b32 v42, 8, v2
    v_add_lshl_u32 v42, v42, v2, 7
    v_mov_b32 v14, 1172
    s_mov_b32 s62, 0
M_pu:
    ds_read_b32 v15, v14
    s_waitcnt lgkmcnt(0)
    v_cmp_gt_u32 vcc, 7, v15
    s_add_u32 s62, s62, 1
    s_cbranch_vccz M_pu_d
    s_sleep 1
    s_cmp_lt_u32 s62, 1000000
    s_cbranch_scc1 M_pu
M_pu_d:
    v_mov_b32 v14, 1152
    s_mov_b32 s62, 0
M_pv:
    ds_read_b32 v15, v14
    s_waitcnt lgkmcnt(0)
    v_cmp_gt_u32 vcc, 14, v15
    s_add_u32 s62, s62, 1
    s_cbranch_vccz M_pv_d
    s_sleep 1
    s_cmp_lt_u32 s62, 1000000
    s_cbranch_scc1 M_pv
M_pv_d:
    s_mov_b64 exec, 0xffff
    buffer_store_dword v41, v42, s[24:27], s54 offen sc1
    s_mov_b64 exec, -1
    s_mov_b32 s62, 0
M_hint:
    s_load_dwordx16 s[64:79], s[10:11], s46 glc
    s_waitcnt lgkmcnt(0)
    s_add_u32 s64, s64, s65
    s_add_u32 s64, s64, s66
    s_add_u32 s64, s64, s67
    s_add_u32 s64, s64, s68
    s_add_u32 s64, s64, s69
    s_add_u32 s64, s64, s70
    s_add_u32 s64, s64, s71
    s_add_u32 s64, s64, s72
    s_add_u32 s64, s64, s73
    s_add_u32 s64, s64, s74
    s_add_u32 s64, s64, s75
    s_add_u32 s64, s64, s76
    s_add_u32 s64, s64, s77
    s_add_u32 s64, s64, s78
    s_add_u32 s64, s64, s79
    s_cmp_eq_u32 s64, s47
    s_cbranch_scc1 M_hint_d
    s_add_u32 s62, s62, 1
    s_cmp_lt_u32 s62, 200000
    s_cbranch_scc1 M_hint
M_hint_d:
    buffer_load_dwordx4 v[16:19], v9, s[24:27], s44 offen offset:0 sc1
    buffer_load_dwordx4 v[20:23], v9, s[24:27], s44 offen offset:1024 sc1
    buffer_load_dwordx4 v[24:27], v9, s[24:27], s44 offen offset:2048 sc1
    buffer_load_dwordx4 v[28:31], v9, s[24:27], s44 offen offset:3072 sc1
    v_mov_b32 v14, 1152
    s_mov_b32 s62, 0
M_pw:
    ds_read_b32 v15, v14
    s_waitcnt lgkmcnt(0)
    v_cmp_gt_u32 vcc, 20, v15
    s_add_u32 s62, s62, 1
    s_cbranch_vccz M_pw_d
    s_cmp_lt_u32 s62, 1000000
    s_cbranch_scc1 M_pw
M_pw_d:
    s_mov_b64 exec, 0xf
    buffer_store_dword v41, v40, s[24:27], s55 offen sc1
    s_mov_b64 exec, -1
    s_mov_b32 s62, 0
    s_waitcnt vmcnt(1)
    s_branch M_ph_c
    s_mov_b32 s62, 0
M_ph:
    buffer_load_dwordx4 v[16:19], v9, s[24:27], s44 offen offset:0 sc1
    buffer_load_dwordx4 v[20:23], v9, s[24:27], s44 offen offset:1024 sc1
    buffer_load_dwordx4 v[24:27], v9, s[24:27], s44 offen offset:2048 sc1
    buffer_load_dwordx4 v[28:31], v9, s[24:27], s44 offen offset:3072 sc1
    s_waitcnt vmcnt(0)
M_ph_c:
    v_pk_add_f32 v[32:33], v[16:17], v[20:21]
    v_pk_add_f32 v[34:35], v[18:19], v[22:23]
    v_pk_add_f32 v[36:37], v[24:25], v[28:29]
    v_pk_add_f32 v[38:39], v[26:27], v[30:31]
    v_permlane16_swap_b32 v32, v33
    v_permlane16_swap_b32 v34, v35
    v_permlane16_swap_b32 v36, v37
    v_permlane16_swap_b32 v38, v39
    v_add_f32 v32, v32, v33
    v_add_f32 v34, v34, v35
    v_add_f32 v36, v36, v37
    v_add_f32 v38, v38, v39
    v_permlane32_swap_b32 v32, v34
    s_nop 0
    v_permlane32_swap_b32 v36, v38
    v_add_f32 v32, v32, v34
    v_add_f32 v36, v36, v38
    v_cmp_u_f32 vcc, v32, v36
    v_mul_f32 v33, 0xbfb8aa3b, v32
    s_cbranch_vccz M_ph_d
    v_max_u32 v34, v16, v17
    v_max3_u32 v34, v34, v18, v19
    v_max3_u32 v34, v34, v20, v21
    v_max3_u32 v34, v34, v22, v23
    v_max3_u32 v34, v34, v24, v25
    v_max3_u32 v34, v34, v26, v27
    v_max3_u32 v34, v34, v28, v29
    v_max3_u32 v34, v34, v30, v31
    v_cmp_eq_u32 vcc, -1, v34
    s_add_u32 s62, s62, 1
    s_cbranch_vccz M_ph_d
    s_cmp_lt_u32 s62, 200000
    s_cbranch_scc1 M_ph
M_ph_d:
    v_exp_f32 v33, v33
    v_mul_f32 v16, v32, v36
    v_add_f32 v33, 1.0, v33
    v_rcp_f32 v33, v33
    s_nop 0
    v_mul_f32 v16, v16, v33
    v_cvt_pk_bf16_f32 v16, v16, v16
    ds_write_b16 v12, v16 offset:1024
    s_waitcnt lgkmcnt(0)
    s_barrier
L_fin:
L_end:
    s_endpgm
.section .rodata,"a"
.p2align 6
.amdhsa_kernel recurrent_scan__spectral_fnet__moe_arch_mod__prompt_kernel
  .amdhsa_next_free_vgpr 128
  .amdhsa_next_free_sgpr 102
  .amdhsa_accum_offset 128
  .amdhsa_group_segment_fixed_size 0
  .amdhsa_kernarg_size 104
  .amdhsa_user_sgpr_count 2
  .amdhsa_user_sgpr_kernarg_segment_ptr 1
  .amdhsa_system_sgpr_workgroup_id_x 1
.end_amdhsa_kernel
```

```asm
; @launch grid=(480,1,1) block=(512,1,1) lds=67072
.amdgcn_target "amdgcn-amd-amdhsa--gfx950"
.text
.globl recurrent_scan__spectral_fnet__moe_arch_mod__prompt_kernel
.p2align 8
.type recurrent_scan__spectral_fnet__moe_arch_mod__prompt_kernel,@function
recurrent_scan__spectral_fnet__moe_arch_mod__prompt_kernel:
    s_cmp_ge_u32 s2, 480
    s_cbranch_scc1 L_end
    s_load_dwordx2 s[4:5], s[0:1], 0
    s_load_dwordx2 s[10:11], s[0:1], 96
    s_load_dwordx8 s[36:43], s[0:1], 48
    s_load_dwordx2 s[8:9], s[0:1], 80
    v_lshrrev_b32 v1, 6, v0
    v_and_b32 v2, 63, v0
    v_readfirstlane_b32 s3, v1
    v_and_b32 v3, 15, v0
    v_lshrrev_b32 v4, 4, v2
    s_cmp_ge_u32 s2, 256
    s_cbranch_scc1 M_first
    s_cmp_ge_u32 s3, 1
    s_cbranch_scc1 L_nopf
    s_getpc_b64 s[6:7]
L_pc:
    s_mov_b32 m0, 66816
    s_bfe_u32 s34, s2, 0x20003
    s_mul_i32 s34, s34, 4096
    v_lshl_add_u32 v8, v0, 7, s34
    v_min_u32 v8, L_end-L_pc, v8
    v_mov_b32 v9, s7
    v_add_co_u32 v8, vcc, s6, v8
    s_nop 1
    v_addc_co_u32 v9, vcc, 0, v9, vcc
    s_mov_b64 exec, 0xffffffff
    global_load_lds_dword v[8:9], off
    s_mov_b64 exec, -1
L_nopf:
    s_cmp_ge_u32 s2, 256
    s_cbranch_scc1 M_first
    s_and_b32 s28, s2, 7
    s_bfe_u32 s44, s2, 0x10003
    s_lshr_b32 s45, s2, 4
    s_xor_b32 s30, s45, 15
    s_lshl3_add_u32 s30, s30, s28
    s_cmp_eq_u32 s30, 0
    s_cselect_b32 s46, 1, 0
    s_cmp_eq_u32 s2, 248
    s_cselect_b32 s30, 128, s30
    s_lshl_b32 s31, s3, 8
    s_add_u32 s31, s31, s30
    s_sub_u32 s32, 0, s31
    s_and_b32 s32, s32, 2047
    s_cmp_eq_u32 s44, 0
    s_cselect_b32 s47, s31, s32
    s_cselect_b32 s48, s32, s31
    s_lshl_b32 s49, s47, 11
    s_lshl_b32 s48, s48, 11
    v_lshrrev_b32 v5, 3, v2
    v_and_b32 v5, 2, v5
    v_xor_b32 v5, v5, v2
    v_lshlrev_b32 v5, 4, v5
    s_lshl_b32 s53, s3, 12
    s_mov_b32 s14, 4194304
    s_mov_b32 s15, 0x20000
    s_mov_b32 s18, 2048
    s_mov_b32 s19, 0x20000
    s_mov_b32 m0, 41216
    s_cmp_lg_u32 s3, 0
    s_waitcnt lgkmcnt(0)
    s_mov_b64 s[12:13], s[4:5]
    s_load_dword s33, s[10:11], 0
    s_cbranch_scc1 F_nowr
    s_mov_b64 s[16:17], s[36:37]
    buffer_load_dwordx4 v5, s[16:19], 0 offen lds
    buffer_load_dwordx4 v5, s[16:19], 0 offen offset:1024 lds
F_nowr:
    s_mov_b32 m0, s53
    s_mov_b64 s[24:25], s[10:11]
    buffer_load_dwordx4 v5, s[12:15], s49 offen lds
    buffer_load_dwordx4 v5, s[12:15], s49 offen offset:1024 lds
    s_branch F_go
M_first:
    s_cmp_lg_u32 s3, 0
    s_cbranch_scc1 M_entry
    s_setprio 3
    s_lshr_b32 s29, s2, 1
    s_xor_b32 s29, s29, s2
    s_and_b32 s29, s29, 8
    s_mul_i32 s29, s29, 3
    s_xor_b32 s28, s2, s29
    s_bitset0_b32 s28, 8
    v_mul_u32_u24 v8, 7168, v4
    v_lshlrev_b32 v9, 1, v4
    v_xor_b32 v9, v9, v3
    v_lshl_add_u32 v8, v9, 4, v8
    s_and_b32 s34, s28, 7
    s_mulk_i32 s34, 3584
    s_lshr_b32 s35, s28, 3
    s_add_u32 s34, s34, s35
    s_lshl_b32 s34, s34, 8
    s_mov_b32 s14, 7340032
    s_mov_b32 s15, 0x20000
    s_movk_i32 s46, 1280
    s_mov_b32 s45, s34
    s_waitcnt lgkmcnt(0)
    s_mov_b64 s[12:13], s[38:39]
M_burst:
    s_mov_b32 m0, s46
    s_addk_i32 s46, 1024
    buffer_load_dwordx4 v8, s[12:15], s45 offen nt lds
    s_addk_i32 s45, 28672
    v_xor_b32 v8, 128, v8
    s_cmpk_lt_u32 s46, 13568
    s_cbranch_scc1 M_burst
    s_branch M_loader2
F_go:
    s_mov_b32 s26, 268435456
    s_mov_b32 s27, 0x20000
    v_lshlrev_b32 v7, 2, v0
    s_lshl_b32 s34, s2, 11
    s_add_u32 s34, s34, 262144
    v_mov_b32 v6, -1
    buffer_store_dword v6, v7, s[24:27], s34 offen sc1
    v_lshlrev_b32 v126, 4, v2
    s_and_b32 s34, s3, 1
    s_lshr_b32 s35, s3, 1
    v_lshl_add_u32 v119, s34, 3, v126
    s_cmp_eq_u32 s35, 3
    s_cbranch_scc1 F_jobr8
    s_lshl4_add_u32 s54, s44, 1
    s_cmp_eq_u32 s35, 2
    s_cselect_b32 s54, 0, s54
    s_cselect_b32 s57, 4096, 0
    s_cmp_eq_u32 s35, 1
    s_cselect_b32 s55, 0x3a800000, 0
    s_cselect_b32 s58, s46, 0
    s_cselect_b32 s57, 7168, s57
    s_cselect_b32 s55, s55, 0x3d000000
    s_lshl_b32 s34, s34, 4
    v_lshl_add_u32 v109, v4, 2, s34
    v_cvt_f32_u32 v109, v109
    v_add_u32 v119, s57, v119
F_job:
    v_add_u32 v116, s54, v3
    v_cvt_f32_u32 v116, v116
    v_mul_f32 v116, s55, v116
    v_mul_f32 v117, v116, v109
    v_cos_f32 v76, v117
    v_sin_f32 v80, v117
    v_add_f32 v117, v117, v116
    v_cos_f32 v77, v117
    v_sin_f32 v81, v117
    v_add_f32 v117, v117, v116
    v_cos_f32 v78, v117
    v_sin_f32 v82, v117
    v_add_f32 v117, v117, v116
    v_cos_f32 v79, v117
    v_sin_f32 v83, v117
    s_cmp_eq_u32 s35, 0
    s_cbranch_scc1 F_jobf1
    v_cvt_pk_f16_f32 v84, v76, v77
    v_cvt_pk_f16_f32 v85, v78, v79
    v_cvt_pk_f16_f32 v86, v80, v81
    v_cvt_pk_f16_f32 v87, v82, v83
    v_xor_b32 v88, 0x80008000, v86
    v_xor_b32 v89, 0x80008000, v87
    ds_write2st64_b64 v119, v[84:85], v[86:87] offset0:85 offset1:87
    ds_write_b64 v119, v[88:89] offset:45568
    s_cmp_eq_u32 s58, 0
    s_cbranch_scc1 F_jobd
    s_mov_b32 s58, 0
    s_xor_b32 s54, s54, 16
    v_add_u32 v119, 3072, v119
    s_branch F_job
F_jobf1:
    v_cvt_pk_bf16_f32 v84, v76, v77
    v_cvt_pk_bf16_f32 v85, v78, v79
    v_cvt_pk_bf16_f32 v86, -v80, -v81
    v_cvt_pk_bf16_f32 v87, -v82, -v83
    ds_write2st64_b64 v119, v[84:85], v[86:87] offset0:85 offset1:87
    s_branch F_jobd
F_jobr8:
    v_and_b32 v118, 7, v3
    v_cvt_f32_u32 v118, v118
    v_mul_f32 v118, 0x3e000000, v118
    v_and_b32 v117, 1, v4
    v_lshl_add_u32 v117, v117, 1, s34
    v_cvt_f32_u32 v117, v117
    v_mul_f32 v117, v117, v118
    v_add_f32 v117, v117, v117
    v_add_f32 v118, v117, v118
    v_cos_f32 v76, v117
    v_sin_f32 v77, v117
    v_cos_f32 v78, v118
    v_sin_f32 v79, v118
    v_lshrrev_b32 v116, 2, v2
    v_xor_b32 v116, v116, v2
    v_bfe_u32 v116, v116, 3, 1
    v_add_u32 v116, -1, v116
    s_lshl_b32 s34, s44, 31
    v_cvt_pk_f16_f32 v84, v76, v77
    v_cvt_pk_f16_f32 v86, -v77, v76
    v_cvt_pk_f16_f32 v85, v78, v79
    v_cvt_pk_f16_f32 v87, -v79, v78
    v_bitop3_b32 v84, v84, s34, v116 bitop3:0x28
    v_bitop3_b32 v85, v85, s34, v116 bitop3:0x28
    v_bitop3_b32 v86, v86, s34, v116 bitop3:0x28
    v_bitop3_b32 v87, v87, s34, v116 bitop3:0x28
    ds_write2st64_b64 v119, v[84:85], v[86:87] offset0:89 offset1:91
F_jobd:
    s_and_b32 s51, s47, 7
    v_mov_b32 v108, 0
    s_bfe_u32 s34, s47, 0x40003
    v_mov_b32 v109, 0
    s_lshl4_add_u32 s51, s51, s34
    v_mov_b32 v110, 0
    s_lshr_b32 s34, s47, 7
    v_mov_b32 v111, 0
    s_lshl4_add_u32 s51, s51, s34
    v_mov_b32 v7, 56832
    s_lshl3_add_u32 s51, s51, 24576
    ds_write_b128 v7, v[108:111]
    s_lshl_b32 s52, s46, 23
    v_and_b32 v96, 60, v2
    s_sub_u32 s52, 0x3e000000, s52
    v_and_b32 v97, 3, v2
    s_mov_b32 s60, 0x80000000
    v_lshl_add_u32 v96, v96, 1, v97
    s_mov_b32 s61, 0xfffff800
    v_bfe_u32 v97, v2, 4, 1
    s_mov_b32 s71, 0
    v_lshl_add_u32 v96, v97, 2, v96
    v_lshlrev_b32 v96, 3, v96
    v_xor_b32 v97, 32, v96
    v_add_u32 v92, s53, v96
    v_xor_b32 v93, 32, v92
    v_mov_b32 v68, 0x3f803f80
    v_mov_b32 v69, 0x3f803f80
    v_mov_b32 v70, 0x3f803f80
    v_mov_b32 v71, 0x3f803f80
    v_mov_b32 v125, s47
    v_mov_b32 v118, 1
    v_mov_b32 v119, 0
    s_waitcnt vmcnt(3) lgkmcnt(0)
    s_barrier
    ds_read_b64_tr_b16 v[24:25], v96 offset:41216
    ds_read_b64_tr_b16 v[26:27], v96 offset:42240
    ds_read_b64_tr_b16 v[28:29], v97 offset:41216
    ds_read_b64_tr_b16 v[30:31], v97 offset:42240
    ds_read_b128 v[32:35], v126 offset:43520
    ds_read_b128 v[36:39], v126 offset:44544
    ds_read_b128 v[40:43], v126 offset:45568
    ds_read_b128 v[44:47], v126 offset:46592
    ds_read_b128 v[48:51], v126 offset:47616
    ds_read_b128 v[52:55], v126 offset:48640
    ds_read_b128 v[56:59], v126 offset:49664
    ds_read_b128 v[60:63], v126 offset:50688
    ds_read_b128 v[64:67], v126 offset:51712
    s_mul_i32 s33, s33, 0x9e3779b1
    s_add_u32 s33, s33, 0x7f4a7c15
    s_mov_b32 s63, 0x3a800000
    v_mov_b32 v117, s33
    s_waitcnt lgkmcnt(9)
    v_mfma_f32_16x16x32_bf16 v[100:103], v[68:71], v[24:27], 0
    v_mfma_f32_16x16x32_bf16 v[100:103], v[68:71], v[28:31], v[100:103]
    s_nop 7
    v_add_f32_dpp v100, v100, v100 row_ror:8 row_mask:0xf bank_mask:0xf
    s_nop 1
    v_add_f32_dpp v100, v100, v100 row_ror:4 row_mask:0xf bank_mask:0xf
    s_nop 1
    v_add_f32_dpp v100, v100, v100 row_ror:2 row_mask:0xf bank_mask:0xf
    s_nop 1
    v_add_f32_dpp v100, v100, v100 row_ror:1 row_mask:0xf bank_mask:0xf
    s_setprio 2
    s_waitcnt vmcnt(1) lgkmcnt(0)
    s_add_u32 m0, s53, 2048
    s_nop 0
    buffer_load_dwordx4 v5, s[12:15], s48 offen lds
    buffer_load_dwordx4 v5, s[12:15], s48 offen offset:1024 lds
    ds_read_b64_tr_b16 v[8:9], v92 offset:0
    ds_read_b64_tr_b16 v[10:11], v92 offset:1024
    ds_read_b64_tr_b16 v[12:13], v93 offset:0
    ds_read_b64_tr_b16 v[14:15], v93 offset:1024
    s_waitcnt lgkmcnt(2)
    v_mfma_f32_16x16x32_bf16 v[104:107], v[68:71], v[8:11], 0
    v_dot2_f32_bf16 v110, v8, v24, v110
    v_dot2_f32_bf16 v108, v8, v8, v108
    v_dot2_f32_bf16 v110, v9, v25, v110
    v_dot2_f32_bf16 v108, v9, v9, v108
    v_dot2_f32_bf16 v110, v10, v26, v110
    v_dot2_f32_bf16 v108, v10, v10, v108
    v_dot2_f32_bf16 v110, v11, v27, v110
    v_dot2_f32_bf16 v108, v11, v11, v108
    s_waitcnt lgkmcnt(0)
    v_mfma_f32_16x16x32_bf16 v[104:107], v[68:71], v[12:15], v[104:107]
    v_dot2_f32_bf16 v110, v12, v28, v110
    v_dot2_f32_bf16 v108, v12, v12, v108
    v_dot2_f32_bf16 v110, v13, v29, v110
    v_dot2_f32_bf16 v108, v13, v13, v108
    v_dot2_f32_bf16 v110, v14, v30, v110
    v_dot2_f32_bf16 v108, v14, v14, v108
    v_dot2_f32_bf16 v110, v15, v31, v110
    v_dot2_f32_bf16 v108, v15, v15, v108
    v_add_f32_dpp v104, v104, v104 row_ror:8 row_mask:0xf bank_mask:0xf
    s_nop 1
    v_permlane32_swap_b32 v108, v110
    v_add_f32_dpp v104, v104, v104 row_ror:4 row_mask:0xf bank_mask:0xf
    v_add_f32 v108, v108, v110
    s_nop 0
    v_add_f32_dpp v104, v104, v104 row_ror:2 row_mask:0xf bank_mask:0xf
    v_add_f32_dpp v108, v108, v108 row_ror:8 row_mask:0xf bank_mask:0xf
    s_nop 0
    v_add_f32_dpp v104, v104, v104 row_ror:1 row_mask:0xf bank_mask:0xf
    v_add_f32_dpp v108, v108, v108 row_ror:4 row_mask:0xf bank_mask:0xf
    v_mul_f32 v112, 0x3a800000, v104
    s_nop 0
    v_add_f32_dpp v108, v108, v108 row_ror:2 row_mask:0xf bank_mask:0xf
    v_mul_f32 v113, -v112, v112
    s_nop 0
    v_add_f32_dpp v108, v108, v108 row_ror:1 row_mask:0xf bank_mask:0xf
    v_mul_f32 v110, v112, v100
    s_nop 0
    v_add_f32_dpp v108, v108, v108 row_bcast:15 row_mask:0xa bank_mask:0xf
    s_nop 0
    v_readlane_b32 s34, v108, 48
    v_fmamk_f32 v108, v108, 0x3a800000, v113
    v_max_f32 v108, 0, v108
    v_add_f32 v111, 0x3727c5ac, v108
    v_rsq_f32 v111, v111
    v_sub_f32 v110, s34, v110
    v_mul_f32 v110, v110, v111
    v_ashrrev_i32 v115, 31, v110
    v_bitop3_b32 v115, v110, v115, s60 bitop3:0x1e
    v_and_or_b32 v115, v115, s61, v125
    s_mov_b64 exec, 0x10000
    s_waitcnt vmcnt(2)
    ds_max_u32 v7, v115
    ds_add_rtn_u32 v118, v7, v118 offset:8
    v_cvt_pk_bf16_f32 v116, v112, v108
    buffer_store_dwordx2 v[116:117], v119, s[24:27], s51 offen sc1
    s_mov_b64 exec, -1
    ds_read_b32 v114, v7
    v_mul_f32 v111, s52, v111
    v_mul_f32 v113, v112, v111
    v_readlane_b32 s54, v111, 16
    v_readlane_b32 s70, v113, 16
    v_mfma_f32_16x16x32_bf16 v[76:79], v[8:11], v[32:35], 0
    v_mfma_f32_16x16x32_bf16 v[80:83], v[12:15], v[32:35], 0
    v_mfma_f32_16x16x32_bf16 v[84:87], v[8:11], v[36:39], 0
    v_mfma_f32_16x16x32_bf16 v[88:91], v[12:15], v[36:39], 0
    s_waitcnt lgkmcnt(0)
    v_readlane_b32 s34, v118, 16
    s_nop 0
    s_cmp_lg_u32 s34, 7
    s_cbranch_scc0 F_key
F_nokey:
    s_setprio 0
    s_lshr_b32 s58, s3, 2
    v_xor_b32 v94, 0x3d8, v92
    s_lshl4_add_u32 s58, s3, s58
    v_xor_b32 v95, 0x3f8, v92
    s_lshl_b32 s58, s58, 6
    v_and_b32 v72, 0x3d8, v96
    s_and_b32 s59, s3, 3
    v_sub_u32 v72, 1024, v72
    s_lshl3_add_u32 s59, s3, s59
    v_add_u32 v73, -32, v72
    s_lshl_b32 s59, s59, 2
    v_lshrrev_b32 v74, 3, v72
    s_and_b32 s34, s30, 15
    v_lshrrev_b32 v75, 3, v73
    s_sub_u32 s35, 16, s34
    v_bitop3_b32 v72, v72, v74, 32 bitop3:0x78
    s_and_b32 s50, s34, 7
    v_bitop3_b32 v73, v73, v75, 32 bitop3:0x78
    s_cmp_gt_u32 s34, 8
    v_add_u32 v72, s53, v72
    s_cselect_b32 s50, s35, s50
    v_add_u32 v73, s53, v73
    s_and_b32 s34, s34, 8
    v_xor_b32 v74, 1024, v72
    s_lshl4_add_u32 s50, s50, s34
    v_bfe_u32 v120, v3, 1, 2
    s_lshr_b32 s34, s30, 4
    v_xor_b32 v120, v120, v4
    s_add_u32 s50, s50, s34
    v_lshl_add_u32 v120, v3, 2, v120
    s_cmp_eq_u32 s30, 128
    v_lshl_add_u32 v120, v120, 4, s58
    s_cselect_b32 s50, 128, s50
    v_xor_b32 v121, s59, v3
    s_lshl1_add_u32 s29, s50, s44
    v_lshrrev_b32 v16, 1, v4
    s_mul_i32 s50, s29, 8320
    v_lshl_add_u32 v121, v16, 4, v121
    s_lshl_b32 s34, s3, 10
    v_and_b32 v16, 1, v4
    s_add_u32 s50, s50, s34
    v_mul_u32_u24 v16, 1040, v16
    s_add_u32 s50, s50, 1048576
    v_add_lshl_u32 v121, v121, v16, 2
    s_and_b32 s29, s29, 255
    v_and_b32 v17, 7, v3
    s_lshl2_add_u32 s29, s29, 40960
    v_lshrrev_b32 v16, 3, v3
    s_cmp_eq_u32 s44, 0
    v_mul_u32_u24 v122, 128, v17
    s_cselect_b32 s35, 0, 0xc2000000
    v_lshl_add_u32 v122, v16, 6, v122
    v_lshl_add_u32 v122, v4, 4, v122
    v_add_u32 v124, 1, v3
    v_bfe_i32 v124, v124, 4, 1
    v_and_b32 v124, s35, v124
    s_cmp_lg_u32 s71, 0
    s_cbranch_scc1 F_wkey
    s_waitcnt vmcnt(1)
F_wkey_r:
    ds_read_b64_tr_b16 v[24:25], v94 offset:3072
    ds_read_b64_tr_b16 v[26:27], v94 offset:2048
    ds_read_b64_tr_b16 v[28:29], v95 offset:3072
    ds_read_b64_tr_b16 v[30:31], v95 offset:2048
    ds_read_b64_tr_b16 v[16:17], v74 offset:2048
    ds_read_b64_tr_b16 v[18:19], v72 offset:2048
    ds_read_b64_tr_b16 v[20:21], v73 offset:3072
    ds_read_b64_tr_b16 v[22:23], v73 offset:2048
    s_waitcnt lgkmcnt(6)
    v_mfma_f32_16x16x32_bf16 v[104:107], v[68:71], v[24:27], 0
    v_dot2_f32_bf16 v109, v24, v24, v109
    v_dot2_f32_bf16 v109, v25, v25, v109
    v_dot2_f32_bf16 v109, v26, v26, v109
    v_dot2_f32_bf16 v109, v27, v27, v109
    s_waitcnt lgkmcnt(4)
    v_mfma_f32_16x16x32_bf16 v[104:107], v[68:71], v[28:31], v[104:107]
    v_dot2_f32_bf16 v109, v28, v28, v109
    v_dot2_f32_bf16 v109, v29, v29, v109
    v_dot2_f32_bf16 v109, v30, v30, v109
    v_dot2_f32_bf16 v109, v31, v31, v109
    s_mov_b32 exec_lo, 0xeeeeeeee
    s_mov_b32 exec_hi, 0xeeeeeeee
    s_waitcnt lgkmcnt(0)
    v_mov_b32_dpp v16, v24 quad_perm:[0,3,2,1] row_mask:0xf bank_mask:0xf
    v_mov_b32_dpp v17, v25 quad_perm:[0,3,2,1] row_mask:0xf bank_mask:0xf
    v_mov_b32_dpp v18, v26 quad_perm:[0,3,2,1] row_mask:0xf bank_mask:0xf
    v_mov_b32_dpp v19, v27 quad_perm:[0,3,2,1] row_mask:0xf bank_mask:0xf
    v_mov_b32_dpp v20, v28 quad_perm:[0,3,2,1] row_mask:0xf bank_mask:0xf
    v_mov_b32_dpp v21, v29 quad_perm:[0,3,2,1] row_mask:0xf bank_mask:0xf
    v_mov_b32_dpp v22, v30 quad_perm:[0,3,2,1] row_mask:0xf bank_mask:0xf
    v_mov_b32_dpp v23, v31 quad_perm:[0,3,2,1] row_mask:0xf bank_mask:0xf
    s_mov_b64 exec, -1
    v_add_f32_dpp v112, v104, v104 row_ror:8 row_mask:0xf bank_mask:0xf
    v_add_f32_dpp v109, v109, v109 row_ror:8 row_mask:0xf bank_mask:0xf
    v_mfma_f32_16x16x32_bf16 v[92:95], v[16:19], v[32:35], 0
    v_add_f32_dpp v112, v112, v112 row_ror:4 row_mask:0xf bank_mask:0xf
    v_add_f32_dpp v109, v109, v109 row_ror:4 row_mask:0xf bank_mask:0xf
    v_mfma_f32_16x16x32_bf16 v[96:99], v[20:23], v[32:35], 0
    v_add_f32_dpp v112, v112, v112 row_ror:2 row_mask:0xf bank_mask:0xf
    v_add_f32_dpp v109, v109, v109 row_ror:2 row_mask:0xf bank_mask:0xf
    v_mfma_f32_16x16x32_bf16 v[100:103], v[16:19], v[36:39], 0
    v_add_f32_dpp v112, v112, v112 row_ror:1 row_mask:0xf bank_mask:0xf
    v_add_f32_dpp v109, v109, v109 row_ror:1 row_mask:0xf bank_mask:0xf
    v_mfma_f32_16x16x32_bf16 v[104:107], v[20:23], v[36:39], 0
    v_mul_f32 v112, 0x3a800000, v112
    v_add_f32_dpp v109, v109, v109 row_bcast:15 row_mask:0xa bank_mask:0xf
    v_fmaak_f32 v113, v112, v112, 0xb727c5ac
    v_mul_f32 v116, s70, v124
    v_add_f32_dpp v109, v109, v109 row_bcast:31 row_mask:0xc bank_mask:0xf
    v_fma_f32 v109, v109, s63, -v113
    v_max_f32 v109, 0x3727c5ac, v109
    v_rsq_f32 v109, v109
    v_pk_mul_f32 v[84:85], v[84:85], s[54:55] op_sel:[0,0] op_sel_hi:[1,0]
    v_mul_f32 v109, s52, v109
    v_pk_mul_f32 v[86:87], v[86:87], s[54:55] op_sel:[0,0] op_sel_hi:[1,0]
    v_readlane_b32 s55, v109, 48
    s_nop 1
    v_pk_mul_f32 v[88:89], v[88:89], s[54:55] op_sel:[0,0] op_sel_hi:[1,0]
    v_pk_mul_f32 v[90:91], v[90:91], s[54:55] op_sel:[0,0] op_sel_hi:[1,0]
    v_mul_f32 v112, s55, v112
    v_fmac_f32 v116, v112, v124
F_pass:
    v_pk_fma_f32 v[76:77], v[76:77], s[54:55], v[116:117] op_sel:[0,0,0] op_sel_hi:[1,0,0]
    v_pk_fma_f32 v[78:79], v[78:79], s[54:55], v[116:117] op_sel:[0,0,0] op_sel_hi:[1,0,0]
    v_pk_fma_f32 v[80:81], v[80:81], s[54:55], v[116:117] op_sel:[0,0,0] op_sel_hi:[1,0,0]
    v_pk_fma_f32 v[82:83], v[82:83], s[54:55], v[116:117] op_sel:[0,0,0] op_sel_hi:[1,0,0]
    v_pk_fma_f32 v[76:77], v[92:93], s[54:55], v[76:77] op_sel:[0,1,0] op_sel_hi:[1,1,1]
    v_pk_fma_f32 v[78:79], v[94:95], s[54:55], v[78:79] op_sel:[0,1,0] op_sel_hi:[1,1,1]
    v_pk_fma_f32 v[80:81], v[96:97], s[54:55], v[80:81] op_sel:[0,1,0] op_sel_hi:[1,1,1]
    v_pk_fma_f32 v[82:83], v[98:99], s[54:55], v[82:83] op_sel:[0,1,0] op_sel_hi:[1,1,1]
    v_pk_fma_f32 v[84:85], v[100:101], s[54:55], v[84:85] op_sel:[0,1,0] op_sel_hi:[1,1,1]
    v_pk_fma_f32 v[86:87], v[102:103], s[54:55], v[86:87] op_sel:[0,1,0] op_sel_hi:[1,1,1]
    v_pk_fma_f32 v[88:89], v[104:105], s[54:55], v[88:89] op_sel:[0,1,0] op_sel_hi:[1,1,1]
    v_pk_fma_f32 v[90:91], v[106:107], s[54:55], v[90:91] op_sel:[0,1,0] op_sel_hi:[1,1,1]
    v_cvt_pk_f16_f32 v24, v76, v77
    v_cvt_pk_f16_f32 v25, v78, v79
    v_cvt_pk_f16_f32 v26, v80, v81
    v_cvt_pk_f16_f32 v27, v82, v83
    v_cvt_pk_f16_f32 v28, v84, v85
    v_cvt_pk_f16_f32 v29, v86, v87
    v_cvt_pk_f16_f32 v30, v88, v89
    v_cvt_pk_f16_f32 v31, v90, v91
    v_pk_mul_f16 v68, v24, v60
    v_pk_mul_f16 v69, v25, v61
    v_pk_mul_f16 v70, v26, v62
    v_pk_mul_f16 v71, v27, v63
    v_pk_fma_f16 v68, v28, v64, v68
    v_pk_fma_f16 v69, v29, v65, v69
    v_pk_fma_f16 v70, v30, v66, v70
    v_pk_fma_f16 v71, v31, v67, v71
    v_pk_mul_f16 v72, v28, v60
    v_pk_mul_f16 v73, v29, v61
    v_pk_mul_f16 v74, v30, v62
    v_pk_mul_f16 v75, v31, v63
    v_mfma_f32_16x16x32_f16 v[92:95], v[68:71], v[48:51], 0
    v_mfma_f32_16x16x32_f16 v[96:99], v[68:71], v[56:59], 0
    v_pk_fma_f16 v72, v24, v64, v72 neg_lo:[1,0,0] neg_hi:[1,0,0]
    v_pk_fma_f16 v73, v25, v65, v73 neg_lo:[1,0,0] neg_hi:[1,0,0]
    v_pk_fma_f16 v74, v26, v66, v74 neg_lo:[1,0,0] neg_hi:[1,0,0]
    v_pk_fma_f16 v75, v27, v67, v75 neg_lo:[1,0,0] neg_hi:[1,0,0]
    s_nop 1
    v_mfma_f32_16x16x32_f16 v[92:95], v[72:75], v[52:55], v[92:95]
    v_mfma_f32_16x16x32_f16 v[96:99], v[72:75], v[48:51], v[96:99]
    s_nop 7
    v_cvt_pk_f16_f32 v24, v92, v96
    v_cvt_pk_f16_f32 v25, v93, v97
    v_cvt_pk_f16_f32 v26, v94, v98
    v_cvt_pk_f16_f32 v27, v95, v99
    ds_write_b128 v120, v[24:27] offset:32768
    s_waitcnt lgkmcnt(0)
    s_barrier
    ds_read2st64_b32 v[28:29], v121 offset0:128 offset1:132
    ds_read2st64_b32 v[30:31], v121 offset0:136 offset1:140
    s_waitcnt lgkmcnt(0)
    v_mfma_f32_16x16x32_f16 v[100:103], v[28:31], v[40:43], 0
    v_mfma_f32_16x16x32_f16 v[104:107], v[28:31], v[44:47], 0
    s_nop 7
    v_cvt_pk_f16_f32 v68, v100, v104
    v_cvt_pk_f16_f32 v69, v101, v105
    v_cvt_pk_f16_f32 v70, v102, v106
    v_cvt_pk_f16_f32 v71, v103, v107
    buffer_store_dwordx4 v[68:71], v122, s[24:27], s50 offen sc1
    s_cmp_lg_u32 s46, 0
    s_cbranch_scc1 F_second
    s_mov_b32 s34, 0x71605432
    v_bfe_u32 v6, v2, 2, 2
    s_mov_b32 s35, 0x98fedcba
    v_lshl_add_u32 v6, v6, 2, v4
    s_lshl_b32 s56, s45, 2
    v_and_b32 v1, 3, v2
    s_lshr_b64 s[34:35], s[34:35], s56
    v_lshlrev_b32 v1, 4, v1
    s_and_b32 s34, s34, 15
    v_lshl_add_u32 v6, v6, 18, v1
    s_xor_b32 s45, s45, 8
    v_lshrrev_b32 v108, 3, v3
    s_cmp_eq_u32 s44, 0
    v_and_b32 v109, 7, v3
    s_cselect_b32 s45, s45, s34
    v_lshlrev_b32 v123, 14, v108
    s_sub_u32 s34, 0, s28
    v_lshl_add_u32 v123, v4, 20, v123
    s_and_b32 s34, s34, 7
    v_lshl_add_u32 v123, v109, 3, v123
    s_lshr_b32 s35, s45, 1
    s_cmp_lt_u32 s35, s44
    s_cselect_b32 s28, s34, s28
    s_sub_u32 s34, 0, s28
    s_and_b32 s34, s34, 7
    s_sub_u32 s35, 31, s45
    s_cmp_eq_u32 s44, 0
    s_cselect_b32 s56, s28, s34
    s_cselect_b32 s57, s45, s35
    s_lshl4_add_u32 s64, s3, s56
    s_lshl_b32 s64, s64, 11
    s_lshl_b32 s34, s57, 6
    s_add_u32 s64, s64, s34
    s_add_u32 s65, s64, 262144
    s_add_u32 s66, s64, 524288
    s_add_u32 s67, s64, 786432
    s_mov_b64 s[20:21], s[8:9]
    s_mov_b32 s22, 4194304
    s_mov_b32 s23, 0x20000
    s_mov_b32 s16, 0
    s_lshr_b32 s34, s57, 1
    s_lshl4_add_u32 s34, s56, s34
    s_cmp_eq_u32 s34, 63
    s_cselect_b32 s46, 3, 0
    s_lshr_b32 s34, s3, 1
    s_lshl2_add_u32 s34, s46, s34
    s_cmp_lg_u32 s34, 0
    s_cbranch_scc1 F_xp0
    s_mov_b32 m0, s53
    s_add_u32 s35, s64, 16384
    buffer_load_dwordx4 v6, s[12:15], s64 offen lds
    s_add_u32 m0, s53, 1152
    s_add_u32 s35, s64, 16384
    buffer_load_dwordx4 v6, s[12:15], s35 offen lds
F_xp0:
    v_and_b32 v110, 31, v2
    v_lshrrev_b32 v111, 5, v2
    s_lshl_b32 s61, s44, 31
    s_xor_b32 s60, s61, 0x3a000000
    v_lshrrev_b32 v112, 1, v110
    v_lshl_add_u32 v112, v112, 3, s56
    v_cvt_f32_u32 v112, v112
    v_mul_f32 v112, s60, v112
    v_and_b32 v113, 1, v110
    v_cvt_f32_u32 v114, v113
    s_sub_u32 s58, 16, s3
    s_cmp_eq_u32 s3, 0
    s_cselect_b32 s34, 0, 0x3e800000
    s_cselect_b32 s35, 0, -1
    s_cselect_b32 s58, 8, s58
    v_mul_f32 v114, s34, v114
    v_mul_f32 v117, 0x42000000, v112
    v_lshl_add_u32 v116, v111, 4, s3
    v_cvt_f32_u32 v116, v116
    v_fma_f32 v116, v116, v112, v114
    v_cos_f32 v108, v116
    v_sin_f32 v109, v116
    v_add_f32 v116, v116, v117
    v_cvt_pk_f16_f32 v32, v108, v109
    v_cos_f32 v108, v116
    v_sin_f32 v109, v116
    v_add_f32 v116, v116, v117
    v_cvt_pk_f16_f32 v33, v108, v109
    v_cos_f32 v108, v116
    v_sin_f32 v109, v116
    v_add_f32 v116, v116, v117
    v_cvt_pk_f16_f32 v34, v108, v109
    v_cos_f32 v108, v116
    v_sin_f32 v109, v116
    v_add_f32 v116, v116, v117
    v_cvt_pk_f16_f32 v35, v108, v109
    v_mov_b32 v48, s33
    v_lshlrev_b32 v49, 10, v2
    s_lshl2_add_u32 s34, s46, s3
    s_cmp_ge_u32 s34, 4
    s_cbranch_scc1 F_x5a
    s_lshr_b32 s34, s3, 1
    s_lshl2_add_u32 s34, s46, s34
    s_cmp_lg_u32 s34, 1
    s_cbranch_scc1 F_xp1
    s_mov_b32 m0, s53
    s_add_u32 s35, s64, 16384
    buffer_load_dwordx4 v6, s[12:15], s64 offen lds
    s_add_u32 m0, s53, 1152
    s_add_u32 s35, s64, 16384
    buffer_load_dwordx4 v6, s[12:15], s35 offen lds
F_xp1:
    s_waitcnt vmcnt(2)
    s_branch F_x5b
F_x5a:
    s_waitcnt vmcnt(0)
F_x5b:
    s_cmp_lg_u32 s3, 7
    s_barrier
    s_cbranch_scc1 F_noflag
    s_mov_b32 exec_lo, 0xffffffff
    s_mov_b32 exec_hi, 0
    buffer_store_dword v48, v49, s[24:27], s29 offen sc1
    s_mov_b64 exec, -1
F_noflag:
    s_lshr_b32 s34, s3, s46
    s_cmp_lt_u32 s34, 4
    s_cbranch_scc1 F_x5c
    s_lshr_b32 s34, s3, 1
    s_lshl2_add_u32 s34, s46, s34
    s_cmp_lg_u32 s34, 2
    s_cbranch_scc1 F_xp2
    s_mov_b32 m0, s53
    s_add_u32 s35, s64, 16384
    buffer_load_dwordx4 v6, s[12:15], s64 offen lds
    s_add_u32 m0, s53, 1152
    s_add_u32 s35, s64, 16384
    buffer_load_dwordx4 v6, s[12:15], s35 offen lds
F_xp2:
F_x5c:
    v_lshrrev_b32 v118, 3, v3
    v_lshlrev_b32 v124, 7, v118
    v_lshl_add_u32 v124, v4, 5, v124
    s_lshl3_add_u32 s59, s56, s3
    s_lshl_b32 s59, s59, 8
    s_add_u32 s59, s59, 24576
    s_mov_b32 s62, 0
F_stats:
    buffer_load_dwordx4 v[24:27], v124, s[24:27], s59 offen sc1
    buffer_load_dwordx4 v[28:31], v124, s[24:27], s59 offen offset:16 sc1
    s_cmp_lg_u32 s62, 0
    s_cbranch_scc1 F_stats_w
F_stats_i:
    v_lshl_add_u32 v116, v111, 4, s58
    v_cvt_f32_u32 v116, v116
    v_fma_f32 v116, v116, v112, -v114
    v_cos_f32 v108, v116
    v_sin_f32 v109, v116
    v_add_f32 v116, v116, v117
    v_cvt_pk_f16_f32 v36, v108, v109
    v_cos_f32 v108, v116
    v_sin_f32 v109, v116
    v_add_f32 v116, v116, v117
    v_cvt_pk_f16_f32 v37, v108, v109
    v_cos_f32 v108, v116
    v_sin_f32 v109, v116
    v_add_f32 v116, v116, v117
    v_cvt_pk_f16_f32 v38, v108, v109
    v_cos_f32 v108, v116
    v_sin_f32 v109, v116
    v_add_f32 v116, v116, v117
    v_cvt_pk_f16_f32 v39, v108, v109
    s_cmp_lg_u32 s3, 0
    s_cbranch_scc1 F_now0
    v_mul_f32 v116, 0x43000000, v112
    v_cos_f32 v108, v116
    v_sin_f32 v109, v116
    v_add_u32 v115, -1, v113
    v_and_b32 v32, v32, v115
    v_bfi_b32 v36, v115, 0, v36
    v_and_b32 v33, v33, v115
    v_bfi_b32 v37, v115, 0, v37
    v_and_b32 v34, v34, v115
    v_bfi_b32 v38, v115, 0, v38
    v_and_b32 v35, v35, v115
    v_bfi_b32 v39, v115, 0, v39
    v_or_b32 v115, v113, v111
    v_add_u32 v115, -1, v115
    v_cvt_pk_f16_f32 v40, v108, v109
    v_and_b32 v40, v40, v115
    v_mov_b32 v41, 0
    v_mov_b32 v57, 0
    v_mov_b32 v42, 0
    v_mov_b32 v58, 0
    v_mov_b32 v43, 0
    v_mov_b32 v59, 0
F_now0:
    s_lshr_b32 s34, s3, 1
    s_lshl2_add_u32 s34, s46, s34
    s_cmp_lg_u32 s34, 3
    s_cbranch_scc1 F_xp3
    s_mov_b32 m0, s53
    s_add_u32 s35, s64, 16384
    buffer_load_dwordx4 v6, s[12:15], s64 offen lds
    s_add_u32 m0, s53, 1152
    s_add_u32 s35, s64, 16384
    buffer_load_dwordx4 v6, s[12:15], s35 offen lds
F_xp3:
    s_xor_b32 s60, s61, 0x3d800000
    v_cvt_f32_u32 v117, v3
    v_mul_f32 v117, s60, v117
    v_lshlrev_b32 v116, 1, v4
    v_cvt_f32_u32 v116, v116
    v_mul_f32 v116, v116, v117
    v_add_f32 v117, v116, v117
    v_cos_f32 v108, v116
    v_sin_f32 v109, v116
    v_cos_f32 v114, v117
    v_sin_f32 v115, v117
    v_cvt_pk_f16_f32 v44, v108, v109
    s_mov_b32 s34, 0x3c003c00
    v_cvt_pk_f16_f32 v45, v114, v115
    s_mov_b64 exec, 0xffff
    v_lshl_or_b32 v44, v3, 31, s34
    s_mov_b64 exec, -1
    v_lshl_add_u32 v122, s3, 1, v118
    v_mul_u32_u24 v122, 1280, v122
    v_mul_u32_u24 v108, 272, v4
    v_and_b32 v109, 7, v3
    v_lshlrev_b32 v109, 5, v109
    v_add3_u32 v122, v122, v108, v109
    s_lshr_b32 s34, s3, 1
    s_mul_i32 s34, s34, 272
    s_and_b32 s35, s3, 1
    s_lshl2_add_u32 s34, s35, s34
    v_mul_u32_u24 v121, 2560, v111
    v_lshl_add_u32 v121, v110, 3, v121
    v_add_u32 v121, s34, v121
    s_cmp_eq_u32 s44, 0
    s_cselect_b32 s34, 0, 31
    s_cselect_b32 s35, -1, 0
    s_lshl_b32 s60, s45, 5
    s_add_u32 s35, s35, s60
    v_xor_b32 v108, s34, v110
    v_add_u32 v108, s35, v108
    v_max_i32 v108, 0, v108
    v_bfe_u32 v125, v108, 4, 1
    v_mul_u32_u24 v125, 8320, v125
    v_lshrrev_b32 v109, 6, v108
    v_lshl_add_u32 v125, v109, 10, v125
    v_bfe_u32 v109, v108, 5, 1
    v_lshl_add_u32 v125, v109, 6, v125
    v_and_b32 v108, 15, v108
    v_lshl_add_u32 v125, v108, 2, v125
    v_mul_u32_u24 v120, 16640, v111
    v_add_u32 v120, v120, v125
    s_lshl_b32 s58, s28, 7
    s_add_u32 s58, s58, 1048576
    s_add_u32 s60, s58, 2129920
    s_mul_i32 s34, s3, 266240
    s_add_u32 s58, s58, s34
    s_lshl4_add_u32 s47, s3, s56
    s_lshl_b32 s48, s57, 7
    s_add_u32 s49, s48, 491520
    s_lshl1_add_u32 s48, s48, 753664
    s_add_u32 s52, s48, 128
    s_and_b32 s34, s2, 31
    s_lshl3_add_u32 s34, s34, s3
    s_lshl_b32 s34, s34, 7
    s_add_u32 s34, s34, 40960
    s_add_u32 s42, s10, s34
    s_addc_u32 s43, s11, 0
    s_mov_b32 s40, s33
    s_mov_b32 s41, s33
    s_and_b32 s63, s2, 31
    s_lshl_b32 s63, s63, 7
    s_add_u32 s63, s63, 4096
    v_mul_u32_u24 v108, 1152, v118
    v_lshl_add_u32 v108, v4, 6, v108
    v_and_b32 v109, 7, v3
    v_lshlrev_b32 v109, 3, v109
    v_add3_u32 v108, v108, v109, s53
    s_cmp_eq_u32 s46, 3
    s_cbranch_scc1 F_poll
    s_waitcnt vmcnt(0)
F_xt:
    ds_read_b64 v[8:9], v108 offset:0
    ds_read_b64 v[10:11], v108 offset:256
    ds_read_b64 v[12:13], v108 offset:512
    ds_read_b64 v[14:15], v108 offset:768
    s_waitcnt lgkmcnt(3)
    v_lshlrev_b32 v60, 16, v8
    v_and_b32 v64, 0xffff0000, v8
    v_lshlrev_b32 v68, 16, v9
    v_and_b32 v72, 0xffff0000, v9
    s_waitcnt lgkmcnt(2)
    v_lshlrev_b32 v61, 16, v10
    v_and_b32 v65, 0xffff0000, v10
    v_lshlrev_b32 v69, 16, v11
    v_and_b32 v73, 0xffff0000, v11
    s_waitcnt lgkmcnt(1)
    v_lshlrev_b32 v62, 16, v12
    v_and_b32 v66, 0xffff0000, v12
    v_lshlrev_b32 v70, 16, v13
    v_and_b32 v74, 0xffff0000, v13
    s_waitcnt lgkmcnt(0)
    v_lshlrev_b32 v63, 16, v14
    v_and_b32 v67, 0xffff0000, v14
    v_lshlrev_b32 v71, 16, v15
    v_and_b32 v75, 0xffff0000, v15
F_stats_w:
    s_waitcnt vmcnt(0)
F_stats_c:
    v_xor_b32 v108, s33, v25
    v_xor_b32 v109, s33, v27
    v_xor_b32 v110, s33, v29
    v_xor_b32 v111, s33, v31
    v_or3_b32 v108, v108, v109, v110
    v_or_b32 v108, v108, v111
    v_cmp_ne_u32 vcc, 0, v108
    s_add_u32 s62, s62, 1
    s_cbranch_vccz F_stats_d
    s_sleep 4
    s_cmp_lt_u32 s62, 200000
    s_cbranch_scc1 F_stats
F_stats_d:
    s_cmp_lt_u32 s2, 224
    s_cbranch_scc1 F_npf2
    s_cmp_gt_u32 s3, 1
    s_cbranch_scc1 F_npf2
    s_getpc_b64 s[6:7]
L_pc2:
    s_mov_b32 m0, 66816
    v_lshlrev_b32 v110, 7, v0
    v_min_u32 v110, L_end-L_pc2, v110
    v_mov_b32 v111, s7
    v_add_co_u32 v110, vcc, s6, v110
    s_nop 1
    v_addc_co_u32 v111, vcc, 0, v111, vcc
    global_load_lds_dword v[110:111], off sc1
F_npf2:
    s_cmp_eq_u32 s46, 2
    s_cbranch_scc1 F_npre
    s_load_dwordx16 s[68:83], s[42:43], 0 glc
    s_load_dwordx16 s[84:99], s[42:43], 64 glc
F_npre:
    s_mov_b32 s34, 0xbe38aa3b
    v_mov_b32 v108, 0x3427c5ac
    v_and_b32 v16, 0xffff0000, v24
    v_fmamk_f32 v16, v16, 0x3c800000, v108
    v_and_b32 v17, 0xffff0000, v26
    v_fmamk_f32 v17, v17, 0x3c800000, v108
    v_and_b32 v18, 0xffff0000, v28
    v_fmamk_f32 v18, v18, 0x3c800000, v108
    v_and_b32 v19, 0xffff0000, v30
    v_fmamk_f32 v19, v19, 0x3c800000, v108
    v_rsq_f32 v16, v16
    v_lshlrev_b32 v20, 16, v24
    v_rsq_f32 v17, v17
    v_lshlrev_b32 v21, 16, v26
    v_rsq_f32 v18, v18
    v_lshlrev_b32 v22, 16, v28
    v_rsq_f32 v19, v19
    v_lshlrev_b32 v23, 16, v30
    v_pk_mul_f32 v[20:21], v[20:21], v[16:17] neg_lo:[1,0] neg_hi:[1,0]
    v_pk_mul_f32 v[22:23], v[22:23], v[18:19] neg_lo:[1,0] neg_hi:[1,0]
    v_pk_mul_f32 v[24:25], v[16:17], s[34:35] op_sel:[0,0] op_sel_hi:[1,0]
    v_pk_mul_f32 v[26:27], v[18:19], s[34:35] op_sel:[0,0] op_sel_hi:[1,0]
    v_pk_mul_f32 v[28:29], v[20:21], s[34:35] op_sel:[0,0] op_sel_hi:[1,0]
    v_pk_mul_f32 v[30:31], v[22:23], s[34:35] op_sel:[0,0] op_sel_hi:[1,0]
    v_pk_fma_f32 v[92:93], v[60:61], v[24:25], v[28:29]
    v_pk_fma_f32 v[94:95], v[62:63], v[26:27], v[30:31]
    v_pk_fma_f32 v[96:97], v[64:65], v[24:25], v[28:29]
    v_pk_fma_f32 v[98:99], v[66:67], v[26:27], v[30:31]
    v_pk_fma_f32 v[100:101], v[68:69], v[24:25], v[28:29]
    v_pk_fma_f32 v[102:103], v[70:71], v[26:27], v[30:31]
    v_pk_fma_f32 v[104:105], v[72:73], v[24:25], v[28:29]
    v_pk_fma_f32 v[106:107], v[74:75], v[26:27], v[30:31]
    v_exp_f32 v92, v92
    v_exp_f32 v93, v93
    v_pk_fma_f32 v[76:77], v[60:61], v[16:17], v[20:21]
    v_exp_f32 v94, v94
    v_exp_f32 v95, v95
    v_pk_fma_f32 v[78:79], v[62:63], v[18:19], v[22:23]
    v_exp_f32 v96, v96
    v_exp_f32 v97, v97
    v_pk_fma_f32 v[80:81], v[64:65], v[16:17], v[20:21]
    v_exp_f32 v98, v98
    v_exp_f32 v99, v99
    v_pk_fma_f32 v[82:83], v[66:67], v[18:19], v[22:23]
    v_exp_f32 v100, v100
    v_exp_f32 v101, v101
    v_pk_fma_f32 v[84:85], v[68:69], v[16:17], v[20:21]
    v_exp_f32 v102, v102
    v_exp_f32 v103, v103
    v_pk_fma_f32 v[86:87], v[70:71], v[18:19], v[22:23]
    v_exp_f32 v104, v104
    v_exp_f32 v105, v105
    v_pk_fma_f32 v[88:89], v[72:73], v[16:17], v[20:21]
    v_exp_f32 v106, v106
    v_exp_f32 v107, v107
    v_pk_fma_f32 v[90:91], v[74:75], v[18:19], v[22:23]
    s_mov_b32 s62, 0
    s_cmp_lg_u32 s46, 2
    s_cbranch_scc1 F_poll_w
F_mid:
    v_pk_add_f32 v[92:93], v[92:93], 1.0 op_sel_hi:[1,0]
    v_pk_add_f32 v[94:95], v[94:95], 1.0 op_sel_hi:[1,0]
    v_pk_add_f32 v[96:97], v[96:97], 1.0 op_sel_hi:[1,0]
    v_pk_add_f32 v[98:99], v[98:99], 1.0 op_sel_hi:[1,0]
    v_pk_add_f32 v[100:101], v[100:101], 1.0 op_sel_hi:[1,0]
    v_pk_add_f32 v[102:103], v[102:103], 1.0 op_sel_hi:[1,0]
    v_pk_add_f32 v[104:105], v[104:105], 1.0 op_sel_hi:[1,0]
    v_pk_add_f32 v[106:107], v[106:107], 1.0 op_sel_hi:[1,0]
    v_rcp_f32 v92, v92
    v_rcp_f32 v93, v93
    v_rcp_f32 v94, v94
    v_rcp_f32 v95, v95
    v_rcp_f32 v96, v96
    v_rcp_f32 v97, v97
    v_rcp_f32 v98, v98
    v_rcp_f32 v99, v99
    v_rcp_f32 v100, v100
    v_rcp_f32 v101, v101
    v_rcp_f32 v102, v102
    v_rcp_f32 v103, v103
    v_rcp_f32 v104, v104
    v_rcp_f32 v105, v105
    v_rcp_f32 v106, v106
    v_rcp_f32 v107, v107
    v_pk_mul_f32 v[76:77], v[76:77], v[92:93]
    v_pk_mul_f32 v[78:79], v[78:79], v[94:95]
    v_pk_mul_f32 v[80:81], v[80:81], v[96:97]
    v_pk_mul_f32 v[82:83], v[82:83], v[98:99]
    v_pk_mul_f32 v[84:85], v[84:85], v[100:101]
    v_pk_mul_f32 v[86:87], v[86:87], v[102:103]
    v_pk_mul_f32 v[88:89], v[88:89], v[104:105]
    v_pk_mul_f32 v[90:91], v[90:91], v[106:107]
    s_mov_b32 s62, 0
    s_cmp_eq_u32 s46, 2
    s_cbranch_scc1 F_fetched
    s_branch F_poll_w
F_poll:
    s_load_dwordx16 s[68:83], s[42:43], 0 glc
    s_load_dwordx16 s[84:99], s[42:43], 64 glc
F_poll_w:
    s_waitcnt lgkmcnt(0)
    s_xor_b64 s[68:69], s[68:69], s[40:41]
    s_xor_b64 s[70:71], s[70:71], s[40:41]
    s_or_b64 s[68:69], s[68:69], s[70:71]
    s_xor_b64 s[72:73], s[72:73], s[40:41]
    s_or_b64 s[68:69], s[68:69], s[72:73]
    s_xor_b64 s[74:75], s[74:75], s[40:41]
    s_or_b64 s[68:69], s[68:69], s[74:75]
    s_xor_b64 s[76:77], s[76:77], s[40:41]
    s_or_b64 s[68:69], s[68:69], s[76:77]
    s_xor_b64 s[78:79], s[78:79], s[40:41]
    s_or_b64 s[68:69], s[68:69], s[78:79]
    s_xor_b64 s[80:81], s[80:81], s[40:41]
    s_or_b64 s[68:69], s[68:69], s[80:81]
    s_xor_b64 s[82:83], s[82:83], s[40:41]
    s_or_b64 s[68:69], s[68:69], s[82:83]
    s_xor_b64 s[84:85], s[84:85], s[40:41]
    s_or_b64 s[68:69], s[68:69], s[84:85]
    s_xor_b64 s[86:87], s[86:87], s[40:41]
    s_or_b64 s[68:69], s[68:69], s[86:87]
    s_xor_b64 s[88:89], s[88:89], s[40:41]
    s_or_b64 s[68:69], s[68:69], s[88:89]
    s_xor_b64 s[90:91], s[90:91], s[40:41]
    s_or_b64 s[68:69], s[68:69], s[90:91]
    s_xor_b64 s[92:93], s[92:93], s[40:41]
    s_or_b64 s[68:69], s[68:69], s[92:93]
    s_xor_b64 s[94:95], s[94:95], s[40:41]
    s_or_b64 s[68:69], s[68:69], s[94:95]
    s_xor_b64 s[96:97], s[96:97], s[40:41]
    s_or_b64 s[68:69], s[68:69], s[96:97]
    s_xor_b64 s[98:99], s[98:99], s[40:41]
    s_or_b64 s[68:69], s[68:69], s[98:99]
    s_cbranch_scc0 F_rel
    s_cmp_lg_u32 s46, 0
    s_cbranch_scc1 F_poll_n
    s_mov_b32 s46, 1
    s_load_dwordx16 s[68:83], s[42:43], 0 glc
    s_load_dwordx16 s[84:99], s[42:43], 64 glc
    s_branch F_mid
F_poll_n:
    s_add_u32 s62, s62, 1
    s_sleep 5
    s_cmp_lt_u32 s62, 200000
    s_cbranch_scc1 F_poll
F_rel:
    s_cmp_lg_u32 s46, 3
    s_cbranch_scc1 F_nlx
    s_mov_b32 m0, s53
    s_add_u32 s35, s64, 16384
    buffer_load_dwordx4 v6, s[12:15], s64 offen lds
    s_add_u32 m0, s53, 1152
    s_add_u32 s35, s64, 16384
    buffer_load_dwordx4 v6, s[12:15], s35 offen lds
F_nlx:
    buffer_load_dword v48, v120, s[24:27], s58 offen sc1
    s_add_u32 s58, s58, 33280
    buffer_load_dword v49, v120, s[24:27], s58 offen sc1
    s_add_u32 s58, s58, 33280
    buffer_load_dword v50, v120, s[24:27], s58 offen sc1
    s_add_u32 s58, s58, 33280
    buffer_load_dword v51, v120, s[24:27], s58 offen sc1
    s_add_u32 s58, s58, 33280
    buffer_load_dword v52, v120, s[24:27], s58 offen sc1
    s_add_u32 s58, s58, 33280
    buffer_load_dword v53, v120, s[24:27], s58 offen sc1
    s_add_u32 s58, s58, 33280
    buffer_load_dword v54, v120, s[24:27], s58 offen sc1
    s_add_u32 s58, s58, 33280
    buffer_load_dword v55, v120, s[24:27], s58 offen sc1
    s_load_dwordx2 s[36:37], s[10:11], s63
    s_cmp_lg_u32 s3, 0
    s_cbranch_scc1 F_novx
    buffer_load_dword v56, v125, s[24:27], s60 offen sc1
F_novx:
    s_cmp_eq_u32 s46, 3
    s_cbranch_scc1 F_lx
    s_cmp_eq_u32 s46, 0
    s_mov_b32 s46, 2
    s_cbranch_scc1 F_mid
F_fetched:
    s_cmp_lg_u32 s3, 0
    s_cbranch_scc1 F_A
    s_waitcnt vmcnt(0)
    v_mfma_f32_32x32x16_f16 v[92:107], v[40:43], v[56:59], 0
    v_mfma_f32_32x32x16_f16 v[92:107], v[32:35], v[48:51], v[92:107]
    s_branch F_A2
F_A:
    s_waitcnt vmcnt(4)
    v_mfma_f32_32x32x16_f16 v[92:107], v[32:35], v[48:51], 0
    s_waitcnt vmcnt(0)
F_A2:
    v_mfma_f32_32x32x16_f16 v[92:107], v[36:39], v[52:55], v[92:107]
    s_waitcnt lgkmcnt(0)
    s_and_b32 s34, s36, 0x77
    s_cmp_eq_u32 s34, s47
    s_cbranch_scc1 F_eh
F_eh_r:
    s_nop 7
    v_cvt_pk_f16_f32 v48, v92, v93
    v_cvt_pk_f16_f32 v49, v94, v95
    ds_write2st64_b32 v121, v48, v49 offset0:128 offset1:133
    v_cvt_pk_f16_f32 v50, v96, v97
    v_cvt_pk_f16_f32 v51, v98, v99
    ds_write2st64_b32 v121, v50, v51 offset0:148 offset1:153
    v_cvt_pk_f16_f32 v52, v100, v101
    v_cvt_pk_f16_f32 v53, v102, v103
    ds_write2st64_b32 v121, v52, v53 offset0:168 offset1:173
    v_cvt_pk_f16_f32 v54, v104, v105
    v_cvt_pk_f16_f32 v55, v106, v107
    ds_write2st64_b32 v121, v54, v55 offset0:188 offset1:193
    s_waitcnt lgkmcnt(0)
    s_barrier
    ds_read_b128 v[48:51], v122 offset:32768
    ds_read_b128 v[52:55], v122 offset:32784
    s_waitcnt lgkmcnt(1)
    v_mfma_f32_16x16x16_f16 v[92:95], v[44:45], v[48:49], 0
    v_mfma_f32_16x16x16_f16 v[96:99], v[44:45], v[50:51], 0
    s_waitcnt lgkmcnt(0)
    v_mfma_f32_16x16x16_f16 v[100:103], v[44:45], v[52:53], 0
    v_mfma_f32_16x16x16_f16 v[104:107], v[44:45], v[54:55], 0
    s_and_b32 s34, s36, 0x77
    s_cmp_lg_u32 s34, s47
    s_cbranch_scc1 F_noh
    s_mul_i32 s50, s33, 28
    s_sub_u32 s50, s50, s68
    s_sub_u32 s50, s50, s69
    s_sub_u32 s50, s50, s70
    s_sub_u32 s50, s50, s71
    s_sub_u32 s50, s50, s72
    s_sub_u32 s50, s50, s73
    s_sub_u32 s50, s50, s74
    s_sub_u32 s50, s50, s75
    s_sub_u32 s50, s50, s76
    s_sub_u32 s50, s50, s77
    s_sub_u32 s50, s50, s78
    s_sub_u32 s50, s50, s79
    s_sub_u32 s50, s50, s80
    s_sub_u32 s50, s50, s81
    s_sub_u32 s50, s50, s84
    s_sub_u32 s50, s50, s85
    s_sub_u32 s50, s50, s86
    s_sub_u32 s50, s50, s87
    s_sub_u32 s50, s50, s88
    s_sub_u32 s50, s50, s89
    s_sub_u32 s50, s50, s90
    s_sub_u32 s50, s50, s91
    s_sub_u32 s50, s50, s92
    s_sub_u32 s50, s50, s93
    s_sub_u32 s50, s50, s94
    s_sub_u32 s50, s50, s95
    s_sub_u32 s50, s50, s96
    s_sub_u32 s50, s50, s97
    s_cmp_eq_u32 s50, 0
    s_cbranch_scc1 F_own
    s_load_dwordx16 s[68:83], s[10:11], s48 glc
    s_load_dwordx16 s[84:99], s[10:11], s52 glc
F_noh:
    s_cmp_eq_u32 s57, 0
    s_cbranch_scc1 F_zero
F_nz:
    v_pk_fma_f32 v[60:61], v[92:93], v[76:77], v[60:61]
    v_pk_fma_f32 v[64:65], v[96:97], v[80:81], v[64:65]
    v_pk_fma_f32 v[68:69], v[100:101], v[84:85], v[68:69]
    v_pk_fma_f32 v[72:73], v[104:105], v[88:89], v[72:73]
    v_cvt_pk_bf16_f32 v32, v60, v64
    v_cvt_pk_bf16_f32 v33, v68, v72
    buffer_store_dwordx2 v[32:33], v123, s[20:23], s64 offen sc1
    v_cvt_pk_bf16_f32 v34, v61, v65
    v_cvt_pk_bf16_f32 v35, v69, v73
    buffer_store_dwordx2 v[34:35], v123, s[20:23], s65 offen sc1
    v_pk_fma_f32 v[62:63], v[94:95], v[78:79], v[62:63]
    v_pk_fma_f32 v[66:67], v[98:99], v[82:83], v[66:67]
    v_pk_fma_f32 v[70:71], v[102:103], v[86:87], v[70:71]
    v_pk_fma_f32 v[74:75], v[106:107], v[90:91], v[74:75]
    v_cvt_pk_bf16_f32 v36, v62, v66
    v_cvt_pk_bf16_f32 v37, v70, v74
    buffer_store_dwordx2 v[36:37], v123, s[20:23], s66 offen sc1
    v_cvt_pk_bf16_f32 v38, v63, v67
    v_cvt_pk_bf16_f32 v39, v71, v75
    buffer_store_dwordx2 v[38:39], v123, s[20:23], s67 offen sc1
    s_mov_b32 s62, 0
    s_cmp_lg_u32 s16, 0
    s_cbranch_scc1 F_own2
F_res:
    s_cmp_eq_u32 s37, s33
    s_cbranch_scc1 F_res_d
    s_load_dwordx2 s[36:37], s[10:11], s63 glc
    s_add_u32 s62, s62, 1
    s_cmp_lt_u32 s62, 200000
    s_waitcnt lgkmcnt(0)
    s_cbranch_scc1 F_res
F_res_d:
    s_and_b32 s34, s36, 0x77
    s_cmp_lg_u32 s34, s47
    s_cbranch_scc1 L_fin
    v_lshrrev_b32 v108, 3, v2
    v_lshlrev_b32 v108, 12, v108
    v_and_b32 v109, 0x70, v126
    v_add_u32 v108, v108, v109
    s_cmp_eq_u32 s50, 0
    s_cbranch_scc1 F_n2_d
    s_mul_i32 s50, s33, 28
    s_mov_b32 s62, 0
F_n2:
    s_waitcnt lgkmcnt(0)
    s_add_u32 s84, s84, s68
    s_add_u32 s84, s84, s69
    s_add_u32 s84, s84, s70
    s_add_u32 s84, s84, s71
    s_add_u32 s84, s84, s72
    s_add_u32 s84, s84, s73
    s_add_u32 s84, s84, s74
    s_add_u32 s84, s84, s75
    s_add_u32 s84, s84, s76
    s_add_u32 s84, s84, s77
    s_add_u32 s84, s84, s78
    s_add_u32 s84, s84, s79
    s_add_u32 s84, s84, s80
    s_add_u32 s84, s84, s81
    s_add_u32 s84, s84, s85
    s_add_u32 s84, s84, s86
    s_add_u32 s84, s84, s87
    s_add_u32 s84, s84, s88
    s_add_u32 s84, s84, s89
    s_add_u32 s84, s84, s90
    s_add_u32 s84, s84, s91
    s_add_u32 s84, s84, s92
    s_add_u32 s84, s84, s93
    s_add_u32 s84, s84, s94
    s_add_u32 s84, s84, s95
    s_add_u32 s84, s84, s96
    s_add_u32 s84, s84, s97
    s_cmp_eq_u32 s84, s50
    s_cbranch_scc1 F_n2_d
    s_load_dwordx16 s[68:83], s[10:11], s48 glc
    s_load_dwordx16 s[84:99], s[10:11], s52 glc
    s_add_u32 s62, s62, 1
    s_cmp_lt_u32 s62, 200000
    s_cbranch_scc1 F_n2
F_n2_d:
    s_mov_b32 s62, 0
F_h2:
    s_mov_b32 s34, s49
    buffer_load_dwordx4 v[8:11], v108, s[24:27], s34 offen sc1
    s_add_u32 s34, s34, 32768
    buffer_load_dwordx4 v[12:15], v108, s[24:27], s34 offen sc1
    s_add_u32 s34, s34, 32768
    buffer_load_dwordx4 v[24:27], v108, s[24:27], s34 offen sc1
    s_add_u32 s34, s34, 32768
    buffer_load_dwordx4 v[28:31], v108, s[24:27], s34 offen sc1
    s_add_u32 s34, s34, 32768
    buffer_load_dwordx4 v[48:51], v108, s[24:27], s34 offen sc1
    s_add_u32 s34, s34, 32768
    buffer_load_dwordx4 v[52:55], v108, s[24:27], s34 offen sc1
    s_add_u32 s34, s34, 32768
    buffer_load_dwordx4 v[56:59], v108, s[24:27], s34 offen sc1
    s_cmp_lg_u32 s62, 0
    s_cbranch_scc1 F_h2_w
F_own2:
    s_bfe_u32 s38, s36, 0x20007
    s_bfe_u32 s39, s36, 0x20009
    s_bfe_u32 s51, s36, 0x10003
    s_set_gpr_idx_on s38, 1
    v_mov_b32 v40, v92
    v_mov_b32 v41, v96
    v_mov_b32 v42, v100
    v_mov_b32 v43, v104
    v_mov_b32 v44, v16
    v_mov_b32 v45, v20
    s_set_gpr_idx_off
    s_lshl1_add_u32 s34, s39, s51
    s_lshl_b32 s44, s34, 3
    v_add_u32 v114, s53, v126
    ds_write_b128 v114, v[40:43] offset:2560
    v_and_b32 v113, 7, v2
    v_lshl_add_u32 v113, v113, 2, v4
    s_lshl4_add_u32 s34, s44, s53
    v_lshl_add_u32 v112, v113, 2, s34
    ds_read_b32 v112, v112 offset:2560
    s_lshl2_add_u32 s34, s38, s39
    s_lshl_b32 s34, s34, 6
    s_mul_i32 s35, s51, 1152
    s_add_u32 s34, s34, s35
    s_add_u32 s34, s34, s53
    v_lshlrev_b32 v113, 1, v113
    v_add_u32 v110, s34, v113
    ds_read_u16 v110, v110
    v_readlane_b32 s45, v44, s44
    v_readlane_b32 s46, v45, s44
    s_and_b32 s34, s36, 0xfffff800
    s_ashr_i32 s35, s34, 31
    s_orn2_b32 s35, 0x80000000, s35
    s_xor_b32 s34, s34, s35
    v_mov_b32 v109, 0xbfb8aa3b
    v_mul_f32 v109, s34, v109
    v_exp_f32 v109, v109
    s_waitcnt lgkmcnt(0)
    v_lshlrev_b32 v110, 16, v110
    v_mov_b32 v111, s46
    v_add_f32 v109, 1.0, v109
    v_rcp_f32 v109, v109
    v_fmac_f32 v111, s45, v110
    v_mul_f32 v109, 0x41000000, v109
    s_and_b32 s38, s36, 2047
    s_lshl_b32 s38, s38, 11
    s_lshl_b32 s34, s57, 6
    s_add_u32 s38, s38, s34
    s_cmp_eq_u32 s16, 0
    s_cbranch_scc1 F_h2_w
    s_waitcnt vmcnt(4)
    v_pk_add_f32 v[88:89], v[8:9], v[12:13]
    v_pk_add_f32 v[90:91], v[10:11], v[14:15]
    v_pk_add_f32 v[88:89], v[88:89], v[24:25]
    v_pk_add_f32 v[90:91], v[90:91], v[26:27]
    v_pk_add_f32 v[88:89], v[88:89], v[28:29]
    v_pk_add_f32 v[90:91], v[90:91], v[30:31]
    v_pk_add_f32 v[88:89], v[88:89], v[48:49]
    v_pk_add_f32 v[90:91], v[90:91], v[50:51]
    v_pk_add_f32 v[88:89], v[88:89], v[52:53]
    v_pk_add_f32 v[90:91], v[90:91], v[54:55]
    v_pk_add_f32 v[88:89], v[88:89], v[56:57]
    v_pk_add_f32 v[90:91], v[90:91], v[58:59]
    s_nop 0
    v_permlane16_swap_b32 v88, v89
    v_permlane16_swap_b32 v90, v91
    v_add_f32 v88, v88, v89
    v_add_f32 v90, v90, v91
    s_nop 1
    v_permlane32_swap_b32 v88, v90
    v_add_f32 v88, v88, v90
    s_nop 1
    v_add_f32_dpp v88, v88, v88 row_ror:8 row_mask:0xf bank_mask:0xf
    v_cmp_u_f32 vcc, v88, v88
    v_fma_f32 v88, v88, v109, v111
    s_cbranch_vccz F_h2_d
    s_branch F_h2_x
F_h2_w:
    s_waitcnt vmcnt(5)
    v_pk_add_f32 v[88:89], v[8:9], v[12:13]
    v_pk_add_f32 v[90:91], v[10:11], v[14:15]
    s_waitcnt vmcnt(4)
    v_pk_add_f32 v[88:89], v[88:89], v[24:25]
    v_pk_add_f32 v[90:91], v[90:91], v[26:27]
    s_waitcnt vmcnt(3)
    v_pk_add_f32 v[88:89], v[88:89], v[28:29]
    v_pk_add_f32 v[90:91], v[90:91], v[30:31]
    s_waitcnt vmcnt(2)
    v_pk_add_f32 v[88:89], v[88:89], v[48:49]
    v_pk_add_f32 v[90:91], v[90:91], v[50:51]
    s_waitcnt vmcnt(1)
    v_pk_add_f32 v[88:89], v[88:89], v[52:53]
    v_pk_add_f32 v[90:91], v[90:91], v[54:55]
    s_waitcnt vmcnt(0)
    v_pk_add_f32 v[88:89], v[88:89], v[56:57]
    v_pk_add_f32 v[90:91], v[90:91], v[58:59]
    s_nop 0
    v_permlane16_swap_b32 v88, v89
    v_permlane16_swap_b32 v90, v91
    v_add_f32 v88, v88, v89
    v_add_f32 v90, v90, v91
    s_nop 1
    v_permlane32_swap_b32 v88, v90
    v_add_f32 v88, v88, v90
    s_nop 1
    v_add_f32_dpp v88, v88, v88 row_ror:8 row_mask:0xf bank_mask:0xf
    v_cmp_u_f32 vcc, v88, v88
    v_fma_f32 v88, v88, v109, v111
    s_cbranch_vccnz F_h2_x
F_h2_d:
    v_mul_f32 v89, 0xbe38aa3b, v88
    v_exp_f32 v89, v89
    v_mul_f32 v88, v88, v112
    v_add_f32 v89, 1.0, v89
    v_rcp_f32 v89, v89
    s_mov_b32 exec_lo, 0x00ff00ff
    s_mov_b32 exec_hi, 0x00ff00ff
    v_fmac_f32 v110, v88, v89
    v_cvt_pk_bf16_f32 v110, v110, v110
    buffer_store_short v110, v113, s[20:23], s38 offen sc1
    s_cmp_lg_u32 s57, 0
    s_cbranch_scc1 L_fin
    s_mov_b64 exec, 1
    v_mov_b32 v108, 0
    v_mov_b32 v109, s33
    buffer_store_dword v109, v108, s[24:27], 0 offen sc1
    s_branch L_fin
F_lx:
    s_mov_b32 s46, 2
    s_mov_b32 s62, 0
    s_waitcnt vmcnt(8) lgkmcnt(0)
    s_branch F_xt
F_own:
    s_cmp_lg_u32 s37, s33
    s_cbranch_scc1 F_noh
    v_lshrrev_b32 v108, 3, v2
    v_lshlrev_b32 v108, 12, v108
    v_and_b32 v109, 0x70, v126
    v_add_u32 v108, v108, v109
    s_mov_b32 s34, s49
    buffer_load_dwordx4 v[8:11], v108, s[24:27], s34 offen sc1
    s_add_u32 s34, s34, 32768
    buffer_load_dwordx4 v[12:15], v108, s[24:27], s34 offen sc1
    s_add_u32 s34, s34, 32768
    buffer_load_dwordx4 v[24:27], v108, s[24:27], s34 offen sc1
    s_add_u32 s34, s34, 32768
    buffer_load_dwordx4 v[28:31], v108, s[24:27], s34 offen sc1
    s_add_u32 s34, s34, 32768
    buffer_load_dwordx4 v[48:51], v108, s[24:27], s34 offen sc1
    s_add_u32 s34, s34, 32768
    buffer_load_dwordx4 v[52:55], v108, s[24:27], s34 offen sc1
    s_add_u32 s34, s34, 32768
    buffer_load_dwordx4 v[56:59], v108, s[24:27], s34 offen sc1
    s_mov_b32 s16, 1
    s_branch F_noh
F_eh:
    s_load_dwordx16 s[68:83], s[10:11], s48 glc
    s_load_dwordx16 s[84:99], s[10:11], s52 glc
    s_branch F_eh_r
F_h2_x:
    v_max3_u32 v89, v8, v9, v10
    v_max3_u32 v89, v89, v11, v12
    v_max3_u32 v89, v89, v13, v14
    v_max3_u32 v89, v89, v15, v24
    v_max3_u32 v89, v89, v25, v26
    v_max3_u32 v89, v89, v27, v28
    v_max3_u32 v89, v89, v29, v30
    v_max3_u32 v89, v89, v31, v48
    v_max3_u32 v89, v89, v49, v50
    v_max3_u32 v89, v89, v51, v52
    v_max3_u32 v89, v89, v53, v54
    v_max3_u32 v89, v89, v55, v56
    v_max3_u32 v89, v89, v57, v58
    v_max_u32 v89, v89, v59
    v_cmp_eq_u32 vcc, -1, v89
    s_add_u32 s62, s62, 1
    s_cbranch_vccz F_h2_d
    s_cmp_lt_u32 s62, 200000
    s_cbranch_scc1 F_h2
    s_branch F_h2_d
F_zero:
    s_mov_b32 exec_lo, 0x01010101
    s_mov_b32 exec_hi, 0x01010101
    s_nop 2
    v_mov_b32 v92, 0
    v_mov_b32 v93, 0
    v_mov_b32 v94, 0
    v_mov_b32 v95, 0
    s_mov_b64 exec, -1
    s_branch F_nz
F_second:
    ds_read_b128 v[60:63], v126 offset:53760
    ds_read_b128 v[64:67], v126 offset:54784
    s_mov_b32 s46, 0
    s_mul_i32 s34, s44, 16640
    s_add_u32 s50, s50, 8320
    s_sub_u32 s50, s50, s34
    v_add_u32 v113, 1, v3
    v_bfe_i32 v113, v113, 4, 1
    v_and_b32 v113, 0xc2000000, v113
    v_xor_b32 v124, v113, v124
    v_xor_b32 v32, 0x80000000, v32
    v_xor_b32 v33, 0x80000000, v33
    v_xor_b32 v34, 0x80000000, v34
    v_xor_b32 v35, 0x80000000, v35
    v_xor_b32 v36, 0x80000000, v36
    v_xor_b32 v37, 0x80000000, v37
    v_xor_b32 v38, 0x80000000, v38
    v_xor_b32 v39, 0x80000000, v39
    v_mul_f32 v116, s70, v124
    v_fmac_f32 v116, v112, v124
    v_mfma_f32_16x16x32_bf16 v[76:79], v[8:11], v[32:35], 0
    v_mfma_f32_16x16x32_bf16 v[80:83], v[12:15], v[32:35], 0
    v_mfma_f32_16x16x32_bf16 v[84:87], v[8:11], v[36:39], 0
    v_mfma_f32_16x16x32_bf16 v[88:91], v[12:15], v[36:39], 0
    v_mfma_f32_16x16x32_bf16 v[92:95], v[16:19], v[32:35], 0
    v_mfma_f32_16x16x32_bf16 v[96:99], v[20:23], v[32:35], 0
    v_mfma_f32_16x16x32_bf16 v[100:103], v[16:19], v[36:39], 0
    v_mfma_f32_16x16x32_bf16 v[104:107], v[20:23], v[36:39], 0
    s_nop 2
    v_pk_mul_f32 v[84:85], v[84:85], s[54:55] op_sel:[0,0] op_sel_hi:[1,0]
    v_pk_mul_f32 v[86:87], v[86:87], s[54:55] op_sel:[0,0] op_sel_hi:[1,0]
    v_pk_mul_f32 v[88:89], v[88:89], s[54:55] op_sel:[0,0] op_sel_hi:[1,0]
    v_pk_mul_f32 v[90:91], v[90:91], s[54:55] op_sel:[0,0] op_sel_hi:[1,0]
    s_waitcnt lgkmcnt(0)
    s_barrier
    s_branch F_pass
F_key:
    v_mov_b32 v115, s33
    v_lshlrev_b32 v108, 11, v2
    s_lshl3_add_u32 s35, s2, 8192
    s_mov_b32 exec_lo, 0xff
    s_mov_b32 exec_hi, 0x0
    buffer_store_dwordx2 v[114:115], v108, s[24:27], s35 offen sc1
    s_mov_b64 exec, -1
    s_mov_b32 s71, 1
    s_branch F_nokey
F_wkey:
    s_waitcnt vmcnt(2)
    s_branch F_wkey_r
M_entry:
    s_sub_u32 s28, s2, 256
    s_lshr_b32 s29, s28, 1
    s_xor_b32 s29, s29, s28
    s_and_b32 s29, s29, 8
    s_mul_i32 s29, s29, 3
    s_xor_b32 s28, s28, s29
    s_lshr_b32 s29, s28, 2
    s_and_b32 s30, s28, 3
    s_xor_b32 s30, s30, 1
    s_setprio 3
    v_mov_b32 v7, 1152
    s_mov_b32 s26, 268435456
    s_mov_b32 s27, 0x20000
    v_mov_b32 v8, 0
    v_mov_b32 v9, 0
    v_mov_b32 v10, 0
    v_mov_b32 v11, 0
    v_mov_b32 v114, 0
    ds_write_b128 v7, v[8:11]
    ds_write_b128 v7, v[8:11] offset:16
    ds_write_b128 v7, v[8:11] offset:32
    v_mov_b32 v8, 0x3f803f80
    v_mov_b32 v9, 0x3f803f80
    v_lshlrev_b32 v10, 3, v2
    ds_write_b64 v10, v[8:9] offset:512
    s_waitcnt lgkmcnt(0)
    s_load_dword s16, s[10:11], 0
    s_mul_i32 s12, s3, 320
    s_min_u32 s12, s12, 2048
    s_add_u32 s18, s12, 7872
    s_and_b32 s13, s28, 7
    s_lshl_b32 s13, s13, 11
    s_add_u32 s12, s12, s13
    s_add_u32 s12, s12, 7872
    s_add_u32 s12, s10, s12
    s_addc_u32 s13, s11, 0
    s_barrier
    s_waitcnt lgkmcnt(0)
    s_mul_i32 s16, s16, 0x9e3779b1
    s_add_u32 s16, s16, 0x7f4a7c15
    s_mul_i32 s15, s16, 40
    s_mov_b32 s17, 0
    s_sub_u32 s31, s3, 2
    s_cmp_lt_u32 s31, 4
    s_cbranch_scc1 M_pre
    v_mov_b32 v8, 1152
    s_mov_b32 s62, 0
M_pg:
    ds_read_b32 v9, v8
    s_waitcnt lgkmcnt(0)
    v_cmp_gt_u32 vcc, 8, v9
    s_add_u32 s62, s62, 1
    s_cbranch_vccz M_pg_d
    s_sleep 1
    s_cmp_lt_u32 s62, 1000000
    s_cbranch_scc1 M_pg
M_pg_d:
    s_branch M_scan0
M_pre:
    s_and_b32 s46, s28, 7
    s_lshl2_add_u32 s6, s46, s31
    s_lshl_b32 s6, s6, 6
    s_lshr_b32 s44, s28, 3
    s_lshr_b32 s34, s31, 1
    s_lshl1_add_u32 s44, s44, s34
    s_lshl4_add_u32 s44, s44, s46
    s_and_b32 s34, s31, 1
    s_lshl1_add_u32 s44, s44, s34
    s_lshl_b32 s44, s44, 7
    v_lshrrev_b32 v114, 5, v2
    v_mul_u32_u24 v114, 0x4800, v114
    v_xor_b32 v114, s44, v114
    v_and_b32 v115, 31, v2
    v_lshl_add_u32 v114, v115, 2, v114
    s_mov_b32 s44, 262144
    s_lshl2_add_u32 s45, s29, s30
    s_lshl_b32 s45, s45, 10
    s_lshl_b32 s34, s31, 8
    s_add_u32 s45, s45, s34
    s_add_u32 s45, s45, 491520
    s_lshl_b32 s34, s31, 6
    v_lshl_add_u32 v113, v2, 2, s34
    s_mov_b32 s7, s45
    v_bfe_u32 v8, v2, 2, 2
    v_lshl_add_u32 v9, v4, 2, v8
    v_and_b32 v10, 7, v9
    v_lshlrev_b32 v10, 1, v10
    v_bfe_u32 v11, v2, 1, 1
    s_lshl_b32 s34, s31, 2
    v_or_b32 v12, s34, v11
    v_xor_b32 v12, v12, v10
    v_lshlrev_b32 v12, 4, v12
    v_lshl_add_u32 v12, v9, 8, v12
    v_and_b32 v13, 1, v2
    v_lshl_add_u32 v12, v13, 3, v12
    v_xor_b32 v126, 32, v12
    s_lshl_b32 s34, s31, 3
    v_or_b32 v120, s34, v11
    v_xor_b32 v120, v120, v10
    v_lshlrev_b32 v120, 4, v120
    v_lshl_add_u32 v120, v9, 9, v120
    v_lshl_add_u32 v120, v13, 3, v120
    v_xor_b32 v121, 32, v120
    v_xor_b32 v122, 64, v120
    v_xor_b32 v123, 96, v120
    v_lshlrev_b32 v14, 4, v4
    v_and_b32 v15, 1, v2
    v_lshl_add_u32 v15, v15, 9, v14
    v_mov_b32 v8, 1152
    s_mov_b32 s62, 0
M_wg6:
    ds_read_b32 v9, v8
    s_waitcnt lgkmcnt(0)
    v_cmp_gt_u32 vcc, 6, v9
    s_add_u32 s62, s62, 1
    s_cbranch_vccz M_wg6_d
    s_sleep 1
    s_cmp_lt_u32 s62, 1000000
    s_cbranch_scc1 M_wg6
M_wg6_d:
    ds_read_b64_tr_b16 v[16:17], v12 offset:1280
    ds_read_b64_tr_b16 v[18:19], v12 offset:5376
    ds_read_b64_tr_b16 v[32:33], v126 offset:1280
    ds_read_b64_tr_b16 v[34:35], v126 offset:5376
    ds_read_b64_tr_b16 v[20:21], v12 offset:9472
    ds_read_b64_tr_b16 v[22:23], v12 offset:13568
    ds_read_b64_tr_b16 v[36:37], v126 offset:9472
    ds_read_b64_tr_b16 v[38:39], v126 offset:13568
    ds_read_b64_tr_b16 v[24:25], v12 offset:17664
    ds_read_b64_tr_b16 v[26:27], v12 offset:21760
    ds_read_b64_tr_b16 v[40:41], v126 offset:17664
    ds_read_b64_tr_b16 v[42:43], v126 offset:21760
    v_mov_b32 v8, 1
    s_waitcnt lgkmcnt(0)
    s_mov_b64 exec, 1
    ds_add_u32 v7, v8 offset:4
    s_mov_b64 exec, -1
    v_mov_b32 v8, 1152
    s_mov_b32 s62, 0
M_wg:
    ds_read_b32 v9, v8
    s_waitcnt lgkmcnt(0)
    v_cmp_gt_u32 vcc, 8, v9
    s_add_u32 s62, s62, 1
    s_cbranch_vccz M_wg_d
    s_sleep 1
    s_cmp_lt_u32 s62, 1000000
    s_cbranch_scc1 M_wg
M_wg_d:
    ds_read_b64_tr_b16 v[28:29], v12 offset:25856
    ds_read_b64_tr_b16 v[30:31], v12 offset:29952
    ds_read_b64_tr_b16 v[44:45], v126 offset:25856
    ds_read_b64_tr_b16 v[46:47], v126 offset:29952
M_scan0:
    s_lshl_b32 s15, s16, 3
    s_mov_b32 s19, 0
    v_mov_b32 v10, 0
    s_load_dwordx16 s[20:35], s[12:13], 0
    s_load_dwordx16 s[36:51], s[12:13], 64
    s_load_dwordx16 s[52:67], s[12:13], 128
    s_load_dwordx16 s[68:83], s[12:13], 192
    s_load_dwordx16 s[84:99], s[12:13], 256
    v_mov_b32 v8, 1
    s_mov_b64 exec, 1
    s_waitcnt lgkmcnt(0)
    ds_add_u32 v7, v8 offset:24
    s_mov_b64 exec, -1
    s_branch M_scan1
M_scan:
    s_waitcnt lgkmcnt(0)
M_scan1:
    s_add_u32 s14, s21, s23
    s_add_u32 s14, s14, s25
    s_add_u32 s14, s14, s27
    s_add_u32 s14, s14, s29
    s_add_u32 s14, s14, s31
    s_add_u32 s14, s14, s33
    s_add_u32 s14, s14, s35
    s_cmp_lg_u32 s14, s15
    s_cbranch_scc1 M_sec0
    v_max_u32 v10, s20, v10
    v_max_u32 v10, s22, v10
    v_max_u32 v10, s24, v10
    v_max_u32 v10, s26, v10
    v_max_u32 v10, s28, v10
    v_max_u32 v10, s30, v10
    v_max_u32 v10, s32, v10
    v_max_u32 v10, s34, v10
    s_bitset1_b32 s19, 0
    s_mov_b32 s21, 0
M_sec0:
    s_add_u32 s14, s37, s39
    s_add_u32 s14, s14, s41
    s_add_u32 s14, s14, s43
    s_add_u32 s14, s14, s45
    s_add_u32 s14, s14, s47
    s_add_u32 s14, s14, s49
    s_add_u32 s14, s14, s51
    s_cmp_lg_u32 s14, s15
    s_cbranch_scc1 M_sec1
    v_max_u32 v10, s36, v10
    v_max_u32 v10, s38, v10
    v_max_u32 v10, s40, v10
    v_max_u32 v10, s42, v10
    v_max_u32 v10, s44, v10
    v_max_u32 v10, s46, v10
    v_max_u32 v10, s48, v10
    v_max_u32 v10, s50, v10
    s_bitset1_b32 s19, 1
    s_mov_b32 s37, 0
M_sec1:
    s_add_u32 s14, s53, s55
    s_add_u32 s14, s14, s57
    s_add_u32 s14, s14, s59
    s_add_u32 s14, s14, s61
    s_add_u32 s14, s14, s63
    s_add_u32 s14, s14, s65
    s_add_u32 s14, s14, s67
    s_cmp_lg_u32 s14, s15
    s_cbranch_scc1 M_sec2
    v_max_u32 v10, s52, v10
    v_max_u32 v10, s54, v10
    v_max_u32 v10, s56, v10
    v_max_u32 v10, s58, v10
    v_max_u32 v10, s60, v10
    v_max_u32 v10, s62, v10
    v_max_u32 v10, s64, v10
    v_max_u32 v10, s66, v10
    s_bitset1_b32 s19, 2
    s_mov_b32 s53, 0
M_sec2:
    s_add_u32 s14, s69, s71
    s_add_u32 s14, s14, s73
    s_add_u32 s14, s14, s75
    s_add_u32 s14, s14, s77
    s_add_u32 s14, s14, s79
    s_add_u32 s14, s14, s81
    s_add_u32 s14, s14, s83
    s_cmp_lg_u32 s14, s15
    s_cbranch_scc1 M_sec3
    v_max_u32 v10, s68, v10
    v_max_u32 v10, s70, v10
    v_max_u32 v10, s72, v10
    v_max_u32 v10, s74, v10
    v_max_u32 v10, s76, v10
    v_max_u32 v10, s78, v10
    v_max_u32 v10, s80, v10
    v_max_u32 v10, s82, v10
    s_bitset1_b32 s19, 3
    s_mov_b32 s69, 0
M_sec3:
    s_add_u32 s14, s85, s87
    s_add_u32 s14, s14, s89
    s_add_u32 s14, s14, s91
    s_add_u32 s14, s14, s93
    s_add_u32 s14, s14, s95
    s_add_u32 s14, s14, s97
    s_add_u32 s14, s14, s99
    s_cmp_lg_u32 s14, s15
    s_cbranch_scc1 M_sec4
    v_max_u32 v10, s84, v10
    v_max_u32 v10, s86, v10
    v_max_u32 v10, s88, v10
    v_max_u32 v10, s90, v10
    v_max_u32 v10, s92, v10
    v_max_u32 v10, s94, v10
    v_max_u32 v10, s96, v10
    v_max_u32 v10, s98, v10
    s_bitset1_b32 s19, 4
    s_mov_b32 s85, 0
M_sec4:
    s_cmp_eq_u32 s19, 31
    s_cbranch_scc1 M_scan_d
    s_add_u32 s17, s17, 1
    s_add_u32 s14, s2, s17
    s_and_b32 s14, s14, 7
    s_lshl_b32 s14, s14, 11
    s_add_u32 s14, s14, s18
    s_add_u32 s12, s10, s14
    s_addc_u32 s13, s11, 0
    s_sleep 2
    s_cmp_ge_u32 s17, 8
    s_cbranch_scc1 M_scan_u
    s_bitcmp1_b32 s19, 0
    s_cbranch_scc1 M_rla0
    s_load_dwordx16 s[20:35], s[12:13], 0
M_rla0:
    s_bitcmp1_b32 s19, 1
    s_cbranch_scc1 M_rla1
    s_load_dwordx16 s[36:51], s[12:13], 64
M_rla1:
    s_bitcmp1_b32 s19, 2
    s_cbranch_scc1 M_rla2
    s_load_dwordx16 s[52:67], s[12:13], 128
M_rla2:
    s_bitcmp1_b32 s19, 3
    s_cbranch_scc1 M_rla3
    s_load_dwordx16 s[68:83], s[12:13], 192
M_rla3:
    s_bitcmp1_b32 s19, 4
    s_cbranch_scc1 M_rla4
    s_load_dwordx16 s[84:99], s[12:13], 256
M_rla4:
    s_branch M_scan
M_scan_u:
    s_bitcmp1_b32 s19, 0
    s_cbranch_scc1 M_rlb0
    s_load_dwordx16 s[20:35], s[12:13], 0 glc
M_rlb0:
    s_bitcmp1_b32 s19, 1
    s_cbranch_scc1 M_rlb1
    s_load_dwordx16 s[36:51], s[12:13], 64 glc
M_rlb1:
    s_bitcmp1_b32 s19, 2
    s_cbranch_scc1 M_rlb2
    s_load_dwordx16 s[52:67], s[12:13], 128 glc
M_rlb2:
    s_bitcmp1_b32 s19, 3
    s_cbranch_scc1 M_rlb3
    s_load_dwordx16 s[68:83], s[12:13], 192 glc
M_rlb3:
    s_bitcmp1_b32 s19, 4
    s_cbranch_scc1 M_rlb4
    s_load_dwordx16 s[84:99], s[12:13], 256 glc
M_rlb4:
    s_cmp_lt_u32 s17, 200000
    s_cbranch_scc1 M_scan
    s_waitcnt lgkmcnt(0)
M_scan_d:
    v_mov_b32 v8, 1
    s_mov_b64 exec, 1
    ds_max_u32 v7, v10 offset:16
    ds_add_u32 v7, v8 offset:20
    s_mov_b64 exec, -1
    s_sub_u32 s31, s3, 2
    s_cmp_lt_u32 s31, 4
    s_cbranch_scc1 M_comp
    s_mov_b32 s33, s16
    s_sub_u32 s28, s2, 256
    s_lshr_b32 s29, s28, 1
    s_xor_b32 s29, s29, s28
    s_and_b32 s29, s29, 8
    s_mul_i32 s29, s29, 3
    s_xor_b32 s28, s28, s29
    s_lshr_b32 s29, s28, 2
    s_and_b32 s30, s28, 3
    s_xor_b32 s30, s30, 1
    s_mov_b64 s[24:25], s[10:11]
    s_mov_b32 s26, 268435456
    s_mov_b32 s27, 0x20000
    s_cmp_ge_u32 s3, 6
    s_cbranch_scc1 M_agent
    s_cmp_ge_u32 s3, 6
    s_cbranch_scc1 L_fin
    s_cmp_eq_u32 s3, 1
    s_branch M_poller
M_agent:
    s_and_b32 s47, s28, 7
    s_lshl_b32 s47, s47, 8
    s_mov_b32 s49, 0
    s_mov_b32 s62, 0
M_ag:
    ds_read_b64 v[8:9], v7 offset:16
    s_waitcnt lgkmcnt(0)
    v_readfirstlane_b32 s48, v8
    v_readfirstlane_b32 s46, v9
    s_nop 0
    s_cmp_ge_u32 s46, 7
    s_cbranch_scc1 L_fin
    s_cmp_eq_u32 s48, s49
    s_cbranch_scc1 M_ag_n
    s_mov_b32 s49, s48
    s_and_b32 s34, s48, 2047
    s_lshl_b32 s34, s34, 11
    s_add_u32 s34, s34, s47
    s_load_dword s54, s[4:5], s34
    s_add_u32 s34, s34, 64
    s_load_dword s55, s[4:5], s34
    s_add_u32 s34, s34, 64
    s_load_dword s56, s[4:5], s34
    s_add_u32 s34, s34, 64
    s_load_dword s57, s[4:5], s34
    s_and_b32 s50, s48, 7
    s_bfe_u32 s34, s48, 0x40003
    s_lshl4_add_u32 s50, s50, s34
    s_bfe_u32 s34, s48, 0x40007
    s_lshl4_add_u32 s50, s50, s34
    s_lshl3_add_u32 s50, s50, 24576
    s_load_dwordx2 s[52:53], s[10:11], s50
M_ag_n:
    s_add_u32 s62, s62, 1
    s_cmp_lt_u32 s62, 1000000
    s_cbranch_scc1 M_ag
    s_branch L_fin
M_loader2:
    v_mov_b32 v7, 1152
    s_mov_b32 s26, 268435456
    s_mov_b32 s27, 0x20000
    v_xor_b32 v18, 128, v8
    s_lshr_b32 s29, s28, 2
    s_and_b32 s30, s28, 3
    s_xor_b32 s30, s30, 1
    s_mov_b64 s[24:25], s[10:11]
    s_mov_b32 s16, s40
    s_and_b32 s17, s41, 0xffff
    s_mov_b32 s18, 7340032
    s_mov_b32 s19, 0x20000
    s_mov_b32 s47, 3
    s_barrier
M_ld3:
    s_mov_b32 m0, s46
    s_add_u32 s46, s46, 1024
    buffer_load_dwordx4 v8, s[12:15], s45 offen nt lds
    s_add_u32 s45, s45, 28672
    s_waitcnt vmcnt(12)
    s_mov_b32 m0, s46
    s_add_u32 s46, s46, 1024
    buffer_load_dwordx4 v18, s[12:15], s45 offen nt lds
    s_add_u32 s45, s45, 28672
    s_waitcnt vmcnt(12)
    s_mov_b32 m0, s46
    s_add_u32 s46, s46, 1024
    buffer_load_dwordx4 v8, s[12:15], s45 offen nt lds
    s_add_u32 s45, s45, 28672
    s_waitcnt vmcnt(12)
    s_mov_b32 m0, s46
    s_add_u32 s46, s46, 1024
    buffer_load_dwordx4 v18, s[12:15], s45 offen nt lds
    s_add_u32 s45, s45, 28672
    s_waitcnt vmcnt(12)
    s_add_u32 s47, s47, 1
    s_getreg_b32 s35, hwreg(HW_REG_IB_STS)
    s_bfe_u32 s48, s35, 0x20016
    s_and_b32 s35, s35, 15
    s_lshl4_add_u32 s35, s48, s35
    s_add_u32 s35, s35, 3
    s_lshr_b32 s35, s35, 2
    s_sub_u32 s35, s47, s35
    v_mov_b32 v16, s35
    s_mov_b64 exec, 1
    ds_max_i32 v7, v16
    s_mov_b64 exec, -1
    s_cmp_lt_u32 s47, 5
    s_cbranch_scc1 M_ld3
M_ld5:
    s_mov_b32 m0, s46
    s_add_u32 s46, s46, 1024
    buffer_load_dwordx4 v8, s[12:15], s45 offen nt lds
    s_add_u32 s45, s45, 28672
    s_waitcnt vmcnt(28)
    s_mov_b32 m0, s46
    s_add_u32 s46, s46, 1024
    buffer_load_dwordx4 v18, s[12:15], s45 offen nt lds
    s_add_u32 s45, s45, 28672
    s_waitcnt vmcnt(28)
    s_mov_b32 m0, s46
    s_add_u32 s46, s46, 1024
    buffer_load_dwordx4 v8, s[12:15], s45 offen nt lds
    s_add_u32 s45, s45, 28672
    s_waitcnt vmcnt(28)
    s_mov_b32 m0, s46
    s_add_u32 s46, s46, 1024
    buffer_load_dwordx4 v18, s[12:15], s45 offen nt lds
    s_add_u32 s45, s45, 28672
    s_waitcnt vmcnt(28)
    s_add_u32 s47, s47, 1
    s_getreg_b32 s35, hwreg(HW_REG_IB_STS)
    s_bfe_u32 s48, s35, 0x20016
    s_and_b32 s35, s35, 15
    s_lshl4_add_u32 s35, s48, s35
    s_add_u32 s35, s35, 3
    s_lshr_b32 s35, s35, 2
    s_sub_u32 s35, s47, s35
    v_mov_b32 v16, s35
    s_mov_b64 exec, 1
    ds_max_i32 v7, v16
    s_mov_b64 exec, -1
    s_cmp_lt_u32 s47, 8
    s_cbranch_scc1 M_ld5
    s_mov_b32 s20, s42
    s_and_b32 s21, s43, 0xffff
    s_mov_b32 s22, 7340032
    s_mov_b32 s23, 0x20000
    v_lshrrev_b32 v9, 5, v2
    v_and_b32 v10, 31, v2
    v_add_u32 v11, 0, v9
    v_lshlrev_b32 v12, 1, v11
    v_xor_b32 v12, v12, v10
    v_lshlrev_b32 v12, 4, v12
    v_lshl_add_u32 v12, v11, 11, v12
    v_add_u32 v11, 2, v9
    v_lshlrev_b32 v13, 1, v11
    v_xor_b32 v13, v13, v10
    v_lshlrev_b32 v13, 4, v13
    v_lshl_add_u32 v13, v11, 11, v13
    v_add_u32 v11, 4, v9
    v_lshlrev_b32 v14, 1, v11
    v_xor_b32 v14, v14, v10
    v_lshlrev_b32 v14, 4, v14
    v_lshl_add_u32 v14, v11, 11, v14
    v_add_u32 v11, 6, v9
    v_lshlrev_b32 v15, 1, v11
    v_xor_b32 v15, v15, v10
    v_lshlrev_b32 v15, 4, v15
    v_lshl_add_u32 v15, v11, 11, v15
    s_lshl_b32 s44, s29, 17
    s_lshl_b32 s35, s30, 9
    s_add_u32 s44, s44, s35
    s_mov_b32 s46, 34048
    s_xor_b32 s45, s34, 512
M_ld8:
    s_mov_b32 m0, s46
    s_add_u32 s46, s46, 1024
    buffer_load_dwordx4 v8, s[16:19], s45 offen nt lds
    s_add_u32 s45, s45, 28672
    s_waitcnt vmcnt(28)
    s_mov_b32 m0, s46
    s_add_u32 s46, s46, 1024
    buffer_load_dwordx4 v18, s[16:19], s45 offen nt lds
    s_add_u32 s45, s45, 28672
    s_waitcnt vmcnt(28)
    s_mov_b32 m0, s46
    s_add_u32 s46, s46, 1024
    buffer_load_dwordx4 v8, s[16:19], s45 offen nt lds
    s_add_u32 s45, s45, 28672
    s_waitcnt vmcnt(28)
    s_mov_b32 m0, s46
    s_add_u32 s46, s46, 1024
    buffer_load_dwordx4 v18, s[16:19], s45 offen nt lds
    s_add_u32 s45, s45, 28672
    s_waitcnt vmcnt(28)
    s_add_u32 s47, s47, 1
    s_getreg_b32 s35, hwreg(HW_REG_IB_STS)
    s_bfe_u32 s48, s35, 0x20016
    s_and_b32 s35, s35, 15
    s_lshl4_add_u32 s35, s48, s35
    s_add_u32 s35, s35, 3
    s_lshr_b32 s35, s35, 2
    s_sub_u32 s35, s47, s35
    v_mov_b32 v16, s35
    s_mov_b64 exec, 1
    ds_max_i32 v7, v16
    s_mov_b64 exec, -1
    s_cmp_lt_u32 s47, 16
    s_cbranch_scc1 M_ld8
    v_mov_b32 v20, 1156
    s_mov_b32 s62, 0
M_wgc:
    ds_read_b32 v21, v20
    s_waitcnt lgkmcnt(0)
    v_cmp_gt_u32 vcc, 4, v21
    s_add_u32 s62, s62, 1
    s_cbranch_vccz M_wgc_d
    s_sleep 1
    s_cmp_lt_u32 s62, 1000000
    s_cbranch_scc1 M_wgc
M_wgc_d:
    s_mov_b32 s46, 1280
M_ld16:
    s_mov_b32 m0, s46
    s_add_u32 s46, s46, 1024
    buffer_load_dwordx4 v12, s[20:23], s44 offen nt lds
    s_waitcnt vmcnt(28)
    s_mov_b32 m0, s46
    s_add_u32 s46, s46, 1024
    buffer_load_dwordx4 v13, s[20:23], s44 offen nt lds
    s_waitcnt vmcnt(28)
    s_mov_b32 m0, s46
    s_add_u32 s46, s46, 1024
    buffer_load_dwordx4 v14, s[20:23], s44 offen nt lds
    s_waitcnt vmcnt(28)
    s_mov_b32 m0, s46
    s_add_u32 s46, s46, 1024
    buffer_load_dwordx4 v15, s[20:23], s44 offen nt lds
    s_waitcnt vmcnt(28)
    s_add_u32 s44, s44, 16384
    s_add_u32 s47, s47, 1
    s_getreg_b32 s35, hwreg(HW_REG_IB_STS)
    s_bfe_u32 s48, s35, 0x20016
    s_and_b32 s35, s35, 15
    s_lshl4_add_u32 s35, s48, s35
    s_add_u32 s35, s35, 3
    s_lshr_b32 s35, s35, 2
    s_sub_u32 s35, s47, s35
    v_mov_b32 v16, s35
    s_mov_b64 exec, 1
    ds_max_i32 v7, v16
    s_mov_b64 exec, -1
    s_cmp_lt_u32 s47, 22
    s_cbranch_scc1 M_ld16
    v_mov_b32 v20, 1176
    s_mov_b32 s62, 0
M_wgd:
    ds_read_b32 v21, v20
    s_waitcnt lgkmcnt(0)
    v_cmp_gt_u32 vcc, 7, v21
    s_add_u32 s62, s62, 1
    s_cbranch_vccz M_wgd_d
    s_sleep 1
    s_cmp_lt_u32 s62, 1000000
    s_cbranch_scc1 M_wgd
M_wgd_d:
M_ld22:
    s_mov_b32 m0, s46
    s_add_u32 s46, s46, 1024
    buffer_load_dwordx4 v12, s[20:23], s44 offen nt lds
    s_waitcnt vmcnt(28)
    s_mov_b32 m0, s46
    s_add_u32 s46, s46, 1024
    buffer_load_dwordx4 v13, s[20:23], s44 offen nt lds
    s_waitcnt vmcnt(28)
    s_mov_b32 m0, s46
    s_add_u32 s46, s46, 1024
    buffer_load_dwordx4 v14, s[20:23], s44 offen nt lds
    s_waitcnt vmcnt(28)
    s_mov_b32 m0, s46
    s_add_u32 s46, s46, 1024
    buffer_load_dwordx4 v15, s[20:23], s44 offen nt lds
    s_waitcnt vmcnt(28)
    s_add_u32 s44, s44, 16384
    s_add_u32 s47, s47, 1
    s_getreg_b32 s35, hwreg(HW_REG_IB_STS)
    s_bfe_u32 s48, s35, 0x20016
    s_and_b32 s35, s35, 15
    s_lshl4_add_u32 s35, s48, s35
    s_add_u32 s35, s35, 3
    s_lshr_b32 s35, s35, 2
    s_sub_u32 s35, s47, s35
    v_mov_b32 v16, s35
    s_mov_b64 exec, 1
    ds_max_i32 v7, v16
    s_mov_b64 exec, -1
    s_cmp_lt_u32 s47, 24
    s_cbranch_scc1 M_ld22
    s_mov_b64 exec, 1
    v_mov_b32 v16, 18
    s_waitcnt vmcnt(24)
    ds_max_i32 v7, v16
    v_mov_b32 v16, 19
    s_waitcnt vmcnt(20)
    ds_max_i32 v7, v16
    v_mov_b32 v16, 20
    s_waitcnt vmcnt(16)
    ds_max_i32 v7, v16
    v_mov_b32 v16, 21
    s_waitcnt vmcnt(12)
    ds_max_i32 v7, v16
    v_mov_b32 v16, 22
    s_waitcnt vmcnt(8)
    ds_max_i32 v7, v16
    v_mov_b32 v16, 23
    s_waitcnt vmcnt(4)
    ds_max_i32 v7, v16
    v_mov_b32 v16, 24
    s_waitcnt vmcnt(0)
    ds_write_b32 v7, v16
    s_waitcnt lgkmcnt(0)
    s_barrier
    s_branch L_fin
M_comp:
    s_mov_b32 s62, 0
M_box:
    ds_read_b64 v[8:9], v7 offset:16
    s_waitcnt lgkmcnt(0)
    v_cmp_gt_u32 vcc, 7, v9
    s_add_u32 s62, s62, 1
    s_cbranch_vccz M_box_d
    s_cmp_lt_u32 s62, 1000000
    s_cbranch_scc1 M_box
M_box_d:
    v_readfirstlane_b32 s48, v8
    s_nop 0
    s_and_b32 s34, s48, 2047
    s_lshl_b32 s34, s34, 11
    s_add_u32 s34, s34, s6
    s_load_dwordx16 s[64:79], s[4:5], s34
    s_and_b32 s50, s48, 7
    s_bfe_u32 s34, s48, 0x40003
    s_lshl4_add_u32 s50, s50, s34
    s_bfe_u32 s34, s48, 0x40007
    s_lshl4_add_u32 s50, s50, s34
    s_lshl3_add_u32 s50, s50, 24576
    s_load_dwordx2 s[52:53], s[10:11], s50
    s_mov_b32 s33, s16
    s_mov_b64 s[24:25], s[10:11]
    s_mov_b32 s26, 268435456
    s_mov_b32 s27, 0x20000
    s_mov_b32 s44, 262144
    s_mov_b32 s45, s7
    v_mov_b32 v8, 1
    s_waitcnt lgkmcnt(0)
    v_writelane_b32 v11, s64, 0
    v_writelane_b32 v11, s65, 1
    v_writelane_b32 v11, s66, 4
    v_writelane_b32 v11, s67, 5
    v_writelane_b32 v11, s68, 8
    v_writelane_b32 v11, s69, 9
    v_writelane_b32 v11, s70, 12
    v_writelane_b32 v11, s71, 13
    v_writelane_b32 v11, s72, 2
    v_writelane_b32 v11, s73, 3
    v_writelane_b32 v11, s74, 6
    v_writelane_b32 v11, s75, 7
    v_writelane_b32 v11, s76, 10
    v_writelane_b32 v11, s77, 11
    v_writelane_b32 v11, s78, 14
    v_writelane_b32 v11, s79, 15
    s_mov_b64 exec, 0xffff
    ds_write_b32 v113, v11 offset:0
    s_mov_b64 exec, 1
    ds_add_u32 v7, v8 offset:8
    s_mov_b64 exec, -1
    s_mov_b32 s62, 0
M_wx:
    ds_read_b128 v[8:11], v7
    s_waitcnt lgkmcnt(0)
    v_cmp_gt_u32 vcc, 4, v10
    s_add_u32 s62, s62, 1
    s_cbranch_vccz M_wx_d
    s_cmp_lt_u32 s62, 1000000
    s_cbranch_scc1 M_wx
M_wx_d:
    ds_read_b128 v[80:83], v15 offset:0
    ds_read_b128 v[84:87], v15 offset:64
    ds_read_b128 v[88:91], v15 offset:128
    ds_read_b128 v[92:95], v15 offset:192
    v_readfirstlane_b32 s56, v8
    s_nop 0
    s_cmp_ge_u32 s56, 10
    s_cbranch_scc1 M_wu0_k
    s_mov_b32 s62, 0
M_wu0:
    ds_read_b32 v8, v7
    s_waitcnt lgkmcnt(0)
    v_cmp_gt_u32 vcc, 10, v8
    s_add_u32 s62, s62, 1
    s_cbranch_vccz M_wu0_d
    s_sleep 1
    s_cmp_lt_u32 s62, 1000000
    s_cbranch_scc1 M_wu0
M_wu0_d:
    v_readfirstlane_b32 s56, v8
M_wu0_k:
    ds_read_b64_tr_b16 v[48:49], v12 offset:34048
    ds_read_b64_tr_b16 v[50:51], v12 offset:38144
    ds_read_b64_tr_b16 v[64:65], v126 offset:34048
    ds_read_b64_tr_b16 v[66:67], v126 offset:38144
    s_waitcnt lgkmcnt(4)
    v_mfma_f32_16x16x32_bf16 v[96:99], v[80:83], v[16:19], 0
    v_mfma_f32_16x16x32_bf16 v[104:107], v[80:83], v[32:35], 0
    v_mfma_f32_16x16x32_bf16 v[96:99], v[84:87], v[20:23], v[96:99]
    v_mfma_f32_16x16x32_bf16 v[104:107], v[84:87], v[36:39], v[104:107]
    v_mfma_f32_16x16x32_bf16 v[96:99], v[88:91], v[24:27], v[96:99]
    v_mfma_f32_16x16x32_bf16 v[104:107], v[88:91], v[40:43], v[104:107]
    v_mfma_f32_16x16x32_bf16 v[96:99], v[92:95], v[28:31], v[96:99]
    v_mfma_f32_16x16x32_bf16 v[104:107], v[92:95], v[44:47], v[104:107]
    s_mov_b32 s62, 0
M_sta:
    s_cmp_eq_u32 s53, s33
    s_cbranch_scc1 M_sta_d
    s_load_dwordx2 s[52:53], s[10:11], s50 glc
    s_add_u32 s62, s62, 1
    s_cmp_lt_u32 s62, 200000
    s_waitcnt lgkmcnt(0)
    s_cbranch_scc1 M_sta
M_sta_d:
    s_lshl_b32 s54, s52, 16
    s_and_b32 s52, s52, 0xffff0000
    v_mov_b32 v124, 0x3727c5ac
    v_add_f32 v124, s52, v124
    v_cvt_pk_bf16_f32 v124, v124, v124
    v_lshlrev_b32 v124, 16, v124
    v_sqrt_f32 v124, v124
    s_nop 0
    v_cvt_pk_bf16_f32 v124, v124, v124
    v_lshlrev_b32 v124, 16, v124
    v_rcp_f32 v124, v124
    s_cmp_ge_u32 s56, 12
    s_cbranch_scc1 M_wu1_k
    s_mov_b32 s62, 0
M_wu1:
    ds_read_b32 v8, v7
    s_waitcnt lgkmcnt(0)
    v_cmp_gt_u32 vcc, 12, v8
    s_add_u32 s62, s62, 1
    s_cbranch_vccz M_wu1_d
    s_sleep 1
    s_cmp_lt_u32 s62, 1000000
    s_cbranch_scc1 M_wu1
M_wu1_d:
    v_readfirstlane_b32 s56, v8
M_wu1_k:
    ds_read_b64_tr_b16 v[52:53], v12 offset:42240
    ds_read_b64_tr_b16 v[54:55], v12 offset:46336
    ds_read_b64_tr_b16 v[68:69], v126 offset:42240
    ds_read_b64_tr_b16 v[70:71], v126 offset:46336
    s_waitcnt lgkmcnt(4)
    v_mfma_f32_16x16x32_bf16 v[100:103], v[80:83], v[48:51], 0
    v_mfma_f32_16x16x32_bf16 v[108:111], v[80:83], v[64:67], 0
    s_cmp_ge_u32 s56, 14
    s_cbranch_scc1 M_wu2_k
    s_mov_b32 s62, 0
M_wu2:
    ds_read_b32 v8, v7
    s_waitcnt lgkmcnt(0)
    v_cmp_gt_u32 vcc, 14, v8
    s_add_u32 s62, s62, 1
    s_cbranch_vccz M_wu2_d
    s_sleep 1
    s_cmp_lt_u32 s62, 1000000
    s_cbranch_scc1 M_wu2
M_wu2_d:
    v_readfirstlane_b32 s56, v8
M_wu2_k:
    ds_read_b64_tr_b16 v[56:57], v12 offset:50432
    ds_read_b64_tr_b16 v[58:59], v12 offset:54528
    ds_read_b64_tr_b16 v[72:73], v126 offset:50432
    ds_read_b64_tr_b16 v[74:75], v126 offset:54528
    s_waitcnt lgkmcnt(4)
    v_mfma_f32_16x16x32_bf16 v[100:103], v[84:87], v[52:55], v[100:103]
    v_mfma_f32_16x16x32_bf16 v[108:111], v[84:87], v[68:71], v[108:111]
    s_cmp_ge_u32 s56, 16
    s_cbranch_scc1 M_wu3_k
    s_mov_b32 s62, 0
M_wu3:
    ds_read_b32 v8, v7
    s_waitcnt lgkmcnt(0)
    v_cmp_gt_u32 vcc, 16, v8
    s_add_u32 s62, s62, 1
    s_cbranch_vccz M_wu3_d
    s_cmp_lt_u32 s62, 1000000
    s_cbranch_scc1 M_wu3
M_wu3_d:
    v_readfirstlane_b32 s56, v8
M_wu3_k:
    ds_read_b64_tr_b16 v[60:61], v12 offset:58624
    ds_read_b64_tr_b16 v[62:63], v12 offset:62720
    ds_read_b64_tr_b16 v[76:77], v126 offset:58624
    ds_read_b64_tr_b16 v[78:79], v126 offset:62720
    s_waitcnt lgkmcnt(4)
    v_mfma_f32_16x16x32_bf16 v[100:103], v[88:91], v[56:59], v[100:103]
    v_mfma_f32_16x16x32_bf16 v[108:111], v[88:91], v[72:75], v[108:111]
    s_waitcnt lgkmcnt(2)
    v_mfma_f32_16x16x32_bf16 v[100:103], v[92:95], v[60:63], v[100:103]
    s_waitcnt lgkmcnt(0)
    v_mfma_f32_16x16x32_bf16 v[108:111], v[92:95], v[76:79], v[108:111]
    v_mov_b32 v9, 1
    v_mov_b32_dpp v96, v104 quad_perm:[0,1,2,3] row_mask:0x2 bank_mask:0xf
    v_mov_b32_dpp v97, v105 quad_perm:[0,1,2,3] row_mask:0x2 bank_mask:0xf
    s_nop 2
    v_mov_b32_dpp v96, v100 quad_perm:[0,1,2,3] row_mask:0x4 bank_mask:0xf
    v_mov_b32_dpp v97, v101 quad_perm:[0,1,2,3] row_mask:0x4 bank_mask:0xf
    s_nop 0
    v_mov_b32_dpp v96, v108 quad_perm:[0,1,2,3] row_mask:0x8 bank_mask:0xf
    v_mov_b32_dpp v97, v109 quad_perm:[0,1,2,3] row_mask:0x8 bank_mask:0xf
    v_fma_f32 v96, -v97, s54, v96
    v_mul_f32 v96, v96, v124
    buffer_store_dword v96, v114, s[24:27], s44 offen sc1
    s_mov_b64 exec, 1
    ds_add_u32 v7, v9 offset:12
    s_mov_b64 exec, -1
    v_mov_b32 v8, 1152
    s_mov_b32 s62, 0
M_wd0:
    ds_read_b32 v9, v8
    s_waitcnt lgkmcnt(0)
    v_cmp_gt_u32 vcc, 20, v9
    s_add_u32 s62, s62, 1
    s_cbranch_vccz M_wd0_d
    s_sleep 1
    s_cmp_lt_u32 s62, 1000000
    s_cbranch_scc1 M_wd0
M_wd0_d:
    ds_read_b64_tr_b16 v[16:17], v120 offset:1280
    ds_read_b64_tr_b16 v[18:19], v120 offset:9472
    ds_read_b64_tr_b16 v[24:25], v121 offset:1280
    ds_read_b64_tr_b16 v[26:27], v121 offset:9472
    ds_read_b64_tr_b16 v[32:33], v122 offset:1280
    ds_read_b64_tr_b16 v[34:35], v122 offset:9472
    ds_read_b64_tr_b16 v[40:41], v123 offset:1280
    ds_read_b64_tr_b16 v[42:43], v123 offset:9472
    v_mov_b32 v8, 1152
    s_mov_b32 s62, 0
M_wd1:
    ds_read_b32 v9, v8
    s_waitcnt lgkmcnt(0)
    v_cmp_gt_u32 vcc, 24, v9
    s_add_u32 s62, s62, 1
    s_cbranch_vccz M_wd1_d
    s_cmp_lt_u32 s62, 1000000
    s_cbranch_scc1 M_wd1
M_wd1_d:
    ds_read_b64_tr_b16 v[20:21], v120 offset:17664
    ds_read_b64_tr_b16 v[22:23], v120 offset:25856
    ds_read_b64_tr_b16 v[28:29], v121 offset:17664
    ds_read_b64_tr_b16 v[30:31], v121 offset:25856
    ds_read_b64_tr_b16 v[36:37], v122 offset:17664
    ds_read_b64_tr_b16 v[38:39], v122 offset:25856
    ds_read_b64_tr_b16 v[44:45], v123 offset:17664
    s_waitcnt lgkmcnt(4)
    ds_read_b64_tr_b16 v[46:47], v123 offset:25856
    v_lshlrev_b32 v8, 2, v2
    s_waitcnt lgkmcnt(0)
    s_barrier
    ds_read_b128 v[80:83], v14 offset:1024
    ds_read_b128 v[84:87], v14 offset:1088
    s_waitcnt lgkmcnt(1)
    v_mfma_f32_16x16x32_bf16 v[48:51], v[80:83], v[16:19], 0
    v_mfma_f32_16x16x32_bf16 v[52:55], v[80:83], v[24:27], 0
    v_mfma_f32_16x16x32_bf16 v[56:59], v[80:83], v[32:35], 0
    v_mfma_f32_16x16x32_bf16 v[60:63], v[80:83], v[40:43], 0
    s_waitcnt lgkmcnt(0)
    v_mfma_f32_16x16x32_bf16 v[48:51], v[84:87], v[20:23], v[48:51]
    v_mfma_f32_16x16x32_bf16 v[52:55], v[84:87], v[28:31], v[52:55]
    v_mfma_f32_16x16x32_bf16 v[56:59], v[84:87], v[36:39], v[56:59]
    v_mfma_f32_16x16x32_bf16 v[60:63], v[84:87], v[44:47], v[60:63]
    s_nop 5
    v_mov_b32_dpp v48, v52 quad_perm:[0,1,2,3] row_mask:0x2 bank_mask:0xf
    s_nop 1
    v_mov_b32_dpp v48, v56 quad_perm:[0,1,2,3] row_mask:0x4 bank_mask:0xf
    s_nop 1
    v_mov_b32_dpp v48, v60 quad_perm:[0,1,2,3] row_mask:0x8 bank_mask:0xf
    buffer_store_dword v48, v8, s[24:27], s45 offen sc1
    s_branch L_fin
M_poller:
    s_cmp_ge_u32 s28, 64
    s_cbranch_scc1 M_nores
    s_mov_b32 s62, 0
M_pbox:
    ds_read_b64 v[8:9], v7 offset:16
    s_waitcnt lgkmcnt(0)
    v_cmp_gt_u32 vcc, 7, v9
    s_add_u32 s62, s62, 1
    s_cbranch_vccz M_pbox_d
    s_cmp_lt_u32 s62, 1000000
    s_cbranch_scc1 M_pbox
M_pbox_d:
    v_readfirstlane_b32 s48, v8
    v_mov_b32 v9, s33
    v_mov_b32 v10, 0
    s_lshr_b32 s34, s28, 5
    s_add_u32 s34, s34, s28
    s_and_b32 s34, s34, 31
    s_lshl_b32 s34, s34, 7
    s_add_u32 s34, s34, 4096
    s_mov_b64 exec, 1
    buffer_store_dwordx2 v[8:9], v10, s[24:27], s34 offen sc1
    s_mov_b64 exec, -1
M_nores:
    v_lshlrev_b32 v9, 4, v2
    v_and_b32 v12, 8, v2
    v_lshl_add_u32 v12, v12, 2, v4
    v_and_b32 v11, 3, v2
    v_lshl_add_u32 v12, v11, 3, v12
    v_and_b32 v11, 4, v2
    v_add_lshl_u32 v12, v12, v11, 1
    s_lshl_b32 s44, s29, 12
    s_add_u32 s44, s44, 262144
    s_lshl_b32 s46, s28, 7
    s_add_u32 s46, s46, 720896
    s_lshl_b32 s47, s33, 4
    s_lshr_b32 s35, s28, 3
    s_cmp_ge_u32 s35, 14
    s_cselect_b32 s34, 18, 0
    s_add_u32 s35, s35, s34
    s_and_b32 s34, s28, 7
    s_lshl_b32 s34, s34, 8
    s_add_u32 s34, s34, s35
    s_lshl2_add_u32 s55, s34, 753664
    v_lshlrev_b32 v40, 8, v2
    v_mov_b32 v41, s33
    s_and_b32 s34, s28, 0xe8
    s_lshl_b32 s34, s34, 5
    s_bfe_u32 s35, s28, 0x10004
    s_lshl3_add_u32 s34, s35, s34
    s_and_b32 s35, s28, 7
    s_add_u32 s34, s34, s35
    s_lshl2_add_u32 s54, s34, 720896
    v_and_b32 v42, 8, v2
    v_add_lshl_u32 v42, v42, v2, 7
    v_mov_b32 v14, 1172
    s_mov_b32 s62, 0
M_pu:
    ds_read_b32 v15, v14
    s_waitcnt lgkmcnt(0)
    v_cmp_gt_u32 vcc, 7, v15
    s_add_u32 s62, s62, 1
    s_cbranch_vccz M_pu_d
    s_sleep 1
    s_cmp_lt_u32 s62, 1000000
    s_cbranch_scc1 M_pu
M_pu_d:
    v_mov_b32 v14, 1152
    s_mov_b32 s62, 0
M_pv:
    ds_read_b32 v15, v14
    s_waitcnt lgkmcnt(0)
    v_cmp_gt_u32 vcc, 14, v15
    s_add_u32 s62, s62, 1
    s_cbranch_vccz M_pv_d
    s_sleep 1
    s_cmp_lt_u32 s62, 1000000
    s_cbranch_scc1 M_pv
M_pv_d:
    s_mov_b64 exec, 0xffff
    buffer_store_dword v41, v42, s[24:27], s54 offen sc1
    s_mov_b64 exec, -1
    s_mov_b32 s62, 0
M_hint:
    s_load_dwordx16 s[64:79], s[10:11], s46 glc
    s_waitcnt lgkmcnt(0)
    s_add_u32 s64, s64, s65
    s_add_u32 s64, s64, s66
    s_add_u32 s64, s64, s67
    s_add_u32 s64, s64, s68
    s_add_u32 s64, s64, s69
    s_add_u32 s64, s64, s70
    s_add_u32 s64, s64, s71
    s_add_u32 s64, s64, s72
    s_add_u32 s64, s64, s73
    s_add_u32 s64, s64, s74
    s_add_u32 s64, s64, s75
    s_add_u32 s64, s64, s76
    s_add_u32 s64, s64, s77
    s_add_u32 s64, s64, s78
    s_add_u32 s64, s64, s79
    s_cmp_eq_u32 s64, s47
    s_cbranch_scc1 M_hint_d
    s_add_u32 s62, s62, 1
    s_cmp_lt_u32 s62, 200000
    s_cbranch_scc1 M_hint
M_hint_d:
    buffer_load_dwordx4 v[16:19], v9, s[24:27], s44 offen offset:0 sc1
    buffer_load_dwordx4 v[20:23], v9, s[24:27], s44 offen offset:1024 sc1
    buffer_load_dwordx4 v[24:27], v9, s[24:27], s44 offen offset:2048 sc1
    buffer_load_dwordx4 v[28:31], v9, s[24:27], s44 offen offset:3072 sc1
    v_mov_b32 v14, 1152
    s_mov_b32 s62, 0
M_pw:
    ds_read_b32 v15, v14
    s_waitcnt lgkmcnt(0)
    v_cmp_gt_u32 vcc, 20, v15
    s_add_u32 s62, s62, 1
    s_cbranch_vccz M_pw_d
    s_cmp_lt_u32 s62, 1000000
    s_cbranch_scc1 M_pw
M_pw_d:
    s_mov_b64 exec, 0xf
    buffer_store_dword v41, v40, s[24:27], s55 offen sc1
    s_mov_b64 exec, -1
    s_mov_b32 s62, 0
    s_waitcnt vmcnt(1)
    s_branch M_ph_c
    s_mov_b32 s62, 0
M_ph:
    buffer_load_dwordx4 v[16:19], v9, s[24:27], s44 offen offset:0 sc1
    buffer_load_dwordx4 v[20:23], v9, s[24:27], s44 offen offset:1024 sc1
    buffer_load_dwordx4 v[24:27], v9, s[24:27], s44 offen offset:2048 sc1
    buffer_load_dwordx4 v[28:31], v9, s[24:27], s44 offen offset:3072 sc1
    s_waitcnt vmcnt(0)
M_ph_c:
    v_pk_add_f32 v[32:33], v[16:17], v[20:21]
    v_pk_add_f32 v[34:35], v[18:19], v[22:23]
    v_pk_add_f32 v[36:37], v[24:25], v[28:29]
    v_pk_add_f32 v[38:39], v[26:27], v[30:31]
    v_permlane16_swap_b32 v32, v33
    v_permlane16_swap_b32 v34, v35
    v_permlane16_swap_b32 v36, v37
    v_permlane16_swap_b32 v38, v39
    v_add_f32 v32, v32, v33
    v_add_f32 v34, v34, v35
    v_add_f32 v36, v36, v37
    v_add_f32 v38, v38, v39
    v_permlane32_swap_b32 v32, v34
    s_nop 0
    v_permlane32_swap_b32 v36, v38
    v_add_f32 v32, v32, v34
    v_add_f32 v36, v36, v38
    v_cmp_u_f32 vcc, v32, v36
    v_mul_f32 v33, 0xbfb8aa3b, v32
    s_cbranch_vccz M_ph_d
    v_max_u32 v34, v16, v17
    v_max3_u32 v34, v34, v18, v19
    v_max3_u32 v34, v34, v20, v21
    v_max3_u32 v34, v34, v22, v23
    v_max3_u32 v34, v34, v24, v25
    v_max3_u32 v34, v34, v26, v27
    v_max3_u32 v34, v34, v28, v29
    v_max3_u32 v34, v34, v30, v31
    v_cmp_eq_u32 vcc, -1, v34
    s_add_u32 s62, s62, 1
    s_cbranch_vccz M_ph_d
    s_cmp_lt_u32 s62, 200000
    s_cbranch_scc1 M_ph
M_ph_d:
    v_exp_f32 v33, v33
    v_mul_f32 v16, v32, v36
    v_add_f32 v33, 1.0, v33
    v_rcp_f32 v33, v33
    s_nop 0
    v_mul_f32 v16, v16, v33
    v_cvt_pk_bf16_f32 v16, v16, v16
    ds_write_b16 v12, v16 offset:1024
    s_waitcnt lgkmcnt(0)
    s_barrier
L_fin:
L_end:
    s_endpgm
.section .rodata,"a"
.p2align 6
.amdhsa_kernel recurrent_scan__spectral_fnet__moe_arch_mod__prompt_kernel
  .amdhsa_next_free_vgpr 128
  .amdhsa_next_free_sgpr 102
  .amdhsa_accum_offset 128
  .amdhsa_group_segment_fixed_size 0
  .amdhsa_kernarg_size 104
  .amdhsa_user_sgpr_count 2
  .amdhsa_user_sgpr_kernarg_segment_ptr 1
  .amdhsa_system_sgpr_workgroup_id_x 1
.end_amdhsa_kernel
```

```asm
; @launch grid=(480,1,1) block=(512,1,1) lds=67072
.amdgcn_target "amdgcn-amd-amdhsa--gfx950"
.text
.globl recurrent_scan__spectral_fnet__moe_arch_mod__prompt_kernel
.p2align 8
.type recurrent_scan__spectral_fnet__moe_arch_mod__prompt_kernel,@function
recurrent_scan__spectral_fnet__moe_arch_mod__prompt_kernel:
    s_cmp_ge_u32 s2, 480
    s_cbranch_scc1 L_end
    s_load_dwordx2 s[4:5], s[0:1], 0
    s_load_dwordx2 s[10:11], s[0:1], 96
    s_load_dwordx8 s[36:43], s[0:1], 48
    s_load_dwordx2 s[8:9], s[0:1], 80
    v_lshrrev_b32 v1, 6, v0
    v_and_b32 v2, 63, v0
    v_readfirstlane_b32 s3, v1
    v_and_b32 v3, 15, v0
    v_lshrrev_b32 v4, 4, v2
    s_cmp_ge_u32 s2, 256
    s_cbranch_scc1 M_first
    s_cmp_lg_u32 s3, 0
    s_cbranch_scc1 L_nopf
    s_getpc_b64 s[6:7]
L_pc:
    s_mov_b32 m0, 66816
    s_bfe_u32 s34, s2, 0x20003
    s_lshl_b32 s34, s34, 12
    v_lshl_add_u32 v8, v0, 7, s34
    v_min_u32 v8, L_end-L_pc, v8
    s_mov_b32 exec_hi, 0
    global_load_lds_dword v8, s[6:7]
    s_mov_b32 exec_hi, -1
L_nopf:
    s_and_b32 s28, s2, 7
    s_bfe_u32 s44, s2, 0x10003
    s_lshr_b32 s45, s2, 4
    s_xor_b32 s30, s45, 15
    s_lshl3_add_u32 s30, s30, s28
    s_cmp_eq_u32 s30, 0
    s_cselect_b32 s46, 1, 0
    s_cmp_eq_u32 s2, 248
    s_cselect_b32 s30, 128, s30
    s_lshl_b32 s31, s3, 8
    s_add_u32 s31, s31, s30
    s_sub_u32 s32, 0, s31
    s_and_b32 s32, s32, 2047
    s_cmp_eq_u32 s44, 0
    s_cselect_b32 s47, s31, s32
    s_cselect_b32 s48, s32, s31
    s_lshl_b32 s49, s47, 11
    s_lshl_b32 s48, s48, 11
    v_lshrrev_b32 v5, 3, v2
    v_and_b32 v5, 2, v5
    v_xor_b32 v5, v5, v2
    v_lshlrev_b32 v5, 4, v5
    s_lshl_b32 s53, s3, 12
    s_lshl_b32 s14, 1, 22
    s_mov_b32 s15, 0x20000
    s_movk_i32 s18, 2048
    s_mov_b32 s19, s15
    s_mov_b32 m0, 41216
    s_cmp_lg_u32 s3, 0
    s_waitcnt lgkmcnt(0)
    s_mov_b64 s[12:13], s[4:5]
    s_load_dword s33, s[10:11], 0
    s_cbranch_scc1 F_nowr
    s_mov_b64 s[16:17], s[36:37]
    buffer_load_dwordx4 v5, s[16:19], 0 offen lds
    buffer_load_dwordx4 v5, s[16:19], 0 offen offset:1024 lds
F_nowr:
    s_mov_b32 m0, s53
    s_mov_b64 s[24:25], s[10:11]
    buffer_load_dwordx4 v5, s[12:15], s49 offen lds
    buffer_load_dwordx4 v5, s[12:15], s49 offen offset:1024 lds
    s_branch F_go
M_first:
    s_cmp_lg_u32 s3, 0
    s_cbranch_scc1 M_entry
    s_setprio 3
    s_lshr_b32 s29, s2, 1
    s_xor_b32 s29, s29, s2
    s_and_b32 s29, s29, 8
    s_mul_i32 s29, s29, 3
    s_xor_b32 s28, s2, s29
    s_bitset0_b32 s28, 8
    v_mul_u32_u24 v8, 7168, v4
    v_lshlrev_b32 v9, 1, v4
    v_xor_b32 v9, v9, v3
    v_lshl_add_u32 v8, v9, 4, v8
    s_and_b32 s34, s28, 7
    s_mulk_i32 s34, 3584
    s_lshr_b32 s35, s28, 3
    s_add_u32 s34, s34, s35
    s_lshl_b32 s34, s34, 8
    s_mov_b32 s14, 7340032
    s_mov_b32 s15, 0x20000
    s_movk_i32 s46, 1280
    s_mov_b32 s45, s34
    s_waitcnt lgkmcnt(0)
    s_mov_b64 s[12:13], s[38:39]
M_burst:
    s_mov_b32 m0, s46
    s_addk_i32 s46, 1024
    buffer_load_dwordx4 v8, s[12:15], s45 offen nt lds
    s_addk_i32 s45, 28672
    v_xor_b32 v8, 128, v8
    s_cmpk_lt_u32 s46, 13568
    s_cbranch_scc1 M_burst
    s_branch M_loader2
F_go:
    s_mov_b32 s26, 268435456
    s_mov_b32 s27, 0x20000
    v_lshlrev_b32 v7, 2, v0
    s_lshl_b32 s34, s2, 11
    s_add_u32 s34, s34, 262144
    v_mov_b32 v6, -1
    buffer_store_dword v6, v7, s[24:27], s34 offen sc1
    v_lshlrev_b32 v126, 4, v2
    s_and_b32 s34, s3, 1
    s_lshr_b32 s35, s3, 1
    v_lshl_add_u32 v119, s34, 3, v126
    s_cmp_eq_u32 s35, 3
    s_cbranch_scc1 F_jobr8
    s_lshl4_add_u32 s54, s44, 1
    s_cmp_eq_u32 s35, 2
    s_cselect_b32 s54, 0, s54
    s_cselect_b32 s57, 4096, 0
    s_cmp_eq_u32 s35, 1
    s_cselect_b32 s55, 0x3a800000, 0
    s_cselect_b32 s58, s46, 0
    s_cselect_b32 s57, 7168, s57
    s_cselect_b32 s55, s55, 0x3d000000
    s_lshl_b32 s34, s34, 4
    v_lshl_add_u32 v109, v4, 2, s34
    v_cvt_f32_u32 v109, v109
    v_add_u32 v119, s57, v119
F_job:
    v_add_u32 v116, s54, v3
    v_cvt_f32_u32 v116, v116
    v_mul_f32 v116, s55, v116
    v_mul_f32 v117, v116, v109
    v_cos_f32 v76, v117
    v_sin_f32 v80, v117
    v_add_f32 v117, v117, v116
    v_cos_f32 v77, v117
    v_sin_f32 v81, v117
    v_add_f32 v117, v117, v116
    v_cos_f32 v78, v117
    v_sin_f32 v82, v117
    v_add_f32 v117, v117, v116
    v_cos_f32 v79, v117
    v_sin_f32 v83, v117
    s_cmp_eq_u32 s35, 0
    s_cbranch_scc1 F_jobf1
    v_cvt_pk_f16_f32 v84, v76, v77
    v_cvt_pk_f16_f32 v85, v78, v79
    v_cvt_pk_f16_f32 v86, v80, v81
    v_cvt_pk_f16_f32 v87, v82, v83
    v_xor_b32 v88, 0x80008000, v86
    v_xor_b32 v89, 0x80008000, v87
    ds_write2st64_b64 v119, v[84:85], v[86:87] offset0:85 offset1:87
    ds_write_b64 v119, v[88:89] offset:45568
    s_cmp_eq_u32 s58, 0
    s_cbranch_scc1 F_jobd
    s_mov_b32 s58, 0
    s_xor_b32 s54, s54, 16
    v_add_u32 v119, 3072, v119
    s_branch F_job
F_jobf1:
    v_cvt_pk_bf16_f32 v84, v76, v77
    v_cvt_pk_bf16_f32 v85, v78, v79
    v_cvt_pk_bf16_f32 v86, -v80, -v81
    v_cvt_pk_bf16_f32 v87, -v82, -v83
    ds_write2st64_b64 v119, v[84:85], v[86:87] offset0:85 offset1:87
    s_branch F_jobd
F_jobr8:
    v_and_b32 v118, 7, v3
    v_cvt_f32_u32 v118, v118
    v_mul_f32 v118, 0x3e000000, v118
    v_and_b32 v117, 1, v4
    v_lshl_add_u32 v117, v117, 1, s34
    v_cvt_f32_u32 v117, v117
    v_mul_f32 v117, v117, v118
    v_add_f32 v117, v117, v117
    v_add_f32 v118, v117, v118
    v_cos_f32 v76, v117
    v_sin_f32 v77, v117
    v_cos_f32 v78, v118
    v_sin_f32 v79, v118
    v_lshrrev_b32 v116, 2, v2
    v_xor_b32 v116, v116, v2
    v_bfe_u32 v116, v116, 3, 1
    v_add_u32 v116, -1, v116
    s_lshl_b32 s34, s44, 31
    v_cvt_pk_f16_f32 v84, v76, v77
    v_cvt_pk_f16_f32 v86, -v77, v76
    v_cvt_pk_f16_f32 v85, v78, v79
    v_cvt_pk_f16_f32 v87, -v79, v78
    v_bitop3_b32 v84, v84, s34, v116 bitop3:0x28
    v_bitop3_b32 v85, v85, s34, v116 bitop3:0x28
    v_bitop3_b32 v86, v86, s34, v116 bitop3:0x28
    v_bitop3_b32 v87, v87, s34, v116 bitop3:0x28
    ds_write2st64_b64 v119, v[84:85], v[86:87] offset0:89 offset1:91
F_jobd:
    s_and_b32 s51, s47, 7
    v_mov_b32 v108, 0
    s_bfe_u32 s34, s47, 0x40003
    v_mov_b32 v109, 0
    s_lshl4_add_u32 s51, s51, s34
    v_mov_b32 v110, 0
    s_lshr_b32 s34, s47, 7
    v_mov_b32 v111, 0
    s_lshl4_add_u32 s51, s51, s34
    v_mov_b32 v7, 56832
    s_lshl3_add_u32 s51, s51, 24576
    ds_write_b128 v7, v[108:111]
    s_lshl_b32 s52, s46, 23
    v_and_b32 v96, 60, v2
    s_sub_u32 s52, 0x3e000000, s52
    v_and_b32 v97, 3, v2
    s_mov_b32 s60, 0x80000000
    v_lshl_add_u32 v96, v96, 1, v97
    s_mov_b32 s61, 0xfffff800
    v_bfe_u32 v97, v2, 4, 1
    s_mov_b32 s71, 0
    v_lshl_add_u32 v96, v97, 2, v96
    v_lshlrev_b32 v96, 3, v96
    v_xor_b32 v97, 32, v96
    v_add_u32 v92, s53, v96
    v_xor_b32 v93, 32, v92
    v_mov_b32 v68, 0x3f803f80
    v_mov_b32 v69, 0x3f803f80
    v_mov_b32 v70, 0x3f803f80
    v_mov_b32 v71, 0x3f803f80
    v_mov_b32 v125, s47
    v_mov_b32 v118, 1
    v_mov_b32 v119, 0
    s_waitcnt vmcnt(3) lgkmcnt(0)
    s_barrier
    ds_read_b64_tr_b16 v[24:25], v96 offset:41216
    ds_read_b64_tr_b16 v[26:27], v96 offset:42240
    ds_read_b64_tr_b16 v[28:29], v97 offset:41216
    ds_read_b64_tr_b16 v[30:31], v97 offset:42240
    ds_read_b128 v[32:35], v126 offset:43520
    ds_read_b128 v[36:39], v126 offset:44544
    ds_read_b128 v[40:43], v126 offset:45568
    ds_read_b128 v[44:47], v126 offset:46592
    ds_read_b128 v[48:51], v126 offset:47616
    ds_read_b128 v[52:55], v126 offset:48640
    ds_read_b128 v[56:59], v126 offset:49664
    ds_read_b128 v[60:63], v126 offset:50688
    ds_read_b128 v[64:67], v126 offset:51712
    s_mul_i32 s33, s33, 0x9e3779b1
    s_add_u32 s33, s33, 0x7f4a7c15
    s_mov_b32 s63, 0x3a800000
    v_mov_b32 v117, s33
    s_waitcnt lgkmcnt(9)
    v_mfma_f32_16x16x32_bf16 v[100:103], v[68:71], v[24:27], 0
    v_mfma_f32_16x16x32_bf16 v[100:103], v[68:71], v[28:31], v[100:103]
    s_nop 7
    v_add_f32_dpp v100, v100, v100 row_ror:8 row_mask:0xf bank_mask:0xf
    s_nop 1
    v_add_f32_dpp v100, v100, v100 row_ror:4 row_mask:0xf bank_mask:0xf
    s_nop 1
    v_add_f32_dpp v100, v100, v100 row_ror:2 row_mask:0xf bank_mask:0xf
    s_nop 1
    v_add_f32_dpp v100, v100, v100 row_ror:1 row_mask:0xf bank_mask:0xf
    s_setprio 2
    s_waitcnt vmcnt(1) lgkmcnt(0)
    s_add_u32 m0, s53, 2048
    s_nop 0
    buffer_load_dwordx4 v5, s[12:15], s48 offen lds
    buffer_load_dwordx4 v5, s[12:15], s48 offen offset:1024 lds
    ds_read_b64_tr_b16 v[8:9], v92 offset:0
    ds_read_b64_tr_b16 v[10:11], v92 offset:1024
    ds_read_b64_tr_b16 v[12:13], v93 offset:0
    ds_read_b64_tr_b16 v[14:15], v93 offset:1024
    s_waitcnt lgkmcnt(2)
    v_mfma_f32_16x16x32_bf16 v[104:107], v[68:71], v[8:11], 0
    v_dot2_f32_bf16 v110, v8, v24, v110
    v_dot2_f32_bf16 v108, v8, v8, v108
    v_dot2_f32_bf16 v110, v9, v25, v110
    v_dot2_f32_bf16 v108, v9, v9, v108
    v_dot2_f32_bf16 v110, v10, v26, v110
    v_dot2_f32_bf16 v108, v10, v10, v108
    v_dot2_f32_bf16 v110, v11, v27, v110
    v_dot2_f32_bf16 v108, v11, v11, v108
    s_waitcnt lgkmcnt(0)
    v_mfma_f32_16x16x32_bf16 v[104:107], v[68:71], v[12:15], v[104:107]
    v_dot2_f32_bf16 v110, v12, v28, v110
    v_dot2_f32_bf16 v108, v12, v12, v108
    v_dot2_f32_bf16 v110, v13, v29, v110
    v_dot2_f32_bf16 v108, v13, v13, v108
    v_dot2_f32_bf16 v110, v14, v30, v110
    v_dot2_f32_bf16 v108, v14, v14, v108
    v_dot2_f32_bf16 v110, v15, v31, v110
    v_dot2_f32_bf16 v108, v15, v15, v108
    v_add_f32_dpp v104, v104, v104 row_ror:8 row_mask:0xf bank_mask:0xf
    s_nop 1
    v_permlane32_swap_b32 v108, v110
    v_add_f32_dpp v104, v104, v104 row_ror:4 row_mask:0xf bank_mask:0xf
    v_add_f32 v108, v108, v110
    s_nop 0
    v_add_f32_dpp v104, v104, v104 row_ror:2 row_mask:0xf bank_mask:0xf
    v_add_f32_dpp v108, v108, v108 row_ror:8 row_mask:0xf bank_mask:0xf
    s_nop 0
    v_add_f32_dpp v104, v104, v104 row_ror:1 row_mask:0xf bank_mask:0xf
    v_add_f32_dpp v108, v108, v108 row_ror:4 row_mask:0xf bank_mask:0xf
    v_mul_f32 v112, 0x3a800000, v104
    s_nop 0
    v_add_f32_dpp v108, v108, v108 row_ror:2 row_mask:0xf bank_mask:0xf
    v_mul_f32 v113, -v112, v112
    s_nop 0
    v_add_f32_dpp v108, v108, v108 row_ror:1 row_mask:0xf bank_mask:0xf
    v_mul_f32 v110, v112, v100
    s_nop 0
    v_add_f32_dpp v108, v108, v108 row_bcast:15 row_mask:0xa bank_mask:0xf
    s_nop 0
    v_readlane_b32 s34, v108, 48
    v_fmamk_f32 v108, v108, 0x3a800000, v113
    v_max_f32 v108, 0, v108
    v_add_f32 v111, 0x3727c5ac, v108
    v_rsq_f32 v111, v111
    v_sub_f32 v110, s34, v110
    v_mul_f32 v110, v110, v111
    v_ashrrev_i32 v115, 31, v110
    v_bitop3_b32 v115, v110, v115, s60 bitop3:0x1e
    v_and_or_b32 v115, v115, s61, v125
    s_mov_b64 exec, 0x10000
    s_waitcnt vmcnt(2)
    ds_max_u32 v7, v115
    ds_add_rtn_u32 v118, v7, v118 offset:8
    v_cvt_pk_bf16_f32 v116, v112, v108
    buffer_store_dwordx2 v[116:117], v119, s[24:27], s51 offen sc1
    s_mov_b64 exec, -1
    ds_read_b32 v114, v7
    v_mul_f32 v111, s52, v111
    v_mul_f32 v113, v112, v111
    v_readlane_b32 s54, v111, 16
    v_readlane_b32 s70, v113, 16
    v_mfma_f32_16x16x32_bf16 v[76:79], v[8:11], v[32:35], 0
    v_mfma_f32_16x16x32_bf16 v[80:83], v[12:15], v[32:35], 0
    v_mfma_f32_16x16x32_bf16 v[84:87], v[8:11], v[36:39], 0
    v_mfma_f32_16x16x32_bf16 v[88:91], v[12:15], v[36:39], 0
    s_waitcnt lgkmcnt(0)
    v_readlane_b32 s34, v118, 16
    s_nop 0
    s_cmp_lg_u32 s34, 7
    s_cbranch_scc0 F_key
F_nokey:
    s_setprio 0
    s_lshr_b32 s58, s3, 2
    v_xor_b32 v94, 0x3d8, v92
    s_lshl4_add_u32 s58, s3, s58
    v_xor_b32 v95, 0x3f8, v92
    s_lshl_b32 s58, s58, 6
    v_and_b32 v72, 0x3d8, v96
    s_and_b32 s59, s3, 3
    v_sub_u32 v72, 1024, v72
    s_lshl3_add_u32 s59, s3, s59
    v_add_u32 v73, -32, v72
    s_lshl_b32 s59, s59, 2
    v_lshrrev_b32 v74, 3, v72
    s_and_b32 s34, s30, 15
    v_lshrrev_b32 v75, 3, v73
    s_sub_u32 s35, 16, s34
    v_bitop3_b32 v72, v72, v74, 32 bitop3:0x78
    s_and_b32 s50, s34, 7
    v_bitop3_b32 v73, v73, v75, 32 bitop3:0x78
    s_cmp_gt_u32 s34, 8
    v_add_u32 v72, s53, v72
    s_cselect_b32 s50, s35, s50
    v_add_u32 v73, s53, v73
    s_and_b32 s34, s34, 8
    v_xor_b32 v74, 1024, v72
    s_lshl4_add_u32 s50, s50, s34
    v_bfe_u32 v120, v3, 1, 2
    s_lshr_b32 s34, s30, 4
    v_xor_b32 v120, v120, v4
    s_add_u32 s50, s50, s34
    v_lshl_add_u32 v120, v3, 2, v120
    s_cmp_eq_u32 s30, 128
    v_lshl_add_u32 v120, v120, 4, s58
    s_cselect_b32 s50, 128, s50
    v_xor_b32 v121, s59, v3
    s_lshl1_add_u32 s29, s50, s44
    v_lshrrev_b32 v16, 1, v4
    s_mul_i32 s50, s29, 8320
    v_lshl_add_u32 v121, v16, 4, v121
    s_lshl_b32 s34, s3, 10
    v_and_b32 v16, 1, v4
    s_add_u32 s50, s50, s34
    v_mul_u32_u24 v16, 1040, v16
    s_add_u32 s50, s50, 1048576
    v_add_lshl_u32 v121, v121, v16, 2
    s_and_b32 s29, s29, 255
    v_and_b32 v17, 7, v3
    s_lshl2_add_u32 s29, s29, 40960
    v_lshrrev_b32 v16, 3, v3
    s_cmp_eq_u32 s44, 0
    v_mul_u32_u24 v122, 128, v17
    s_cselect_b32 s35, 0, 0xc2000000
    v_lshl_add_u32 v122, v16, 6, v122
    v_lshl_add_u32 v122, v4, 4, v122
    v_add_u32 v124, 1, v3
    v_bfe_i32 v124, v124, 4, 1
    v_and_b32 v124, s35, v124
    s_cmp_lg_u32 s71, 0
    s_cbranch_scc1 F_wkey
    s_waitcnt vmcnt(1)
F_wkey_r:
    ds_read_b64_tr_b16 v[24:25], v94 offset:3072
    ds_read_b64_tr_b16 v[26:27], v94 offset:2048
    ds_read_b64_tr_b16 v[28:29], v95 offset:3072
    ds_read_b64_tr_b16 v[30:31], v95 offset:2048
    ds_read_b64_tr_b16 v[16:17], v74 offset:2048
    ds_read_b64_tr_b16 v[18:19], v72 offset:2048
    ds_read_b64_tr_b16 v[20:21], v73 offset:3072
    ds_read_b64_tr_b16 v[22:23], v73 offset:2048
    s_waitcnt lgkmcnt(6)
    v_mfma_f32_16x16x32_bf16 v[104:107], v[68:71], v[24:27], 0
    v_dot2_f32_bf16 v109, v24, v24, v109
    v_dot2_f32_bf16 v109, v25, v25, v109
    v_dot2_f32_bf16 v109, v26, v26, v109
    v_dot2_f32_bf16 v109, v27, v27, v109
    s_waitcnt lgkmcnt(4)
    v_mfma_f32_16x16x32_bf16 v[104:107], v[68:71], v[28:31], v[104:107]
    v_dot2_f32_bf16 v109, v28, v28, v109
    v_dot2_f32_bf16 v109, v29, v29, v109
    v_dot2_f32_bf16 v109, v30, v30, v109
    v_dot2_f32_bf16 v109, v31, v31, v109
    s_mov_b32 exec_lo, 0xeeeeeeee
    s_mov_b32 exec_hi, 0xeeeeeeee
    s_waitcnt lgkmcnt(0)
    v_mov_b32_dpp v16, v24 quad_perm:[0,3,2,1] row_mask:0xf bank_mask:0xf
    v_mov_b32_dpp v17, v25 quad_perm:[0,3,2,1] row_mask:0xf bank_mask:0xf
    v_mov_b32_dpp v18, v26 quad_perm:[0,3,2,1] row_mask:0xf bank_mask:0xf
    v_mov_b32_dpp v19, v27 quad_perm:[0,3,2,1] row_mask:0xf bank_mask:0xf
    v_mov_b32_dpp v20, v28 quad_perm:[0,3,2,1] row_mask:0xf bank_mask:0xf
    v_mov_b32_dpp v21, v29 quad_perm:[0,3,2,1] row_mask:0xf bank_mask:0xf
    v_mov_b32_dpp v22, v30 quad_perm:[0,3,2,1] row_mask:0xf bank_mask:0xf
    v_mov_b32_dpp v23, v31 quad_perm:[0,3,2,1] row_mask:0xf bank_mask:0xf
    s_mov_b64 exec, -1
    v_add_f32_dpp v112, v104, v104 row_ror:8 row_mask:0xf bank_mask:0xf
    v_add_f32_dpp v109, v109, v109 row_ror:8 row_mask:0xf bank_mask:0xf
    v_mfma_f32_16x16x32_bf16 v[92:95], v[16:19], v[32:35], 0
    v_add_f32_dpp v112, v112, v112 row_ror:4 row_mask:0xf bank_mask:0xf
    v_add_f32_dpp v109, v109, v109 row_ror:4 row_mask:0xf bank_mask:0xf
    v_mfma_f32_16x16x32_bf16 v[96:99], v[20:23], v[32:35], 0
    v_add_f32_dpp v112, v112, v112 row_ror:2 row_mask:0xf bank_mask:0xf
    v_add_f32_dpp v109, v109, v109 row_ror:2 row_mask:0xf bank_mask:0xf
    v_mfma_f32_16x16x32_bf16 v[100:103], v[16:19], v[36:39], 0
    v_add_f32_dpp v112, v112, v112 row_ror:1 row_mask:0xf bank_mask:0xf
    v_add_f32_dpp v109, v109, v109 row_ror:1 row_mask:0xf bank_mask:0xf
    v_mfma_f32_16x16x32_bf16 v[104:107], v[20:23], v[36:39], 0
    v_mul_f32 v112, 0x3a800000, v112
    v_add_f32_dpp v109, v109, v109 row_bcast:15 row_mask:0xa bank_mask:0xf
    v_fmaak_f32 v113, v112, v112, 0xb727c5ac
    v_mul_f32 v116, s70, v124
    v_add_f32_dpp v109, v109, v109 row_bcast:31 row_mask:0xc bank_mask:0xf
    v_fma_f32 v109, v109, s63, -v113
    v_max_f32 v109, 0x3727c5ac, v109
    v_rsq_f32 v109, v109
    v_pk_mul_f32 v[84:85], v[84:85], s[54:55] op_sel:[0,0] op_sel_hi:[1,0]
    v_mul_f32 v109, s52, v109
    v_pk_mul_f32 v[86:87], v[86:87], s[54:55] op_sel:[0,0] op_sel_hi:[1,0]
    v_readlane_b32 s55, v109, 48
    s_nop 1
    v_pk_mul_f32 v[88:89], v[88:89], s[54:55] op_sel:[0,0] op_sel_hi:[1,0]
    v_pk_mul_f32 v[90:91], v[90:91], s[54:55] op_sel:[0,0] op_sel_hi:[1,0]
    v_mul_f32 v112, s55, v112
    v_fmac_f32 v116, v112, v124
F_pass:
    v_pk_fma_f32 v[76:77], v[76:77], s[54:55], v[116:117] op_sel:[0,0,0] op_sel_hi:[1,0,0]
    v_pk_fma_f32 v[78:79], v[78:79], s[54:55], v[116:117] op_sel:[0,0,0] op_sel_hi:[1,0,0]
    v_pk_fma_f32 v[80:81], v[80:81], s[54:55], v[116:117] op_sel:[0,0,0] op_sel_hi:[1,0,0]
    v_pk_fma_f32 v[82:83], v[82:83], s[54:55], v[116:117] op_sel:[0,0,0] op_sel_hi:[1,0,0]
    v_pk_fma_f32 v[76:77], v[92:93], s[54:55], v[76:77] op_sel:[0,1,0] op_sel_hi:[1,1,1]
    v_pk_fma_f32 v[78:79], v[94:95], s[54:55], v[78:79] op_sel:[0,1,0] op_sel_hi:[1,1,1]
    v_pk_fma_f32 v[80:81], v[96:97], s[54:55], v[80:81] op_sel:[0,1,0] op_sel_hi:[1,1,1]
    v_pk_fma_f32 v[82:83], v[98:99], s[54:55], v[82:83] op_sel:[0,1,0] op_sel_hi:[1,1,1]
    v_pk_fma_f32 v[84:85], v[100:101], s[54:55], v[84:85] op_sel:[0,1,0] op_sel_hi:[1,1,1]
    v_pk_fma_f32 v[86:87], v[102:103], s[54:55], v[86:87] op_sel:[0,1,0] op_sel_hi:[1,1,1]
    v_pk_fma_f32 v[88:89], v[104:105], s[54:55], v[88:89] op_sel:[0,1,0] op_sel_hi:[1,1,1]
    v_pk_fma_f32 v[90:91], v[106:107], s[54:55], v[90:91] op_sel:[0,1,0] op_sel_hi:[1,1,1]
    v_cvt_pk_f16_f32 v24, v76, v77
    v_cvt_pk_f16_f32 v25, v78, v79
    v_cvt_pk_f16_f32 v26, v80, v81
    v_cvt_pk_f16_f32 v27, v82, v83
    v_cvt_pk_f16_f32 v28, v84, v85
    v_cvt_pk_f16_f32 v29, v86, v87
    v_cvt_pk_f16_f32 v30, v88, v89
    v_cvt_pk_f16_f32 v31, v90, v91
    v_pk_mul_f16 v68, v24, v60
    v_pk_mul_f16 v69, v25, v61
    v_pk_mul_f16 v70, v26, v62
    v_pk_mul_f16 v71, v27, v63
    v_pk_fma_f16 v68, v28, v64, v68
    v_pk_fma_f16 v69, v29, v65, v69
    v_pk_fma_f16 v70, v30, v66, v70
    v_pk_fma_f16 v71, v31, v67, v71
    v_pk_mul_f16 v72, v28, v60
    v_pk_mul_f16 v73, v29, v61
    v_pk_mul_f16 v74, v30, v62
    v_pk_mul_f16 v75, v31, v63
    v_mfma_f32_16x16x32_f16 v[92:95], v[68:71], v[48:51], 0
    v_mfma_f32_16x16x32_f16 v[96:99], v[68:71], v[56:59], 0
    v_pk_fma_f16 v72, v24, v64, v72 neg_lo:[1,0,0] neg_hi:[1,0,0]
    v_pk_fma_f16 v73, v25, v65, v73 neg_lo:[1,0,0] neg_hi:[1,0,0]
    v_pk_fma_f16 v74, v26, v66, v74 neg_lo:[1,0,0] neg_hi:[1,0,0]
    v_pk_fma_f16 v75, v27, v67, v75 neg_lo:[1,0,0] neg_hi:[1,0,0]
    s_nop 1
    v_mfma_f32_16x16x32_f16 v[92:95], v[72:75], v[52:55], v[92:95]
    v_mfma_f32_16x16x32_f16 v[96:99], v[72:75], v[48:51], v[96:99]
    s_nop 7
    v_cvt_pk_f16_f32 v24, v92, v96
    v_cvt_pk_f16_f32 v25, v93, v97
    v_cvt_pk_f16_f32 v26, v94, v98
    v_cvt_pk_f16_f32 v27, v95, v99
    ds_write_b128 v120, v[24:27] offset:32768
    s_waitcnt lgkmcnt(0)
    s_barrier
    ds_read2st64_b32 v[28:29], v121 offset0:128 offset1:132
    ds_read2st64_b32 v[30:31], v121 offset0:136 offset1:140
    s_waitcnt lgkmcnt(0)
    v_mfma_f32_16x16x32_f16 v[100:103], v[28:31], v[40:43], 0
    v_mfma_f32_16x16x32_f16 v[104:107], v[28:31], v[44:47], 0
    s_nop 7
    v_cvt_pk_f16_f32 v68, v100, v104
    v_cvt_pk_f16_f32 v69, v101, v105
    v_cvt_pk_f16_f32 v70, v102, v106
    v_cvt_pk_f16_f32 v71, v103, v107
    buffer_store_dwordx4 v[68:71], v122, s[24:27], s50 offen sc1
    s_cmp_lg_u32 s46, 0
    s_cbranch_scc1 F_second
    s_mov_b32 s34, 0x71605432
    v_bfe_u32 v6, v2, 2, 2
    s_mov_b32 s35, 0x98fedcba
    v_lshl_add_u32 v6, v6, 2, v4
    s_lshl_b32 s56, s45, 2
    v_and_b32 v1, 3, v2
    s_lshr_b64 s[34:35], s[34:35], s56
    v_lshlrev_b32 v1, 4, v1
    s_and_b32 s34, s34, 15
    v_lshl_add_u32 v6, v6, 18, v1
    s_xor_b32 s45, s45, 8
    v_lshrrev_b32 v108, 3, v3
    s_cmp_eq_u32 s44, 0
    v_and_b32 v109, 7, v3
    s_cselect_b32 s45, s45, s34
    v_lshlrev_b32 v123, 14, v108
    s_sub_u32 s34, 0, s28
    v_lshl_add_u32 v123, v4, 20, v123
    s_and_b32 s34, s34, 7
    v_lshl_add_u32 v123, v109, 3, v123
    s_lshr_b32 s35, s45, 1
    s_cmp_lt_u32 s35, s44
    s_cselect_b32 s28, s34, s28
    s_sub_u32 s34, 0, s28
    s_and_b32 s34, s34, 7
    s_sub_u32 s35, 31, s45
    s_cmp_eq_u32 s44, 0
    s_cselect_b32 s56, s28, s34
    s_cselect_b32 s57, s45, s35
    s_lshl4_add_u32 s64, s3, s56
    s_lshl_b32 s64, s64, 11
    s_lshl_b32 s34, s57, 6
    s_add_u32 s64, s64, s34
    s_add_u32 s65, s64, 262144
    s_add_u32 s66, s64, 524288
    s_add_u32 s67, s64, 786432
    s_mov_b64 s[20:21], s[8:9]
    s_mov_b32 s22, 4194304
    s_mov_b32 s23, 0x20000
    s_mov_b32 s16, 0
    s_lshr_b32 s34, s3, 1
    s_lshl2_add_u32 s34, s46, s34
    s_cmp_lg_u32 s34, 0
    s_cbranch_scc1 F_xp0
    s_mov_b32 m0, s53
    s_add_u32 s35, s64, 16384
    buffer_load_dwordx4 v6, s[12:15], s64 offen  lds
    s_add_u32 m0, s53, 1152
    s_add_u32 s35, s64, 16384
    buffer_load_dwordx4 v6, s[12:15], s35 offen  lds
F_xp0:
    v_and_b32 v110, 31, v2
    v_lshrrev_b32 v111, 5, v2
    s_lshl_b32 s61, s44, 31
    s_xor_b32 s60, s61, 0x3a000000
    v_lshrrev_b32 v112, 1, v110
    v_lshl_add_u32 v112, v112, 3, s56
    v_cvt_f32_u32 v112, v112
    v_mul_f32 v112, s60, v112
    v_and_b32 v113, 1, v110
    v_cvt_f32_u32 v114, v113
    s_sub_u32 s58, 16, s3
    s_cmp_eq_u32 s3, 0
    s_cselect_b32 s34, 0, 0x3e800000
    s_cselect_b32 s35, 0, -1
    s_cselect_b32 s58, 8, s58
    v_mul_f32 v114, s34, v114
    v_mul_f32 v117, 0x42000000, v112
    v_lshl_add_u32 v116, v111, 4, s3
    v_cvt_f32_u32 v116, v116
    v_fma_f32 v116, v116, v112, v114
    v_cos_f32 v108, v116
    v_sin_f32 v109, v116
    v_add_f32 v116, v116, v117
    v_cvt_pk_f16_f32 v32, v108, v109
    v_cos_f32 v108, v116
    v_sin_f32 v109, v116
    v_add_f32 v116, v116, v117
    v_cvt_pk_f16_f32 v33, v108, v109
    v_cos_f32 v108, v116
    v_sin_f32 v109, v116
    v_add_f32 v116, v116, v117
    v_cvt_pk_f16_f32 v34, v108, v109
    v_cos_f32 v108, v116
    v_sin_f32 v109, v116
    v_add_f32 v116, v116, v117
    v_cvt_pk_f16_f32 v35, v108, v109
    v_mov_b32 v48, s33
    v_lshlrev_b32 v49, 10, v2
    s_lshl2_add_u32 s34, s46, s3
    s_cmp_ge_u32 s34, 4
    s_cbranch_scc1 F_x5a
    s_lshr_b32 s34, s3, 1
    s_lshl2_add_u32 s34, s46, s34
    s_cmp_lg_u32 s34, 1
    s_cbranch_scc1 F_xp1
    s_mov_b32 m0, s53
    s_add_u32 s35, s64, 16384
    buffer_load_dwordx4 v6, s[12:15], s64 offen  lds
    s_add_u32 m0, s53, 1152
    s_add_u32 s35, s64, 16384
    buffer_load_dwordx4 v6, s[12:15], s35 offen  lds
F_xp1:
    s_waitcnt vmcnt(2)
    s_branch F_x5b
F_x5a:
    s_waitcnt vmcnt(0)
F_x5b:
    s_cmp_lg_u32 s3, 7
    s_barrier
    s_cbranch_scc1 F_noflag
    s_mov_b32 exec_lo, 0xffffffff
    s_mov_b32 exec_hi, 0
    buffer_store_dword v48, v49, s[24:27], s29 offen sc1
    s_mov_b64 exec, -1
F_noflag:
    s_lshr_b32 s34, s3, s46
    s_cmp_lt_u32 s34, 4
    s_cbranch_scc1 F_x5c
    s_lshr_b32 s34, s3, 1
    s_lshl2_add_u32 s34, s46, s34
    s_cmp_lg_u32 s34, 2
    s_cbranch_scc1 F_xp2
    s_mov_b32 m0, s53
    s_add_u32 s35, s64, 16384
    buffer_load_dwordx4 v6, s[12:15], s64 offen  lds
    s_add_u32 m0, s53, 1152
    s_add_u32 s35, s64, 16384
    buffer_load_dwordx4 v6, s[12:15], s35 offen  lds
F_xp2:
F_x5c:
    v_lshrrev_b32 v118, 3, v3
    v_lshlrev_b32 v124, 7, v118
    v_lshl_add_u32 v124, v4, 5, v124
    s_lshl3_add_u32 s59, s56, s3
    s_lshl_b32 s59, s59, 8
    s_add_u32 s59, s59, 24576
    s_mov_b32 s62, 0
F_stats:
    buffer_load_dwordx4 v[24:27], v124, s[24:27], s59 offen sc1
    buffer_load_dwordx4 v[28:31], v124, s[24:27], s59 offen offset:16 sc1
    s_cmp_lg_u32 s62, 0
    s_cbranch_scc1 F_stats_w
F_stats_i:
    v_lshl_add_u32 v116, v111, 4, s58
    v_cvt_f32_u32 v116, v116
    v_fma_f32 v116, v116, v112, -v114
    v_cos_f32 v108, v116
    v_sin_f32 v109, v116
    v_add_f32 v116, v116, v117
    v_cvt_pk_f16_f32 v36, v108, v109
    v_cos_f32 v108, v116
    v_sin_f32 v109, v116
    v_add_f32 v116, v116, v117
    v_cvt_pk_f16_f32 v37, v108, v109
    v_cos_f32 v108, v116
    v_sin_f32 v109, v116
    v_add_f32 v116, v116, v117
    v_cvt_pk_f16_f32 v38, v108, v109
    v_cos_f32 v108, v116
    v_sin_f32 v109, v116
    v_add_f32 v116, v116, v117
    v_cvt_pk_f16_f32 v39, v108, v109
    s_cmp_lg_u32 s3, 0
    s_cbranch_scc1 F_now0
    v_mul_f32 v116, 0x43000000, v112
    v_cos_f32 v108, v116
    v_sin_f32 v109, v116
    v_add_u32 v115, -1, v113
    v_and_b32 v32, v32, v115
    v_bfi_b32 v36, v115, 0, v36
    v_and_b32 v33, v33, v115
    v_bfi_b32 v37, v115, 0, v37
    v_and_b32 v34, v34, v115
    v_bfi_b32 v38, v115, 0, v38
    v_and_b32 v35, v35, v115
    v_bfi_b32 v39, v115, 0, v39
    v_or_b32 v115, v113, v111
    v_add_u32 v115, -1, v115
    v_cvt_pk_f16_f32 v40, v108, v109
    v_and_b32 v40, v40, v115
    v_mov_b32 v41, 0
    v_mov_b32 v57, 0
    v_mov_b32 v42, 0
    v_mov_b32 v58, 0
    v_mov_b32 v43, 0
    v_mov_b32 v59, 0
F_now0:
    s_lshr_b32 s34, s3, 1
    s_lshl2_add_u32 s34, s46, s34
    s_cmp_lg_u32 s34, 3
    s_cbranch_scc1 F_xp3
    s_mov_b32 m0, s53
    s_add_u32 s35, s64, 16384
    buffer_load_dwordx4 v6, s[12:15], s64 offen  lds
    s_add_u32 m0, s53, 1152
    s_add_u32 s35, s64, 16384
    buffer_load_dwordx4 v6, s[12:15], s35 offen  lds
F_xp3:
    s_xor_b32 s60, s61, 0x3d800000
    v_cvt_f32_u32 v117, v3
    v_mul_f32 v117, s60, v117
    v_lshlrev_b32 v116, 1, v4
    v_cvt_f32_u32 v116, v116
    v_mul_f32 v116, v116, v117
    v_add_f32 v117, v116, v117
    v_cos_f32 v108, v116
    v_sin_f32 v109, v116
    v_cos_f32 v114, v117
    v_sin_f32 v115, v117
    v_cvt_pk_f16_f32 v44, v108, v109
    s_mov_b32 s34, 0x3c003c00
    v_cvt_pk_f16_f32 v45, v114, v115
    s_mov_b64 exec, 0xffff
    v_lshl_or_b32 v44, v3, 31, s34
    s_mov_b64 exec, -1
    v_lshl_add_u32 v122, s3, 1, v118
    v_mul_u32_u24 v122, 1280, v122
    v_mul_u32_u24 v108, 272, v4
    v_and_b32 v109, 7, v3
    v_lshlrev_b32 v109, 5, v109
    v_add3_u32 v122, v122, v108, v109
    s_lshr_b32 s34, s3, 1
    s_mul_i32 s34, s34, 272
    s_and_b32 s35, s3, 1
    s_lshl2_add_u32 s34, s35, s34
    v_mul_u32_u24 v121, 2560, v111
    v_lshl_add_u32 v121, v110, 3, v121
    v_add_u32 v121, s34, v121
    s_cmp_eq_u32 s44, 0
    s_cselect_b32 s34, 0, 31
    s_cselect_b32 s35, -1, 0
    s_lshl_b32 s60, s45, 5
    s_add_u32 s35, s35, s60
    v_xor_b32 v108, s34, v110
    v_add_u32 v108, s35, v108
    v_max_i32 v108, 0, v108
    v_bfe_u32 v125, v108, 4, 1
    v_mul_u32_u24 v125, 8320, v125
    v_lshrrev_b32 v109, 6, v108
    v_lshl_add_u32 v125, v109, 10, v125
    v_bfe_u32 v109, v108, 5, 1
    v_lshl_add_u32 v125, v109, 6, v125
    v_and_b32 v108, 15, v108
    v_lshl_add_u32 v125, v108, 2, v125
    v_mul_u32_u24 v120, 16640, v111
    v_add_u32 v120, v120, v125
    s_lshl_b32 s58, s28, 7
    s_add_u32 s58, s58, 1048576
    s_add_u32 s60, s58, 2129920
    s_mul_i32 s34, s3, 266240
    s_add_u32 s58, s58, s34
    s_lshl4_add_u32 s47, s3, s56
    s_lshl_b32 s48, s57, 7
    s_add_u32 s49, s48, 491520
    s_lshl1_add_u32 s48, s48, 753664
    s_add_u32 s52, s48, 128
    s_and_b32 s34, s2, 31
    s_lshl3_add_u32 s34, s34, s3
    s_lshl_b32 s34, s34, 7
    s_add_u32 s34, s34, 40960
    s_add_u32 s42, s10, s34
    s_addc_u32 s43, s11, 0
    s_mov_b32 s40, s33
    s_mov_b32 s41, s33
    s_and_b32 s63, s2, 31
    s_lshl_b32 s63, s63, 7
    s_add_u32 s63, s63, 4096
    v_mul_u32_u24 v108, 1152, v118
    v_lshl_add_u32 v108, v4, 6, v108
    v_and_b32 v109, 7, v3
    v_lshlrev_b32 v109, 3, v109
    v_add3_u32 v108, v108, v109, s53
    s_waitcnt vmcnt(0)
F_xt:
    ds_read_b64 v[8:9], v108 offset:0
    ds_read_b64 v[10:11], v108 offset:256
    ds_read_b64 v[12:13], v108 offset:512
    ds_read_b64 v[14:15], v108 offset:768
    s_waitcnt lgkmcnt(3)
    v_lshlrev_b32 v60, 16, v8
    v_and_b32 v64, 0xffff0000, v8
    v_lshlrev_b32 v68, 16, v9
    v_and_b32 v72, 0xffff0000, v9
    s_waitcnt lgkmcnt(2)
    v_lshlrev_b32 v61, 16, v10
    v_and_b32 v65, 0xffff0000, v10
    v_lshlrev_b32 v69, 16, v11
    v_and_b32 v73, 0xffff0000, v11
    s_waitcnt lgkmcnt(1)
    v_lshlrev_b32 v62, 16, v12
    v_and_b32 v66, 0xffff0000, v12
    v_lshlrev_b32 v70, 16, v13
    v_and_b32 v74, 0xffff0000, v13
    s_waitcnt lgkmcnt(0)
    v_lshlrev_b32 v63, 16, v14
    v_and_b32 v67, 0xffff0000, v14
    v_lshlrev_b32 v71, 16, v15
    v_and_b32 v75, 0xffff0000, v15
F_stats_w:
    s_waitcnt vmcnt(0)
F_stats_c:
    v_xor_b32 v108, s33, v25
    v_xor_b32 v109, s33, v27
    v_xor_b32 v110, s33, v29
    v_xor_b32 v111, s33, v31
    v_or3_b32 v108, v108, v109, v110
    v_or_b32 v108, v108, v111
    v_cmp_ne_u32 vcc, 0, v108
    s_add_u32 s62, s62, 1
    s_cbranch_vccz F_stats_d
    s_sleep 4
    s_cmp_lt_u32 s62, 200000
    s_cbranch_scc1 F_stats
F_stats_d:
    s_cmp_lt_u32 s2, 224
    s_cbranch_scc1 F_npf2
    s_cmp_gt_u32 s3, 1
    s_cbranch_scc1 F_npf2
    s_getpc_b64 s[6:7]
L_pc2:
    s_mov_b32 m0, 66816
    v_lshlrev_b32 v110, 7, v0
    v_min_u32 v110, L_end-L_pc2, v110
    v_mov_b32 v111, s7
    v_add_co_u32 v110, vcc, s6, v110
    s_nop 1
    v_addc_co_u32 v111, vcc, 0, v111, vcc
    global_load_lds_dword v[110:111], off sc1
F_npf2:
    s_cmp_eq_u32 s46, 2
    s_cbranch_scc1 F_npre
    s_load_dwordx16 s[68:83], s[42:43], 0 glc
    s_load_dwordx16 s[84:99], s[42:43], 64 glc
F_npre:
    s_mov_b32 s34, 0xbe38aa3b
    v_mov_b32 v108, 0x3427c5ac
    v_and_b32 v16, 0xffff0000, v24
    v_fmamk_f32 v16, v16, 0x3c800000, v108
    v_and_b32 v17, 0xffff0000, v26
    v_fmamk_f32 v17, v17, 0x3c800000, v108
    v_and_b32 v18, 0xffff0000, v28
    v_fmamk_f32 v18, v18, 0x3c800000, v108
    v_and_b32 v19, 0xffff0000, v30
    v_fmamk_f32 v19, v19, 0x3c800000, v108
    v_rsq_f32 v16, v16
    v_lshlrev_b32 v20, 16, v24
    v_rsq_f32 v17, v17
    v_lshlrev_b32 v21, 16, v26
    v_rsq_f32 v18, v18
    v_lshlrev_b32 v22, 16, v28
    v_rsq_f32 v19, v19
    v_lshlrev_b32 v23, 16, v30
    v_pk_mul_f32 v[20:21], v[20:21], v[16:17] neg_lo:[1,0] neg_hi:[1,0]
    v_pk_mul_f32 v[22:23], v[22:23], v[18:19] neg_lo:[1,0] neg_hi:[1,0]
    v_pk_mul_f32 v[24:25], v[16:17], s[34:35] op_sel:[0,0] op_sel_hi:[1,0]
    v_pk_mul_f32 v[26:27], v[18:19], s[34:35] op_sel:[0,0] op_sel_hi:[1,0]
    v_pk_mul_f32 v[28:29], v[20:21], s[34:35] op_sel:[0,0] op_sel_hi:[1,0]
    v_pk_mul_f32 v[30:31], v[22:23], s[34:35] op_sel:[0,0] op_sel_hi:[1,0]
    v_pk_fma_f32 v[92:93], v[60:61], v[24:25], v[28:29]
    v_pk_fma_f32 v[94:95], v[62:63], v[26:27], v[30:31]
    v_pk_fma_f32 v[96:97], v[64:65], v[24:25], v[28:29]
    v_pk_fma_f32 v[98:99], v[66:67], v[26:27], v[30:31]
    v_pk_fma_f32 v[100:101], v[68:69], v[24:25], v[28:29]
    v_pk_fma_f32 v[102:103], v[70:71], v[26:27], v[30:31]
    v_pk_fma_f32 v[104:105], v[72:73], v[24:25], v[28:29]
    v_pk_fma_f32 v[106:107], v[74:75], v[26:27], v[30:31]
    v_exp_f32 v92, v92
    v_exp_f32 v93, v93
    v_pk_fma_f32 v[76:77], v[60:61], v[16:17], v[20:21]
    v_exp_f32 v94, v94
    v_exp_f32 v95, v95
    v_pk_fma_f32 v[78:79], v[62:63], v[18:19], v[22:23]
    v_exp_f32 v96, v96
    v_exp_f32 v97, v97
    v_pk_fma_f32 v[80:81], v[64:65], v[16:17], v[20:21]
    v_exp_f32 v98, v98
    v_exp_f32 v99, v99
    v_pk_fma_f32 v[82:83], v[66:67], v[18:19], v[22:23]
    v_exp_f32 v100, v100
    v_exp_f32 v101, v101
    v_pk_fma_f32 v[84:85], v[68:69], v[16:17], v[20:21]
    v_exp_f32 v102, v102
    v_exp_f32 v103, v103
    v_pk_fma_f32 v[86:87], v[70:71], v[18:19], v[22:23]
    v_exp_f32 v104, v104
    v_exp_f32 v105, v105
    v_pk_fma_f32 v[88:89], v[72:73], v[16:17], v[20:21]
    v_exp_f32 v106, v106
    v_exp_f32 v107, v107
    v_pk_fma_f32 v[90:91], v[74:75], v[18:19], v[22:23]
    s_mov_b32 s62, 0
    s_cmp_lg_u32 s46, 2
    s_cbranch_scc1 F_poll_w
F_mid:
    v_pk_add_f32 v[92:93], v[92:93], 1.0 op_sel_hi:[1,0]
    v_pk_add_f32 v[94:95], v[94:95], 1.0 op_sel_hi:[1,0]
    v_pk_add_f32 v[96:97], v[96:97], 1.0 op_sel_hi:[1,0]
    v_pk_add_f32 v[98:99], v[98:99], 1.0 op_sel_hi:[1,0]
    v_pk_add_f32 v[100:101], v[100:101], 1.0 op_sel_hi:[1,0]
    v_pk_add_f32 v[102:103], v[102:103], 1.0 op_sel_hi:[1,0]
    v_pk_add_f32 v[104:105], v[104:105], 1.0 op_sel_hi:[1,0]
    v_pk_add_f32 v[106:107], v[106:107], 1.0 op_sel_hi:[1,0]
    v_rcp_f32 v92, v92
    v_rcp_f32 v93, v93
    v_rcp_f32 v94, v94
    v_rcp_f32 v95, v95
    v_rcp_f32 v96, v96
    v_rcp_f32 v97, v97
    v_rcp_f32 v98, v98
    v_rcp_f32 v99, v99
    v_rcp_f32 v100, v100
    v_rcp_f32 v101, v101
    v_rcp_f32 v102, v102
    v_rcp_f32 v103, v103
    v_rcp_f32 v104, v104
    v_rcp_f32 v105, v105
    v_rcp_f32 v106, v106
    v_rcp_f32 v107, v107
    v_pk_mul_f32 v[76:77], v[76:77], v[92:93]
    v_pk_mul_f32 v[78:79], v[78:79], v[94:95]
    v_pk_mul_f32 v[80:81], v[80:81], v[96:97]
    v_pk_mul_f32 v[82:83], v[82:83], v[98:99]
    v_pk_mul_f32 v[84:85], v[84:85], v[100:101]
    v_pk_mul_f32 v[86:87], v[86:87], v[102:103]
    v_pk_mul_f32 v[88:89], v[88:89], v[104:105]
    v_pk_mul_f32 v[90:91], v[90:91], v[106:107]
    s_mov_b32 s62, 0
    s_cmp_eq_u32 s46, 2
    s_cbranch_scc1 F_fetched
    s_branch F_poll_w
F_poll:
    s_load_dwordx16 s[68:83], s[42:43], 0 glc
    s_load_dwordx16 s[84:99], s[42:43], 64 glc
F_poll_w:
    s_waitcnt lgkmcnt(0)
    s_xor_b64 s[68:69], s[68:69], s[40:41]
    s_xor_b64 s[70:71], s[70:71], s[40:41]
    s_or_b64 s[68:69], s[68:69], s[70:71]
    s_xor_b64 s[72:73], s[72:73], s[40:41]
    s_or_b64 s[68:69], s[68:69], s[72:73]
    s_xor_b64 s[74:75], s[74:75], s[40:41]
    s_or_b64 s[68:69], s[68:69], s[74:75]
    s_xor_b64 s[76:77], s[76:77], s[40:41]
    s_or_b64 s[68:69], s[68:69], s[76:77]
    s_xor_b64 s[78:79], s[78:79], s[40:41]
    s_or_b64 s[68:69], s[68:69], s[78:79]
    s_xor_b64 s[80:81], s[80:81], s[40:41]
    s_or_b64 s[68:69], s[68:69], s[80:81]
    s_xor_b64 s[82:83], s[82:83], s[40:41]
    s_or_b64 s[68:69], s[68:69], s[82:83]
    s_xor_b64 s[84:85], s[84:85], s[40:41]
    s_or_b64 s[68:69], s[68:69], s[84:85]
    s_xor_b64 s[86:87], s[86:87], s[40:41]
    s_or_b64 s[68:69], s[68:69], s[86:87]
    s_xor_b64 s[88:89], s[88:89], s[40:41]
    s_or_b64 s[68:69], s[68:69], s[88:89]
    s_xor_b64 s[90:91], s[90:91], s[40:41]
    s_or_b64 s[68:69], s[68:69], s[90:91]
    s_xor_b64 s[92:93], s[92:93], s[40:41]
    s_or_b64 s[68:69], s[68:69], s[92:93]
    s_xor_b64 s[94:95], s[94:95], s[40:41]
    s_or_b64 s[68:69], s[68:69], s[94:95]
    s_xor_b64 s[96:97], s[96:97], s[40:41]
    s_or_b64 s[68:69], s[68:69], s[96:97]
    s_xor_b64 s[98:99], s[98:99], s[40:41]
    s_or_b64 s[68:69], s[68:69], s[98:99]
    s_cbranch_scc0 F_rel
    s_cmp_lg_u32 s46, 0
    s_cbranch_scc1 F_poll_n
    s_mov_b32 s46, 1
    s_load_dwordx16 s[68:83], s[42:43], 0 glc
    s_load_dwordx16 s[84:99], s[42:43], 64 glc
    s_branch F_mid
F_poll_n:
    s_add_u32 s62, s62, 1
    s_sleep 5
    s_cmp_lt_u32 s62, 200000
    s_cbranch_scc1 F_poll
F_rel:
    buffer_load_dword v48, v120, s[24:27], s58 offen sc1
    s_add_u32 s58, s58, 33280
    buffer_load_dword v49, v120, s[24:27], s58 offen sc1
    s_add_u32 s58, s58, 33280
    buffer_load_dword v50, v120, s[24:27], s58 offen sc1
    s_add_u32 s58, s58, 33280
    buffer_load_dword v51, v120, s[24:27], s58 offen sc1
    s_add_u32 s58, s58, 33280
    buffer_load_dword v52, v120, s[24:27], s58 offen sc1
    s_add_u32 s58, s58, 33280
    buffer_load_dword v53, v120, s[24:27], s58 offen sc1
    s_add_u32 s58, s58, 33280
    buffer_load_dword v54, v120, s[24:27], s58 offen sc1
    s_add_u32 s58, s58, 33280
    buffer_load_dword v55, v120, s[24:27], s58 offen sc1
    s_load_dwordx2 s[36:37], s[10:11], s63
    s_cmp_lg_u32 s3, 0
    s_cbranch_scc1 F_novx
    buffer_load_dword v56, v125, s[24:27], s60 offen sc1
F_novx:
    s_cmp_eq_u32 s46, 0
    s_mov_b32 s46, 2
    s_cbranch_scc1 F_mid
F_fetched:
    s_cmp_lg_u32 s3, 0
    s_cbranch_scc1 F_A
    s_waitcnt vmcnt(0)
    v_mfma_f32_32x32x16_f16 v[92:107], v[40:43], v[56:59], 0
    v_mfma_f32_32x32x16_f16 v[92:107], v[32:35], v[48:51], v[92:107]
    s_branch F_A2
F_A:
    s_waitcnt vmcnt(4)
    v_mfma_f32_32x32x16_f16 v[92:107], v[32:35], v[48:51], 0
    s_waitcnt vmcnt(0)
F_A2:
    v_mfma_f32_32x32x16_f16 v[92:107], v[36:39], v[52:55], v[92:107]
    s_waitcnt lgkmcnt(0)
    s_and_b32 s34, s36, 0x77
    s_cmp_eq_u32 s34, s47
    s_cbranch_scc1 F_eh
F_eh_r:
    s_nop 7
    v_cvt_pk_f16_f32 v48, v92, v93
    v_cvt_pk_f16_f32 v49, v94, v95
    ds_write2st64_b32 v121, v48, v49 offset0:128 offset1:133
    v_cvt_pk_f16_f32 v50, v96, v97
    v_cvt_pk_f16_f32 v51, v98, v99
    ds_write2st64_b32 v121, v50, v51 offset0:148 offset1:153
    v_cvt_pk_f16_f32 v52, v100, v101
    v_cvt_pk_f16_f32 v53, v102, v103
    ds_write2st64_b32 v121, v52, v53 offset0:168 offset1:173
    v_cvt_pk_f16_f32 v54, v104, v105
    v_cvt_pk_f16_f32 v55, v106, v107
    ds_write2st64_b32 v121, v54, v55 offset0:188 offset1:193
    s_waitcnt lgkmcnt(0)
    s_barrier
    ds_read_b128 v[48:51], v122 offset:32768
    ds_read_b128 v[52:55], v122 offset:32784
    s_waitcnt lgkmcnt(1)
    v_mfma_f32_16x16x16_f16 v[92:95], v[44:45], v[48:49], 0
    v_mfma_f32_16x16x16_f16 v[96:99], v[44:45], v[50:51], 0
    s_waitcnt lgkmcnt(0)
    v_mfma_f32_16x16x16_f16 v[100:103], v[44:45], v[52:53], 0
    v_mfma_f32_16x16x16_f16 v[104:107], v[44:45], v[54:55], 0
    s_and_b32 s34, s36, 0x77
    s_cmp_lg_u32 s34, s47
    s_cbranch_scc1 F_noh
    s_mul_i32 s50, s33, 28
    s_sub_u32 s50, s50, s68
    s_sub_u32 s50, s50, s69
    s_sub_u32 s50, s50, s70
    s_sub_u32 s50, s50, s71
    s_sub_u32 s50, s50, s72
    s_sub_u32 s50, s50, s73
    s_sub_u32 s50, s50, s74
    s_sub_u32 s50, s50, s75
    s_sub_u32 s50, s50, s76
    s_sub_u32 s50, s50, s77
    s_sub_u32 s50, s50, s78
    s_sub_u32 s50, s50, s79
    s_sub_u32 s50, s50, s80
    s_sub_u32 s50, s50, s81
    s_sub_u32 s50, s50, s84
    s_sub_u32 s50, s50, s85
    s_sub_u32 s50, s50, s86
    s_sub_u32 s50, s50, s87
    s_sub_u32 s50, s50, s88
    s_sub_u32 s50, s50, s89
    s_sub_u32 s50, s50, s90
    s_sub_u32 s50, s50, s91
    s_sub_u32 s50, s50, s92
    s_sub_u32 s50, s50, s93
    s_sub_u32 s50, s50, s94
    s_sub_u32 s50, s50, s95
    s_sub_u32 s50, s50, s96
    s_sub_u32 s50, s50, s97
    s_cmp_eq_u32 s50, 0
    s_cbranch_scc1 F_own
    s_load_dwordx16 s[68:83], s[10:11], s48 glc
    s_load_dwordx16 s[84:99], s[10:11], s52 glc
F_noh:
    s_cmp_eq_u32 s57, 0
    s_cbranch_scc1 F_zero
F_nz:
    v_pk_fma_f32 v[60:61], v[92:93], v[76:77], v[60:61]
    v_pk_fma_f32 v[64:65], v[96:97], v[80:81], v[64:65]
    v_pk_fma_f32 v[68:69], v[100:101], v[84:85], v[68:69]
    v_pk_fma_f32 v[72:73], v[104:105], v[88:89], v[72:73]
    v_cvt_pk_bf16_f32 v32, v60, v64
    v_cvt_pk_bf16_f32 v33, v68, v72
    buffer_store_dwordx2 v[32:33], v123, s[20:23], s64 offen sc1
    v_cvt_pk_bf16_f32 v34, v61, v65
    v_cvt_pk_bf16_f32 v35, v69, v73
    buffer_store_dwordx2 v[34:35], v123, s[20:23], s65 offen sc1
    v_pk_fma_f32 v[62:63], v[94:95], v[78:79], v[62:63]
    v_pk_fma_f32 v[66:67], v[98:99], v[82:83], v[66:67]
    v_pk_fma_f32 v[70:71], v[102:103], v[86:87], v[70:71]
    v_pk_fma_f32 v[74:75], v[106:107], v[90:91], v[74:75]
    v_cvt_pk_bf16_f32 v36, v62, v66
    v_cvt_pk_bf16_f32 v37, v70, v74
    buffer_store_dwordx2 v[36:37], v123, s[20:23], s66 offen sc1
    v_cvt_pk_bf16_f32 v38, v63, v67
    v_cvt_pk_bf16_f32 v39, v71, v75
    buffer_store_dwordx2 v[38:39], v123, s[20:23], s67 offen sc1
    s_mov_b32 s62, 0
    s_cmp_lg_u32 s16, 0
    s_cbranch_scc1 F_own2
F_res:
    s_cmp_eq_u32 s37, s33
    s_cbranch_scc1 F_res_d
    s_load_dwordx2 s[36:37], s[10:11], s63 glc
    s_add_u32 s62, s62, 1
    s_cmp_lt_u32 s62, 200000
    s_waitcnt lgkmcnt(0)
    s_cbranch_scc1 F_res
F_res_d:
    s_and_b32 s34, s36, 0x77
    s_cmp_lg_u32 s34, s47
    s_cbranch_scc1 L_fin
    v_lshrrev_b32 v108, 3, v2
    v_lshlrev_b32 v108, 12, v108
    v_and_b32 v109, 0x70, v126
    v_add_u32 v108, v108, v109
    s_cmp_eq_u32 s50, 0
    s_cbranch_scc1 F_n2_d
    s_mul_i32 s50, s33, 28
    s_mov_b32 s62, 0
F_n2:
    s_waitcnt lgkmcnt(0)
    s_add_u32 s84, s84, s68
    s_add_u32 s84, s84, s69
    s_add_u32 s84, s84, s70
    s_add_u32 s84, s84, s71
    s_add_u32 s84, s84, s72
    s_add_u32 s84, s84, s73
    s_add_u32 s84, s84, s74
    s_add_u32 s84, s84, s75
    s_add_u32 s84, s84, s76
    s_add_u32 s84, s84, s77
    s_add_u32 s84, s84, s78
    s_add_u32 s84, s84, s79
    s_add_u32 s84, s84, s80
    s_add_u32 s84, s84, s81
    s_add_u32 s84, s84, s85
    s_add_u32 s84, s84, s86
    s_add_u32 s84, s84, s87
    s_add_u32 s84, s84, s88
    s_add_u32 s84, s84, s89
    s_add_u32 s84, s84, s90
    s_add_u32 s84, s84, s91
    s_add_u32 s84, s84, s92
    s_add_u32 s84, s84, s93
    s_add_u32 s84, s84, s94
    s_add_u32 s84, s84, s95
    s_add_u32 s84, s84, s96
    s_add_u32 s84, s84, s97
    s_cmp_eq_u32 s84, s50
    s_cbranch_scc1 F_n2_d
    s_load_dwordx16 s[68:83], s[10:11], s48 glc
    s_load_dwordx16 s[84:99], s[10:11], s52 glc
    s_add_u32 s62, s62, 1
    s_cmp_lt_u32 s62, 200000
    s_cbranch_scc1 F_n2
F_n2_d:
    s_mov_b32 s62, 0
F_h2:
    s_mov_b32 s34, s49
    buffer_load_dwordx4 v[8:11], v108, s[24:27], s34 offen sc1
    s_add_u32 s34, s34, 32768
    buffer_load_dwordx4 v[12:15], v108, s[24:27], s34 offen sc1
    s_add_u32 s34, s34, 32768
    buffer_load_dwordx4 v[24:27], v108, s[24:27], s34 offen sc1
    s_add_u32 s34, s34, 32768
    buffer_load_dwordx4 v[28:31], v108, s[24:27], s34 offen sc1
    s_add_u32 s34, s34, 32768
    buffer_load_dwordx4 v[48:51], v108, s[24:27], s34 offen sc1
    s_add_u32 s34, s34, 32768
    buffer_load_dwordx4 v[52:55], v108, s[24:27], s34 offen sc1
    s_add_u32 s34, s34, 32768
    buffer_load_dwordx4 v[56:59], v108, s[24:27], s34 offen sc1
    s_cmp_lg_u32 s62, 0
    s_cbranch_scc1 F_h2_w
F_own2:
    s_bfe_u32 s38, s36, 0x20007
    s_bfe_u32 s39, s36, 0x20009
    s_bfe_u32 s51, s36, 0x10003
    s_set_gpr_idx_on s38, 1
    v_mov_b32 v40, v92
    v_mov_b32 v41, v96
    v_mov_b32 v42, v100
    v_mov_b32 v43, v104
    v_mov_b32 v44, v16
    v_mov_b32 v45, v20
    s_set_gpr_idx_off
    s_lshl1_add_u32 s34, s39, s51
    s_lshl_b32 s44, s34, 3
    v_add_u32 v114, s53, v126
    ds_write_b128 v114, v[40:43] offset:2560
    v_and_b32 v113, 7, v2
    v_lshl_add_u32 v113, v113, 2, v4
    s_lshl4_add_u32 s34, s44, s53
    v_lshl_add_u32 v112, v113, 2, s34
    ds_read_b32 v112, v112 offset:2560
    s_lshl2_add_u32 s34, s38, s39
    s_lshl_b32 s34, s34, 6
    s_mul_i32 s35, s51, 1152
    s_add_u32 s34, s34, s35
    s_add_u32 s34, s34, s53
    v_lshlrev_b32 v113, 1, v113
    v_add_u32 v110, s34, v113
    ds_read_u16 v110, v110
    v_readlane_b32 s45, v44, s44
    v_readlane_b32 s46, v45, s44
    s_and_b32 s34, s36, 0xfffff800
    s_ashr_i32 s35, s34, 31
    s_orn2_b32 s35, 0x80000000, s35
    s_xor_b32 s34, s34, s35
    v_mov_b32 v109, 0xbfb8aa3b
    v_mul_f32 v109, s34, v109
    v_exp_f32 v109, v109
    s_waitcnt lgkmcnt(0)
    v_lshlrev_b32 v110, 16, v110
    v_mov_b32 v111, s46
    v_add_f32 v109, 1.0, v109
    v_rcp_f32 v109, v109
    v_fmac_f32 v111, s45, v110
    v_mul_f32 v109, 0x41000000, v109
    s_and_b32 s38, s36, 2047
    s_lshl_b32 s38, s38, 11
    s_lshl_b32 s34, s57, 6
    s_add_u32 s38, s38, s34
    s_cmp_eq_u32 s16, 0
    s_cbranch_scc1 F_h2_w
    s_waitcnt vmcnt(4)
    v_pk_add_f32 v[88:89], v[8:9], v[12:13]
    v_pk_add_f32 v[90:91], v[10:11], v[14:15]
    v_pk_add_f32 v[88:89], v[88:89], v[24:25]
    v_pk_add_f32 v[90:91], v[90:91], v[26:27]
    v_pk_add_f32 v[88:89], v[88:89], v[28:29]
    v_pk_add_f32 v[90:91], v[90:91], v[30:31]
    v_pk_add_f32 v[88:89], v[88:89], v[48:49]
    v_pk_add_f32 v[90:91], v[90:91], v[50:51]
    v_pk_add_f32 v[88:89], v[88:89], v[52:53]
    v_pk_add_f32 v[90:91], v[90:91], v[54:55]
    v_pk_add_f32 v[88:89], v[88:89], v[56:57]
    v_pk_add_f32 v[90:91], v[90:91], v[58:59]
    s_nop 0
    v_permlane16_swap_b32 v88, v89
    v_permlane16_swap_b32 v90, v91
    v_add_f32 v88, v88, v89
    v_add_f32 v90, v90, v91
    s_nop 1
    v_permlane32_swap_b32 v88, v90
    v_add_f32 v88, v88, v90
    s_nop 1
    v_add_f32_dpp v88, v88, v88 row_ror:8 row_mask:0xf bank_mask:0xf
    v_cmp_u_f32 vcc, v88, v88
    v_fma_f32 v88, v88, v109, v111
    s_cbranch_vccz F_h2_d
    s_branch F_h2_x
F_h2_w:
    s_waitcnt vmcnt(5)
    v_pk_add_f32 v[88:89], v[8:9], v[12:13]
    v_pk_add_f32 v[90:91], v[10:11], v[14:15]
    s_waitcnt vmcnt(4)
    v_pk_add_f32 v[88:89], v[88:89], v[24:25]
    v_pk_add_f32 v[90:91], v[90:91], v[26:27]
    s_waitcnt vmcnt(3)
    v_pk_add_f32 v[88:89], v[88:89], v[28:29]
    v_pk_add_f32 v[90:91], v[90:91], v[30:31]
    s_waitcnt vmcnt(2)
    v_pk_add_f32 v[88:89], v[88:89], v[48:49]
    v_pk_add_f32 v[90:91], v[90:91], v[50:51]
    s_waitcnt vmcnt(1)
    v_pk_add_f32 v[88:89], v[88:89], v[52:53]
    v_pk_add_f32 v[90:91], v[90:91], v[54:55]
    s_waitcnt vmcnt(0)
    v_pk_add_f32 v[88:89], v[88:89], v[56:57]
    v_pk_add_f32 v[90:91], v[90:91], v[58:59]
    s_nop 0
    v_permlane16_swap_b32 v88, v89
    v_permlane16_swap_b32 v90, v91
    v_add_f32 v88, v88, v89
    v_add_f32 v90, v90, v91
    s_nop 1
    v_permlane32_swap_b32 v88, v90
    v_add_f32 v88, v88, v90
    s_nop 1
    v_add_f32_dpp v88, v88, v88 row_ror:8 row_mask:0xf bank_mask:0xf
    v_cmp_u_f32 vcc, v88, v88
    v_fma_f32 v88, v88, v109, v111
    s_cbranch_vccnz F_h2_x
F_h2_d:
    v_mul_f32 v89, 0xbe38aa3b, v88
    v_exp_f32 v89, v89
    v_mul_f32 v88, v88, v112
    v_add_f32 v89, 1.0, v89
    v_rcp_f32 v89, v89
    s_mov_b32 exec_lo, 0x00ff00ff
    s_mov_b32 exec_hi, 0x00ff00ff
    v_fmac_f32 v110, v88, v89
    v_cvt_pk_bf16_f32 v110, v110, v110
    buffer_store_short v110, v113, s[20:23], s38 offen sc1
    s_cmp_lg_u32 s57, 0
    s_cbranch_scc1 L_fin
    s_mov_b64 exec, 1
    v_mov_b32 v108, 0
    v_mov_b32 v109, s33
    buffer_store_dword v109, v108, s[24:27], 0 offen sc1
    s_branch L_fin
F_own:
    s_cmp_lg_u32 s37, s33
    s_cbranch_scc1 F_noh
    v_lshrrev_b32 v108, 3, v2
    v_lshlrev_b32 v108, 12, v108
    v_and_b32 v109, 0x70, v126
    v_add_u32 v108, v108, v109
    s_mov_b32 s34, s49
    buffer_load_dwordx4 v[8:11], v108, s[24:27], s34 offen sc1
    s_add_u32 s34, s34, 32768
    buffer_load_dwordx4 v[12:15], v108, s[24:27], s34 offen sc1
    s_add_u32 s34, s34, 32768
    buffer_load_dwordx4 v[24:27], v108, s[24:27], s34 offen sc1
    s_add_u32 s34, s34, 32768
    buffer_load_dwordx4 v[28:31], v108, s[24:27], s34 offen sc1
    s_add_u32 s34, s34, 32768
    buffer_load_dwordx4 v[48:51], v108, s[24:27], s34 offen sc1
    s_add_u32 s34, s34, 32768
    buffer_load_dwordx4 v[52:55], v108, s[24:27], s34 offen sc1
    s_add_u32 s34, s34, 32768
    buffer_load_dwordx4 v[56:59], v108, s[24:27], s34 offen sc1
    s_mov_b32 s16, 1
    s_branch F_noh
F_eh:
    s_load_dwordx16 s[68:83], s[10:11], s48 glc
    s_load_dwordx16 s[84:99], s[10:11], s52 glc
    s_branch F_eh_r
F_h2_x:
    v_max3_u32 v89, v8, v9, v10
    v_max3_u32 v89, v89, v11, v12
    v_max3_u32 v89, v89, v13, v14
    v_max3_u32 v89, v89, v15, v24
    v_max3_u32 v89, v89, v25, v26
    v_max3_u32 v89, v89, v27, v28
    v_max3_u32 v89, v89, v29, v30
    v_max3_u32 v89, v89, v31, v48
    v_max3_u32 v89, v89, v49, v50
    v_max3_u32 v89, v89, v51, v52
    v_max3_u32 v89, v89, v53, v54
    v_max3_u32 v89, v89, v55, v56
    v_max3_u32 v89, v89, v57, v58
    v_max_u32 v89, v89, v59
    v_cmp_eq_u32 vcc, -1, v89
    s_add_u32 s62, s62, 1
    s_cbranch_vccz F_h2_d
    s_cmp_lt_u32 s62, 200000
    s_cbranch_scc1 F_h2
    s_branch F_h2_d
F_zero:
    s_mov_b32 exec_lo, 0x01010101
    s_mov_b32 exec_hi, 0x01010101
    s_nop 2
    v_mov_b32 v92, 0
    v_mov_b32 v93, 0
    v_mov_b32 v94, 0
    v_mov_b32 v95, 0
    s_mov_b64 exec, -1
    s_branch F_nz
F_second:
    ds_read_b128 v[60:63], v126 offset:53760
    ds_read_b128 v[64:67], v126 offset:54784
    s_mov_b32 s46, 0
    s_mul_i32 s34, s44, 16640
    s_add_u32 s50, s50, 8320
    s_sub_u32 s50, s50, s34
    v_add_u32 v113, 1, v3
    v_bfe_i32 v113, v113, 4, 1
    v_and_b32 v113, 0xc2000000, v113
    v_xor_b32 v124, v113, v124
    v_xor_b32 v32, 0x80000000, v32
    v_xor_b32 v33, 0x80000000, v33
    v_xor_b32 v34, 0x80000000, v34
    v_xor_b32 v35, 0x80000000, v35
    v_xor_b32 v36, 0x80000000, v36
    v_xor_b32 v37, 0x80000000, v37
    v_xor_b32 v38, 0x80000000, v38
    v_xor_b32 v39, 0x80000000, v39
    v_mul_f32 v116, s70, v124
    v_fmac_f32 v116, v112, v124
    v_mfma_f32_16x16x32_bf16 v[76:79], v[8:11], v[32:35], 0
    v_mfma_f32_16x16x32_bf16 v[80:83], v[12:15], v[32:35], 0
    v_mfma_f32_16x16x32_bf16 v[84:87], v[8:11], v[36:39], 0
    v_mfma_f32_16x16x32_bf16 v[88:91], v[12:15], v[36:39], 0
    v_mfma_f32_16x16x32_bf16 v[92:95], v[16:19], v[32:35], 0
    v_mfma_f32_16x16x32_bf16 v[96:99], v[20:23], v[32:35], 0
    v_mfma_f32_16x16x32_bf16 v[100:103], v[16:19], v[36:39], 0
    v_mfma_f32_16x16x32_bf16 v[104:107], v[20:23], v[36:39], 0
    s_nop 2
    v_pk_mul_f32 v[84:85], v[84:85], s[54:55] op_sel:[0,0] op_sel_hi:[1,0]
    v_pk_mul_f32 v[86:87], v[86:87], s[54:55] op_sel:[0,0] op_sel_hi:[1,0]
    v_pk_mul_f32 v[88:89], v[88:89], s[54:55] op_sel:[0,0] op_sel_hi:[1,0]
    v_pk_mul_f32 v[90:91], v[90:91], s[54:55] op_sel:[0,0] op_sel_hi:[1,0]
    s_waitcnt lgkmcnt(0)
    s_barrier
    s_branch F_pass
F_key:
    v_mov_b32 v115, s33
    v_lshlrev_b32 v108, 11, v2
    s_lshl3_add_u32 s35, s2, 8192
    s_mov_b32 exec_lo, 0xff
    s_mov_b32 exec_hi, 0x0
    buffer_store_dwordx2 v[114:115], v108, s[24:27], s35 offen sc1
    s_mov_b64 exec, -1
    s_mov_b32 s71, 1
    s_branch F_nokey
F_wkey:
    s_waitcnt vmcnt(2)
    s_branch F_wkey_r
M_entry:
    s_sub_u32 s28, s2, 256
    s_lshr_b32 s29, s28, 1
    s_xor_b32 s29, s29, s28
    s_and_b32 s29, s29, 8
    s_mul_i32 s29, s29, 3
    s_xor_b32 s28, s28, s29
    s_lshr_b32 s29, s28, 4
    s_bfe_u32 s30, s28, 0x20001
    s_lshl2_add_u32 s29, s29, s30
    s_and_b32 s30, s28, 1
    s_lshl_b32 s30, s30, 1
    s_bitcmp1_b32 s28, 3
    s_addc_u32 s30, s30, 0
    s_setprio 3
    v_mov_b32 v7, 1152
    s_mov_b32 s26, 268435456
    s_mov_b32 s27, 0x20000
    v_mov_b32 v8, 0
    v_mov_b32 v9, 0
    v_mov_b32 v10, 0
    v_mov_b32 v11, 0
    v_mov_b32 v114, 0
    ds_write_b128 v7, v[8:11]
    ds_write_b128 v7, v[8:11] offset:16
    ds_write_b128 v7, v[8:11] offset:32
    v_mov_b32 v8, 0x3f803f80
    v_mov_b32 v9, 0x3f803f80
    v_lshlrev_b32 v10, 3, v2
    ds_write_b64 v10, v[8:9] offset:512
    s_waitcnt lgkmcnt(0)
    s_load_dword s16, s[10:11], 0
    s_mul_i32 s12, s3, 320
    s_min_u32 s12, s12, 2048
    s_add_u32 s18, s12, 7872
    s_and_b32 s13, s28, 7
    s_lshl_b32 s13, s13, 11
    s_add_u32 s12, s12, s13
    s_add_u32 s12, s12, 7872
    s_add_u32 s12, s10, s12
    s_addc_u32 s13, s11, 0
    s_barrier
    s_waitcnt lgkmcnt(0)
    s_mul_i32 s16, s16, 0x9e3779b1
    s_add_u32 s16, s16, 0x7f4a7c15
    s_mul_i32 s15, s16, 40
    s_mov_b32 s17, 0
    s_sub_u32 s31, s3, 2
    s_cmp_lt_u32 s31, 4
    s_cbranch_scc1 M_pre
    v_mov_b32 v8, 1152
    s_mov_b32 s62, 0
M_pg:
    ds_read_b32 v9, v8
    s_waitcnt lgkmcnt(0)
    v_cmp_gt_u32 vcc, 8, v9
    s_add_u32 s62, s62, 1
    s_cbranch_vccz M_pg_d
    s_sleep 1
    s_cmp_lt_u32 s62, 1000000
    s_cbranch_scc1 M_pg
M_pg_d:
    s_branch M_scan0
M_pre:
    s_and_b32 s46, s28, 7
    s_lshl2_add_u32 s6, s46, s31
    s_lshl_b32 s6, s6, 6
    s_lshr_b32 s44, s28, 3
    s_lshr_b32 s34, s31, 1
    s_lshl1_add_u32 s44, s44, s34
    s_lshl4_add_u32 s44, s44, s46
    s_and_b32 s34, s31, 1
    s_lshl1_add_u32 s44, s44, s34
    s_lshl_b32 s44, s44, 7
    v_lshrrev_b32 v114, 5, v2
    v_mul_u32_u24 v114, 0x4800, v114
    v_xor_b32 v114, s44, v114
    v_and_b32 v115, 31, v2
    v_lshl_add_u32 v114, v115, 2, v114
    s_mov_b32 s44, 262144
    s_lshl2_add_u32 s45, s29, s30
    s_lshl_b32 s45, s45, 10
    s_lshl_b32 s34, s31, 8
    s_add_u32 s45, s45, s34
    s_add_u32 s45, s45, 491520
    s_lshl_b32 s34, s31, 6
    v_lshl_add_u32 v113, v2, 2, s34
    s_mov_b32 s7, s45
    v_bfe_u32 v8, v2, 2, 2
    v_lshl_add_u32 v9, v4, 2, v8
    v_and_b32 v10, 7, v9
    v_lshlrev_b32 v10, 1, v10
    v_bfe_u32 v11, v2, 1, 1
    s_lshl_b32 s34, s31, 2
    v_or_b32 v12, s34, v11
    v_xor_b32 v12, v12, v10
    v_lshlrev_b32 v12, 4, v12
    v_lshl_add_u32 v12, v9, 8, v12
    v_and_b32 v13, 1, v2
    v_lshl_add_u32 v12, v13, 3, v12
    v_xor_b32 v126, 32, v12
    s_lshl_b32 s34, s31, 3
    v_or_b32 v120, s34, v11
    v_xor_b32 v120, v120, v10
    v_lshlrev_b32 v120, 4, v120
    v_lshl_add_u32 v120, v9, 9, v120
    v_lshl_add_u32 v120, v13, 3, v120
    v_xor_b32 v121, 32, v120
    v_xor_b32 v122, 64, v120
    v_xor_b32 v123, 96, v120
    v_lshlrev_b32 v14, 4, v4
    v_and_b32 v15, 1, v2
    v_lshl_add_u32 v15, v15, 9, v14
    v_mov_b32 v8, 1152
    s_mov_b32 s62, 0
M_wg6:
    ds_read_b32 v9, v8
    s_waitcnt lgkmcnt(0)
    v_cmp_gt_u32 vcc, 6, v9
    s_add_u32 s62, s62, 1
    s_cbranch_vccz M_wg6_d
    s_sleep 1
    s_cmp_lt_u32 s62, 1000000
    s_cbranch_scc1 M_wg6
M_wg6_d:
    ds_read_b64_tr_b16 v[16:17], v12 offset:1280
    ds_read_b64_tr_b16 v[18:19], v12 offset:5376
    ds_read_b64_tr_b16 v[32:33], v126 offset:1280
    ds_read_b64_tr_b16 v[34:35], v126 offset:5376
    ds_read_b64_tr_b16 v[20:21], v12 offset:9472
    ds_read_b64_tr_b16 v[22:23], v12 offset:13568
    ds_read_b64_tr_b16 v[36:37], v126 offset:9472
    ds_read_b64_tr_b16 v[38:39], v126 offset:13568
    ds_read_b64_tr_b16 v[24:25], v12 offset:17664
    ds_read_b64_tr_b16 v[26:27], v12 offset:21760
    ds_read_b64_tr_b16 v[40:41], v126 offset:17664
    ds_read_b64_tr_b16 v[42:43], v126 offset:21760
    v_mov_b32 v8, 1
    s_waitcnt lgkmcnt(0)
    s_mov_b64 exec, 1
    ds_add_u32 v7, v8 offset:4
    s_mov_b64 exec, -1
    v_mov_b32 v8, 1152
    s_mov_b32 s62, 0
M_wg:
    ds_read_b32 v9, v8
    s_waitcnt lgkmcnt(0)
    v_cmp_gt_u32 vcc, 8, v9
    s_add_u32 s62, s62, 1
    s_cbranch_vccz M_wg_d
    s_sleep 1
    s_cmp_lt_u32 s62, 1000000
    s_cbranch_scc1 M_wg
M_wg_d:
    ds_read_b64_tr_b16 v[28:29], v12 offset:25856
    ds_read_b64_tr_b16 v[30:31], v12 offset:29952
    ds_read_b64_tr_b16 v[44:45], v126 offset:25856
    ds_read_b64_tr_b16 v[46:47], v126 offset:29952
M_scan0:
    s_lshl_b32 s15, s16, 3
    s_mov_b32 s19, 0
    v_mov_b32 v10, 0
    s_load_dwordx16 s[20:35], s[12:13], 0
    s_load_dwordx16 s[36:51], s[12:13], 64
    s_load_dwordx16 s[52:67], s[12:13], 128
    s_load_dwordx16 s[68:83], s[12:13], 192
    s_load_dwordx16 s[84:99], s[12:13], 256
    v_mov_b32 v8, 1
    s_mov_b64 exec, 1
    s_waitcnt lgkmcnt(0)
    ds_add_u32 v7, v8 offset:24
    s_mov_b64 exec, -1
    s_branch M_scan1
M_scan:
    s_waitcnt lgkmcnt(0)
M_scan1:
    s_add_u32 s14, s21, s23
    s_add_u32 s14, s14, s25
    s_add_u32 s14, s14, s27
    s_add_u32 s14, s14, s29
    s_add_u32 s14, s14, s31
    s_add_u32 s14, s14, s33
    s_add_u32 s14, s14, s35
    s_cmp_lg_u32 s14, s15
    s_cbranch_scc1 M_sec0
    v_max_u32 v10, s20, v10
    v_max_u32 v10, s22, v10
    v_max_u32 v10, s24, v10
    v_max_u32 v10, s26, v10
    v_max_u32 v10, s28, v10
    v_max_u32 v10, s30, v10
    v_max_u32 v10, s32, v10
    v_max_u32 v10, s34, v10
    s_bitset1_b32 s19, 0
    s_mov_b32 s21, 0
M_sec0:
    s_add_u32 s14, s37, s39
    s_add_u32 s14, s14, s41
    s_add_u32 s14, s14, s43
    s_add_u32 s14, s14, s45
    s_add_u32 s14, s14, s47
    s_add_u32 s14, s14, s49
    s_add_u32 s14, s14, s51
    s_cmp_lg_u32 s14, s15
    s_cbranch_scc1 M_sec1
    v_max_u32 v10, s36, v10
    v_max_u32 v10, s38, v10
    v_max_u32 v10, s40, v10
    v_max_u32 v10, s42, v10
    v_max_u32 v10, s44, v10
    v_max_u32 v10, s46, v10
    v_max_u32 v10, s48, v10
    v_max_u32 v10, s50, v10
    s_bitset1_b32 s19, 1
    s_mov_b32 s37, 0
M_sec1:
    s_add_u32 s14, s53, s55
    s_add_u32 s14, s14, s57
    s_add_u32 s14, s14, s59
    s_add_u32 s14, s14, s61
    s_add_u32 s14, s14, s63
    s_add_u32 s14, s14, s65
    s_add_u32 s14, s14, s67
    s_cmp_lg_u32 s14, s15
    s_cbranch_scc1 M_sec2
    v_max_u32 v10, s52, v10
    v_max_u32 v10, s54, v10
    v_max_u32 v10, s56, v10
    v_max_u32 v10, s58, v10
    v_max_u32 v10, s60, v10
    v_max_u32 v10, s62, v10
    v_max_u32 v10, s64, v10
    v_max_u32 v10, s66, v10
    s_bitset1_b32 s19, 2
    s_mov_b32 s53, 0
M_sec2:
    s_add_u32 s14, s69, s71
    s_add_u32 s14, s14, s73
    s_add_u32 s14, s14, s75
    s_add_u32 s14, s14, s77
    s_add_u32 s14, s14, s79
    s_add_u32 s14, s14, s81
    s_add_u32 s14, s14, s83
    s_cmp_lg_u32 s14, s15
    s_cbranch_scc1 M_sec3
    v_max_u32 v10, s68, v10
    v_max_u32 v10, s70, v10
    v_max_u32 v10, s72, v10
    v_max_u32 v10, s74, v10
    v_max_u32 v10, s76, v10
    v_max_u32 v10, s78, v10
    v_max_u32 v10, s80, v10
    v_max_u32 v10, s82, v10
    s_bitset1_b32 s19, 3
    s_mov_b32 s69, 0
M_sec3:
    s_add_u32 s14, s85, s87
    s_add_u32 s14, s14, s89
    s_add_u32 s14, s14, s91
    s_add_u32 s14, s14, s93
    s_add_u32 s14, s14, s95
    s_add_u32 s14, s14, s97
    s_add_u32 s14, s14, s99
    s_cmp_lg_u32 s14, s15
    s_cbranch_scc1 M_sec4
    v_max_u32 v10, s84, v10
    v_max_u32 v10, s86, v10
    v_max_u32 v10, s88, v10
    v_max_u32 v10, s90, v10
    v_max_u32 v10, s92, v10
    v_max_u32 v10, s94, v10
    v_max_u32 v10, s96, v10
    v_max_u32 v10, s98, v10
    s_bitset1_b32 s19, 4
    s_mov_b32 s85, 0
M_sec4:
    s_cmp_eq_u32 s19, 31
    s_cbranch_scc1 M_scan_d
    s_add_u32 s17, s17, 1
    s_add_u32 s14, s2, s17
    s_and_b32 s14, s14, 7
    s_lshl_b32 s14, s14, 11
    s_add_u32 s14, s14, s18
    s_add_u32 s12, s10, s14
    s_addc_u32 s13, s11, 0
    s_sleep 2
    s_cmp_ge_u32 s17, 8
    s_cbranch_scc1 M_scan_u
    s_bitcmp1_b32 s19, 0
    s_cbranch_scc1 M_rla0
    s_load_dwordx16 s[20:35], s[12:13], 0
M_rla0:
    s_bitcmp1_b32 s19, 1
    s_cbranch_scc1 M_rla1
    s_load_dwordx16 s[36:51], s[12:13], 64
M_rla1:
    s_bitcmp1_b32 s19, 2
    s_cbranch_scc1 M_rla2
    s_load_dwordx16 s[52:67], s[12:13], 128
M_rla2:
    s_bitcmp1_b32 s19, 3
    s_cbranch_scc1 M_rla3
    s_load_dwordx16 s[68:83], s[12:13], 192
M_rla3:
    s_bitcmp1_b32 s19, 4
    s_cbranch_scc1 M_rla4
    s_load_dwordx16 s[84:99], s[12:13], 256
M_rla4:
    s_branch M_scan
M_scan_u:
    s_bitcmp1_b32 s19, 0
    s_cbranch_scc1 M_rlb0
    s_load_dwordx16 s[20:35], s[12:13], 0 glc
M_rlb0:
    s_bitcmp1_b32 s19, 1
    s_cbranch_scc1 M_rlb1
    s_load_dwordx16 s[36:51], s[12:13], 64 glc
M_rlb1:
    s_bitcmp1_b32 s19, 2
    s_cbranch_scc1 M_rlb2
    s_load_dwordx16 s[52:67], s[12:13], 128 glc
M_rlb2:
    s_bitcmp1_b32 s19, 3
    s_cbranch_scc1 M_rlb3
    s_load_dwordx16 s[68:83], s[12:13], 192 glc
M_rlb3:
    s_bitcmp1_b32 s19, 4
    s_cbranch_scc1 M_rlb4
    s_load_dwordx16 s[84:99], s[12:13], 256 glc
M_rlb4:
    s_cmp_lt_u32 s17, 200000
    s_cbranch_scc1 M_scan
    s_waitcnt lgkmcnt(0)
M_scan_d:
    v_mov_b32 v8, 1
    s_mov_b64 exec, 1
    ds_max_u32 v7, v10 offset:16
    ds_add_u32 v7, v8 offset:20
    s_mov_b64 exec, -1
    s_sub_u32 s31, s3, 2
    s_cmp_lt_u32 s31, 4
    s_cbranch_scc1 M_comp
    s_mov_b32 s33, s16
    s_sub_u32 s28, s2, 256
    s_lshr_b32 s29, s28, 1
    s_xor_b32 s29, s29, s28
    s_and_b32 s29, s29, 8
    s_mul_i32 s29, s29, 3
    s_xor_b32 s28, s28, s29
    s_lshr_b32 s29, s28, 4
    s_bfe_u32 s30, s28, 0x20001
    s_lshl2_add_u32 s29, s29, s30
    s_and_b32 s30, s28, 1
    s_lshl_b32 s30, s30, 1
    s_bitcmp1_b32 s28, 3
    s_addc_u32 s30, s30, 0
    s_mov_b64 s[24:25], s[10:11]
    s_mov_b32 s26, 268435456
    s_mov_b32 s27, 0x20000
    s_cmp_ge_u32 s3, 6
    s_cbranch_scc1 M_agent
    s_cmp_ge_u32 s3, 6
    s_cbranch_scc1 L_fin
    s_cmp_eq_u32 s3, 1
    s_branch M_poller
M_agent:
    s_and_b32 s47, s28, 7
    s_lshl_b32 s47, s47, 8
    s_mov_b32 s49, 0
    s_mov_b32 s62, 0
M_ag:
    ds_read_b64 v[8:9], v7 offset:16
    s_waitcnt lgkmcnt(0)
    v_readfirstlane_b32 s48, v8
    v_readfirstlane_b32 s46, v9
    s_nop 0
    s_cmp_ge_u32 s46, 7
    s_cbranch_scc1 L_fin
    s_cmp_eq_u32 s48, s49
    s_cbranch_scc1 M_ag_n
    s_mov_b32 s49, s48
    s_and_b32 s34, s48, 2047
    s_lshl_b32 s34, s34, 11
    s_add_u32 s34, s34, s47
    s_load_dword s54, s[4:5], s34
    s_add_u32 s34, s34, 64
    s_load_dword s55, s[4:5], s34
    s_add_u32 s34, s34, 64
    s_load_dword s56, s[4:5], s34
    s_add_u32 s34, s34, 64
    s_load_dword s57, s[4:5], s34
    s_and_b32 s50, s48, 7
    s_bfe_u32 s34, s48, 0x40003
    s_lshl4_add_u32 s50, s50, s34
    s_bfe_u32 s34, s48, 0x40007
    s_lshl4_add_u32 s50, s50, s34
    s_lshl3_add_u32 s50, s50, 24576
    s_load_dwordx2 s[52:53], s[10:11], s50
M_ag_n:
    s_add_u32 s62, s62, 1
    s_cmp_lt_u32 s62, 1000000
    s_cbranch_scc1 M_ag
    s_branch L_fin
M_loader2:
    v_mov_b32 v7, 1152
    s_mov_b32 s26, 268435456
    s_mov_b32 s27, 0x20000
    v_xor_b32 v18, 128, v8
    s_lshr_b32 s29, s28, 4
    s_bfe_u32 s30, s28, 0x20001
    s_lshl2_add_u32 s29, s29, s30
    s_and_b32 s30, s28, 1
    s_lshl_b32 s30, s30, 1
    s_bitcmp1_b32 s28, 3
    s_addc_u32 s30, s30, 0
    s_mov_b64 s[24:25], s[10:11]
    s_mov_b32 s16, s40
    s_and_b32 s17, s41, 0xffff
    s_mov_b32 s18, 7340032
    s_mov_b32 s19, 0x20000
    s_mov_b32 s47, 3
    s_barrier
M_ld3:
    s_mov_b32 m0, s46
    s_add_u32 s46, s46, 1024
    buffer_load_dwordx4 v8, s[12:15], s45 offen nt lds
    s_add_u32 s45, s45, 28672
    s_waitcnt vmcnt(12)
    s_mov_b32 m0, s46
    s_add_u32 s46, s46, 1024
    buffer_load_dwordx4 v18, s[12:15], s45 offen nt lds
    s_add_u32 s45, s45, 28672
    s_waitcnt vmcnt(12)
    s_mov_b32 m0, s46
    s_add_u32 s46, s46, 1024
    buffer_load_dwordx4 v8, s[12:15], s45 offen nt lds
    s_add_u32 s45, s45, 28672
    s_waitcnt vmcnt(12)
    s_mov_b32 m0, s46
    s_add_u32 s46, s46, 1024
    buffer_load_dwordx4 v18, s[12:15], s45 offen nt lds
    s_add_u32 s45, s45, 28672
    s_waitcnt vmcnt(12)
    s_add_u32 s47, s47, 1
    s_getreg_b32 s35, hwreg(HW_REG_IB_STS)
    s_bfe_u32 s48, s35, 0x20016
    s_and_b32 s35, s35, 15
    s_lshl4_add_u32 s35, s48, s35
    s_add_u32 s35, s35, 3
    s_lshr_b32 s35, s35, 2
    s_sub_u32 s35, s47, s35
    v_mov_b32 v16, s35
    s_mov_b64 exec, 1
    ds_max_i32 v7, v16
    s_mov_b64 exec, -1
    s_cmp_lt_u32 s47, 5
    s_cbranch_scc1 M_ld3
M_ld5:
    s_mov_b32 m0, s46
    s_add_u32 s46, s46, 1024
    buffer_load_dwordx4 v8, s[12:15], s45 offen nt lds
    s_add_u32 s45, s45, 28672
    s_waitcnt vmcnt(28)
    s_mov_b32 m0, s46
    s_add_u32 s46, s46, 1024
    buffer_load_dwordx4 v18, s[12:15], s45 offen nt lds
    s_add_u32 s45, s45, 28672
    s_waitcnt vmcnt(28)
    s_mov_b32 m0, s46
    s_add_u32 s46, s46, 1024
    buffer_load_dwordx4 v8, s[12:15], s45 offen nt lds
    s_add_u32 s45, s45, 28672
    s_waitcnt vmcnt(28)
    s_mov_b32 m0, s46
    s_add_u32 s46, s46, 1024
    buffer_load_dwordx4 v18, s[12:15], s45 offen nt lds
    s_add_u32 s45, s45, 28672
    s_waitcnt vmcnt(28)
    s_add_u32 s47, s47, 1
    s_getreg_b32 s35, hwreg(HW_REG_IB_STS)
    s_bfe_u32 s48, s35, 0x20016
    s_and_b32 s35, s35, 15
    s_lshl4_add_u32 s35, s48, s35
    s_add_u32 s35, s35, 3
    s_lshr_b32 s35, s35, 2
    s_sub_u32 s35, s47, s35
    v_mov_b32 v16, s35
    s_mov_b64 exec, 1
    ds_max_i32 v7, v16
    s_mov_b64 exec, -1
    s_cmp_lt_u32 s47, 8
    s_cbranch_scc1 M_ld5
    s_mov_b32 s20, s42
    s_and_b32 s21, s43, 0xffff
    s_mov_b32 s22, 7340032
    s_mov_b32 s23, 0x20000
    v_lshrrev_b32 v9, 5, v2
    v_and_b32 v10, 31, v2
    v_add_u32 v11, 0, v9
    v_lshlrev_b32 v12, 1, v11
    v_xor_b32 v12, v12, v10
    v_lshlrev_b32 v12, 4, v12
    v_lshl_add_u32 v12, v11, 11, v12
    v_add_u32 v11, 2, v9
    v_lshlrev_b32 v13, 1, v11
    v_xor_b32 v13, v13, v10
    v_lshlrev_b32 v13, 4, v13
    v_lshl_add_u32 v13, v11, 11, v13
    v_add_u32 v11, 4, v9
    v_lshlrev_b32 v14, 1, v11
    v_xor_b32 v14, v14, v10
    v_lshlrev_b32 v14, 4, v14
    v_lshl_add_u32 v14, v11, 11, v14
    v_add_u32 v11, 6, v9
    v_lshlrev_b32 v15, 1, v11
    v_xor_b32 v15, v15, v10
    v_lshlrev_b32 v15, 4, v15
    v_lshl_add_u32 v15, v11, 11, v15
    s_lshl_b32 s44, s29, 17
    s_lshl_b32 s35, s30, 9
    s_add_u32 s44, s44, s35
    s_mov_b32 s46, 34048
    s_xor_b32 s45, s34, 512
M_ld8:
    s_mov_b32 m0, s46
    s_add_u32 s46, s46, 1024
    buffer_load_dwordx4 v8, s[16:19], s45 offen nt lds
    s_add_u32 s45, s45, 28672
    s_waitcnt vmcnt(28)
    s_mov_b32 m0, s46
    s_add_u32 s46, s46, 1024
    buffer_load_dwordx4 v18, s[16:19], s45 offen nt lds
    s_add_u32 s45, s45, 28672
    s_waitcnt vmcnt(28)
    s_mov_b32 m0, s46
    s_add_u32 s46, s46, 1024
    buffer_load_dwordx4 v8, s[16:19], s45 offen nt lds
    s_add_u32 s45, s45, 28672
    s_waitcnt vmcnt(28)
    s_mov_b32 m0, s46
    s_add_u32 s46, s46, 1024
    buffer_load_dwordx4 v18, s[16:19], s45 offen nt lds
    s_add_u32 s45, s45, 28672
    s_waitcnt vmcnt(28)
    s_add_u32 s47, s47, 1
    s_getreg_b32 s35, hwreg(HW_REG_IB_STS)
    s_bfe_u32 s48, s35, 0x20016
    s_and_b32 s35, s35, 15
    s_lshl4_add_u32 s35, s48, s35
    s_add_u32 s35, s35, 3
    s_lshr_b32 s35, s35, 2
    s_sub_u32 s35, s47, s35
    v_mov_b32 v16, s35
    s_mov_b64 exec, 1
    ds_max_i32 v7, v16
    s_mov_b64 exec, -1
    s_cmp_lt_u32 s47, 16
    s_cbranch_scc1 M_ld8
    v_mov_b32 v20, 1156
    s_mov_b32 s62, 0
M_wgc:
    ds_read_b32 v21, v20
    s_waitcnt lgkmcnt(0)
    v_cmp_gt_u32 vcc, 4, v21
    s_add_u32 s62, s62, 1
    s_cbranch_vccz M_wgc_d
    s_sleep 1
    s_cmp_lt_u32 s62, 1000000
    s_cbranch_scc1 M_wgc
M_wgc_d:
    s_mov_b32 s46, 1280
M_ld16:
    s_mov_b32 m0, s46
    s_add_u32 s46, s46, 1024
    buffer_load_dwordx4 v12, s[20:23], s44 offen nt lds
    s_waitcnt vmcnt(28)
    s_mov_b32 m0, s46
    s_add_u32 s46, s46, 1024
    buffer_load_dwordx4 v13, s[20:23], s44 offen nt lds
    s_waitcnt vmcnt(28)
    s_mov_b32 m0, s46
    s_add_u32 s46, s46, 1024
    buffer_load_dwordx4 v14, s[20:23], s44 offen nt lds
    s_waitcnt vmcnt(28)
    s_mov_b32 m0, s46
    s_add_u32 s46, s46, 1024
    buffer_load_dwordx4 v15, s[20:23], s44 offen nt lds
    s_waitcnt vmcnt(28)
    s_add_u32 s44, s44, 16384
    s_add_u32 s47, s47, 1
    s_getreg_b32 s35, hwreg(HW_REG_IB_STS)
    s_bfe_u32 s48, s35, 0x20016
    s_and_b32 s35, s35, 15
    s_lshl4_add_u32 s35, s48, s35
    s_add_u32 s35, s35, 3
    s_lshr_b32 s35, s35, 2
    s_sub_u32 s35, s47, s35
    v_mov_b32 v16, s35
    s_mov_b64 exec, 1
    ds_max_i32 v7, v16
    s_mov_b64 exec, -1
    s_cmp_lt_u32 s47, 22
    s_cbranch_scc1 M_ld16
    v_mov_b32 v20, 1176
    s_mov_b32 s62, 0
M_wgd:
    ds_read_b32 v21, v20
    s_waitcnt lgkmcnt(0)
    v_cmp_gt_u32 vcc, 7, v21
    s_add_u32 s62, s62, 1
    s_cbranch_vccz M_wgd_d
    s_sleep 1
    s_cmp_lt_u32 s62, 1000000
    s_cbranch_scc1 M_wgd
M_wgd_d:
M_ld22:
    s_mov_b32 m0, s46
    s_add_u32 s46, s46, 1024
    buffer_load_dwordx4 v12, s[20:23], s44 offen nt lds
    s_waitcnt vmcnt(28)
    s_mov_b32 m0, s46
    s_add_u32 s46, s46, 1024
    buffer_load_dwordx4 v13, s[20:23], s44 offen nt lds
    s_waitcnt vmcnt(28)
    s_mov_b32 m0, s46
    s_add_u32 s46, s46, 1024
    buffer_load_dwordx4 v14, s[20:23], s44 offen nt lds
    s_waitcnt vmcnt(28)
    s_mov_b32 m0, s46
    s_add_u32 s46, s46, 1024
    buffer_load_dwordx4 v15, s[20:23], s44 offen nt lds
    s_waitcnt vmcnt(28)
    s_add_u32 s44, s44, 16384
    s_add_u32 s47, s47, 1
    s_getreg_b32 s35, hwreg(HW_REG_IB_STS)
    s_bfe_u32 s48, s35, 0x20016
    s_and_b32 s35, s35, 15
    s_lshl4_add_u32 s35, s48, s35
    s_add_u32 s35, s35, 3
    s_lshr_b32 s35, s35, 2
    s_sub_u32 s35, s47, s35
    v_mov_b32 v16, s35
    s_mov_b64 exec, 1
    ds_max_i32 v7, v16
    s_mov_b64 exec, -1
    s_cmp_lt_u32 s47, 24
    s_cbranch_scc1 M_ld22
    s_mov_b64 exec, 1
    v_mov_b32 v16, 18
    s_waitcnt vmcnt(24)
    ds_max_i32 v7, v16
    v_mov_b32 v16, 19
    s_waitcnt vmcnt(20)
    ds_max_i32 v7, v16
    v_mov_b32 v16, 20
    s_waitcnt vmcnt(16)
    ds_max_i32 v7, v16
    v_mov_b32 v16, 21
    s_waitcnt vmcnt(12)
    ds_max_i32 v7, v16
    v_mov_b32 v16, 22
    s_waitcnt vmcnt(8)
    ds_max_i32 v7, v16
    v_mov_b32 v16, 23
    s_waitcnt vmcnt(4)
    ds_max_i32 v7, v16
    v_mov_b32 v16, 24
    s_waitcnt vmcnt(0)
    ds_write_b32 v7, v16
    s_waitcnt lgkmcnt(0)
    s_barrier
    s_branch L_fin
M_comp:
    s_mov_b32 s62, 0
M_box:
    ds_read_b64 v[8:9], v7 offset:16
    s_waitcnt lgkmcnt(0)
    v_cmp_gt_u32 vcc, 7, v9
    s_add_u32 s62, s62, 1
    s_cbranch_vccz M_box_d
    s_cmp_lt_u32 s62, 1000000
    s_cbranch_scc1 M_box
M_box_d:
    v_readfirstlane_b32 s48, v8
    s_nop 0
    s_and_b32 s34, s48, 2047
    s_lshl_b32 s34, s34, 11
    s_add_u32 s34, s34, s6
    s_load_dwordx16 s[64:79], s[4:5], s34
    s_and_b32 s50, s48, 7
    s_bfe_u32 s34, s48, 0x40003
    s_lshl4_add_u32 s50, s50, s34
    s_bfe_u32 s34, s48, 0x40007
    s_lshl4_add_u32 s50, s50, s34
    s_lshl3_add_u32 s50, s50, 24576
    s_load_dwordx2 s[52:53], s[10:11], s50
    s_mov_b32 s33, s16
    s_mov_b64 s[24:25], s[10:11]
    s_mov_b32 s26, 268435456
    s_mov_b32 s27, 0x20000
    s_mov_b32 s44, 262144
    s_mov_b32 s45, s7
    v_mov_b32 v8, 1
    s_waitcnt lgkmcnt(0)
    v_writelane_b32 v11, s64, 0
    v_writelane_b32 v11, s65, 1
    v_writelane_b32 v11, s66, 4
    v_writelane_b32 v11, s67, 5
    v_writelane_b32 v11, s68, 8
    v_writelane_b32 v11, s69, 9
    v_writelane_b32 v11, s70, 12
    v_writelane_b32 v11, s71, 13
    v_writelane_b32 v11, s72, 2
    v_writelane_b32 v11, s73, 3
    v_writelane_b32 v11, s74, 6
    v_writelane_b32 v11, s75, 7
    v_writelane_b32 v11, s76, 10
    v_writelane_b32 v11, s77, 11
    v_writelane_b32 v11, s78, 14
    v_writelane_b32 v11, s79, 15
    s_mov_b64 exec, 0xffff
    ds_write_b32 v113, v11 offset:0
    s_mov_b64 exec, 1
    ds_add_u32 v7, v8 offset:8
    s_mov_b64 exec, -1
    s_mov_b32 s62, 0
M_wx:
    ds_read_b128 v[8:11], v7
    s_waitcnt lgkmcnt(0)
    v_cmp_gt_u32 vcc, 4, v10
    s_add_u32 s62, s62, 1
    s_cbranch_vccz M_wx_d
    s_cmp_lt_u32 s62, 1000000
    s_cbranch_scc1 M_wx
M_wx_d:
    ds_read_b128 v[80:83], v15 offset:0
    ds_read_b128 v[84:87], v15 offset:64
    ds_read_b128 v[88:91], v15 offset:128
    ds_read_b128 v[92:95], v15 offset:192
    v_readfirstlane_b32 s56, v8
    s_nop 0
    s_cmp_ge_u32 s56, 10
    s_cbranch_scc1 M_wu0_k
    s_mov_b32 s62, 0
M_wu0:
    ds_read_b32 v8, v7
    s_waitcnt lgkmcnt(0)
    v_cmp_gt_u32 vcc, 10, v8
    s_add_u32 s62, s62, 1
    s_cbranch_vccz M_wu0_d
    s_sleep 1
    s_cmp_lt_u32 s62, 1000000
    s_cbranch_scc1 M_wu0
M_wu0_d:
    v_readfirstlane_b32 s56, v8
M_wu0_k:
    ds_read_b64_tr_b16 v[48:49], v12 offset:34048
    ds_read_b64_tr_b16 v[50:51], v12 offset:38144
    ds_read_b64_tr_b16 v[64:65], v126 offset:34048
    ds_read_b64_tr_b16 v[66:67], v126 offset:38144
    s_waitcnt lgkmcnt(4)
    v_mfma_f32_16x16x32_bf16 v[96:99], v[80:83], v[16:19], 0
    v_mfma_f32_16x16x32_bf16 v[104:107], v[80:83], v[32:35], 0
    v_mfma_f32_16x16x32_bf16 v[96:99], v[84:87], v[20:23], v[96:99]
    v_mfma_f32_16x16x32_bf16 v[104:107], v[84:87], v[36:39], v[104:107]
    v_mfma_f32_16x16x32_bf16 v[96:99], v[88:91], v[24:27], v[96:99]
    v_mfma_f32_16x16x32_bf16 v[104:107], v[88:91], v[40:43], v[104:107]
    v_mfma_f32_16x16x32_bf16 v[96:99], v[92:95], v[28:31], v[96:99]
    v_mfma_f32_16x16x32_bf16 v[104:107], v[92:95], v[44:47], v[104:107]
    s_mov_b32 s62, 0
M_sta:
    s_cmp_eq_u32 s53, s33
    s_cbranch_scc1 M_sta_d
    s_load_dwordx2 s[52:53], s[10:11], s50 glc
    s_add_u32 s62, s62, 1
    s_cmp_lt_u32 s62, 200000
    s_waitcnt lgkmcnt(0)
    s_cbranch_scc1 M_sta
M_sta_d:
    s_lshl_b32 s54, s52, 16
    s_and_b32 s52, s52, 0xffff0000
    v_mov_b32 v124, 0x3727c5ac
    v_add_f32 v124, s52, v124
    v_cvt_pk_bf16_f32 v124, v124, v124
    v_lshlrev_b32 v124, 16, v124
    v_sqrt_f32 v124, v124
    s_nop 0
    v_cvt_pk_bf16_f32 v124, v124, v124
    v_lshlrev_b32 v124, 16, v124
    v_rcp_f32 v124, v124
    s_cmp_ge_u32 s56, 12
    s_cbranch_scc1 M_wu1_k
    s_mov_b32 s62, 0
M_wu1:
    ds_read_b32 v8, v7
    s_waitcnt lgkmcnt(0)
    v_cmp_gt_u32 vcc, 12, v8
    s_add_u32 s62, s62, 1
    s_cbranch_vccz M_wu1_d
    s_sleep 1
    s_cmp_lt_u32 s62, 1000000
    s_cbranch_scc1 M_wu1
M_wu1_d:
    v_readfirstlane_b32 s56, v8
M_wu1_k:
    ds_read_b64_tr_b16 v[52:53], v12 offset:42240
    ds_read_b64_tr_b16 v[54:55], v12 offset:46336
    ds_read_b64_tr_b16 v[68:69], v126 offset:42240
    ds_read_b64_tr_b16 v[70:71], v126 offset:46336
    s_waitcnt lgkmcnt(4)
    v_mfma_f32_16x16x32_bf16 v[100:103], v[80:83], v[48:51], 0
    v_mfma_f32_16x16x32_bf16 v[108:111], v[80:83], v[64:67], 0
    s_cmp_ge_u32 s56, 14
    s_cbranch_scc1 M_wu2_k
    s_mov_b32 s62, 0
M_wu2:
    ds_read_b32 v8, v7
    s_waitcnt lgkmcnt(0)
    v_cmp_gt_u32 vcc, 14, v8
    s_add_u32 s62, s62, 1
    s_cbranch_vccz M_wu2_d
    s_sleep 1
    s_cmp_lt_u32 s62, 1000000
    s_cbranch_scc1 M_wu2
M_wu2_d:
    v_readfirstlane_b32 s56, v8
M_wu2_k:
    ds_read_b64_tr_b16 v[56:57], v12 offset:50432
    ds_read_b64_tr_b16 v[58:59], v12 offset:54528
    ds_read_b64_tr_b16 v[72:73], v126 offset:50432
    ds_read_b64_tr_b16 v[74:75], v126 offset:54528
    s_waitcnt lgkmcnt(4)
    v_mfma_f32_16x16x32_bf16 v[100:103], v[84:87], v[52:55], v[100:103]
    v_mfma_f32_16x16x32_bf16 v[108:111], v[84:87], v[68:71], v[108:111]
    s_cmp_ge_u32 s56, 16
    s_cbranch_scc1 M_wu3_k
    s_mov_b32 s62, 0
M_wu3:
    ds_read_b32 v8, v7
    s_waitcnt lgkmcnt(0)
    v_cmp_gt_u32 vcc, 16, v8
    s_add_u32 s62, s62, 1
    s_cbranch_vccz M_wu3_d
    s_cmp_lt_u32 s62, 1000000
    s_cbranch_scc1 M_wu3
M_wu3_d:
    v_readfirstlane_b32 s56, v8
M_wu3_k:
    ds_read_b64_tr_b16 v[60:61], v12 offset:58624
    ds_read_b64_tr_b16 v[62:63], v12 offset:62720
    ds_read_b64_tr_b16 v[76:77], v126 offset:58624
    ds_read_b64_tr_b16 v[78:79], v126 offset:62720
    s_waitcnt lgkmcnt(4)
    v_mfma_f32_16x16x32_bf16 v[100:103], v[88:91], v[56:59], v[100:103]
    v_mfma_f32_16x16x32_bf16 v[108:111], v[88:91], v[72:75], v[108:111]
    s_waitcnt lgkmcnt(2)
    v_mfma_f32_16x16x32_bf16 v[100:103], v[92:95], v[60:63], v[100:103]
    s_waitcnt lgkmcnt(0)
    v_mfma_f32_16x16x32_bf16 v[108:111], v[92:95], v[76:79], v[108:111]
    v_mov_b32 v9, 1
    v_mov_b32_dpp v96, v104 quad_perm:[0,1,2,3] row_mask:0x2 bank_mask:0xf
    v_mov_b32_dpp v97, v105 quad_perm:[0,1,2,3] row_mask:0x2 bank_mask:0xf
    s_nop 2
    v_mov_b32_dpp v96, v100 quad_perm:[0,1,2,3] row_mask:0x4 bank_mask:0xf
    v_mov_b32_dpp v97, v101 quad_perm:[0,1,2,3] row_mask:0x4 bank_mask:0xf
    s_nop 0
    v_mov_b32_dpp v96, v108 quad_perm:[0,1,2,3] row_mask:0x8 bank_mask:0xf
    v_mov_b32_dpp v97, v109 quad_perm:[0,1,2,3] row_mask:0x8 bank_mask:0xf
    v_fma_f32 v96, -v97, s54, v96
    v_mul_f32 v96, v96, v124
    buffer_store_dword v96, v114, s[24:27], s44 offen sc1
    s_mov_b64 exec, 1
    ds_add_u32 v7, v9 offset:12
    s_mov_b64 exec, -1
    v_mov_b32 v8, 1152
    s_mov_b32 s62, 0
M_wd0:
    ds_read_b32 v9, v8
    s_waitcnt lgkmcnt(0)
    v_cmp_gt_u32 vcc, 20, v9
    s_add_u32 s62, s62, 1
    s_cbranch_vccz M_wd0_d
    s_sleep 1
    s_cmp_lt_u32 s62, 1000000
    s_cbranch_scc1 M_wd0
M_wd0_d:
    ds_read_b64_tr_b16 v[16:17], v120 offset:1280
    ds_read_b64_tr_b16 v[18:19], v120 offset:9472
    ds_read_b64_tr_b16 v[24:25], v121 offset:1280
    ds_read_b64_tr_b16 v[26:27], v121 offset:9472
    ds_read_b64_tr_b16 v[32:33], v122 offset:1280
    ds_read_b64_tr_b16 v[34:35], v122 offset:9472
    ds_read_b64_tr_b16 v[40:41], v123 offset:1280
    ds_read_b64_tr_b16 v[42:43], v123 offset:9472
    v_mov_b32 v8, 1152
    s_mov_b32 s62, 0
M_wd1:
    ds_read_b32 v9, v8
    s_waitcnt lgkmcnt(0)
    v_cmp_gt_u32 vcc, 24, v9
    s_add_u32 s62, s62, 1
    s_cbranch_vccz M_wd1_d
    s_cmp_lt_u32 s62, 1000000
    s_cbranch_scc1 M_wd1
M_wd1_d:
    ds_read_b64_tr_b16 v[20:21], v120 offset:17664
    ds_read_b64_tr_b16 v[22:23], v120 offset:25856
    ds_read_b64_tr_b16 v[28:29], v121 offset:17664
    ds_read_b64_tr_b16 v[30:31], v121 offset:25856
    ds_read_b64_tr_b16 v[36:37], v122 offset:17664
    ds_read_b64_tr_b16 v[38:39], v122 offset:25856
    ds_read_b64_tr_b16 v[44:45], v123 offset:17664
    s_waitcnt lgkmcnt(4)
    ds_read_b64_tr_b16 v[46:47], v123 offset:25856
    v_lshlrev_b32 v8, 2, v2
    s_waitcnt lgkmcnt(0)
    s_barrier
    ds_read_b128 v[80:83], v14 offset:1024
    ds_read_b128 v[84:87], v14 offset:1088
    s_waitcnt lgkmcnt(1)
    v_mfma_f32_16x16x32_bf16 v[48:51], v[80:83], v[16:19], 0
    v_mfma_f32_16x16x32_bf16 v[52:55], v[80:83], v[24:27], 0
    v_mfma_f32_16x16x32_bf16 v[56:59], v[80:83], v[32:35], 0
    v_mfma_f32_16x16x32_bf16 v[60:63], v[80:83], v[40:43], 0
    s_waitcnt lgkmcnt(0)
    v_mfma_f32_16x16x32_bf16 v[48:51], v[84:87], v[20:23], v[48:51]
    v_mfma_f32_16x16x32_bf16 v[52:55], v[84:87], v[28:31], v[52:55]
    v_mfma_f32_16x16x32_bf16 v[56:59], v[84:87], v[36:39], v[56:59]
    v_mfma_f32_16x16x32_bf16 v[60:63], v[84:87], v[44:47], v[60:63]
    s_nop 5
    v_mov_b32_dpp v48, v52 quad_perm:[0,1,2,3] row_mask:0x2 bank_mask:0xf
    s_nop 1
    v_mov_b32_dpp v48, v56 quad_perm:[0,1,2,3] row_mask:0x4 bank_mask:0xf
    s_nop 1
    v_mov_b32_dpp v48, v60 quad_perm:[0,1,2,3] row_mask:0x8 bank_mask:0xf
    buffer_store_dword v48, v8, s[24:27], s45 offen sc1
    s_branch L_fin
M_poller:
    s_cmp_ge_u32 s28, 64
    s_cbranch_scc1 M_nores
    s_mov_b32 s62, 0
M_pbox:
    ds_read_b64 v[8:9], v7 offset:16
    s_waitcnt lgkmcnt(0)
    v_cmp_gt_u32 vcc, 7, v9
    s_add_u32 s62, s62, 1
    s_cbranch_vccz M_pbox_d
    s_cmp_lt_u32 s62, 1000000
    s_cbranch_scc1 M_pbox
M_pbox_d:
    v_readfirstlane_b32 s48, v8
    v_mov_b32 v9, s33
    v_mov_b32 v10, 0
    s_lshr_b32 s34, s28, 5
    s_add_u32 s34, s34, s28
    s_and_b32 s34, s34, 31
    s_lshl_b32 s34, s34, 7
    s_add_u32 s34, s34, 4096
    s_mov_b64 exec, 1
    buffer_store_dwordx2 v[8:9], v10, s[24:27], s34 offen sc1
    s_mov_b64 exec, -1
M_nores:
    v_lshlrev_b32 v9, 4, v2
    v_and_b32 v12, 8, v2
    v_lshl_add_u32 v12, v12, 2, v4
    v_and_b32 v11, 3, v2
    v_lshl_add_u32 v12, v11, 3, v12
    v_and_b32 v11, 4, v2
    v_add_lshl_u32 v12, v12, v11, 1
    s_lshl_b32 s44, s29, 12
    s_add_u32 s44, s44, 262144
    s_lshl2_add_u32 s46, s29, s30
    s_lshl_b32 s46, s46, 7
    s_add_u32 s46, s46, 720896
    s_lshl_b32 s47, s33, 4
    s_lshr_b32 s35, s28, 3
    s_cmp_ge_u32 s35, 14
    s_cselect_b32 s34, 18, 0
    s_add_u32 s35, s35, s34
    s_and_b32 s34, s28, 7
    s_lshl_b32 s34, s34, 8
    s_add_u32 s34, s34, s35
    s_lshl2_add_u32 s55, s34, 753664
    v_lshlrev_b32 v40, 8, v2
    v_mov_b32 v41, s33
    s_and_b32 s34, s28, 0xe8
    s_lshl_b32 s34, s34, 5
    s_bfe_u32 s35, s28, 0x10004
    s_lshl3_add_u32 s34, s35, s34
    s_and_b32 s35, s28, 7
    s_add_u32 s34, s34, s35
    s_lshl2_add_u32 s54, s34, 720896
    v_and_b32 v42, 8, v2
    v_add_lshl_u32 v42, v42, v2, 7
    v_mov_b32 v14, 1172
    s_mov_b32 s62, 0
M_pu:
    ds_read_b32 v15, v14
    s_waitcnt lgkmcnt(0)
    v_cmp_gt_u32 vcc, 7, v15
    s_add_u32 s62, s62, 1
    s_cbranch_vccz M_pu_d
    s_sleep 1
    s_cmp_lt_u32 s62, 1000000
    s_cbranch_scc1 M_pu
M_pu_d:
    v_mov_b32 v14, 1152
    s_mov_b32 s62, 0
M_pv:
    ds_read_b32 v15, v14
    s_waitcnt lgkmcnt(0)
    v_cmp_gt_u32 vcc, 14, v15
    s_add_u32 s62, s62, 1
    s_cbranch_vccz M_pv_d
    s_sleep 1
    s_cmp_lt_u32 s62, 1000000
    s_cbranch_scc1 M_pv
M_pv_d:
    s_mov_b64 exec, 0xffff
    buffer_store_dword v41, v42, s[24:27], s54 offen sc1
    s_mov_b64 exec, -1
    s_mov_b32 s62, 0
M_hint:
    s_load_dwordx16 s[64:79], s[10:11], s46 glc
    s_waitcnt lgkmcnt(0)
    s_add_u32 s64, s64, s65
    s_add_u32 s64, s64, s66
    s_add_u32 s64, s64, s67
    s_add_u32 s64, s64, s68
    s_add_u32 s64, s64, s69
    s_add_u32 s64, s64, s70
    s_add_u32 s64, s64, s71
    s_add_u32 s64, s64, s72
    s_add_u32 s64, s64, s73
    s_add_u32 s64, s64, s74
    s_add_u32 s64, s64, s75
    s_add_u32 s64, s64, s76
    s_add_u32 s64, s64, s77
    s_add_u32 s64, s64, s78
    s_add_u32 s64, s64, s79
    s_cmp_eq_u32 s64, s47
    s_cbranch_scc1 M_hint_d
    s_add_u32 s62, s62, 1
    s_cmp_lt_u32 s62, 200000
    s_cbranch_scc1 M_hint
M_hint_d:
    buffer_load_dwordx4 v[16:19], v9, s[24:27], s44 offen offset:0 sc1
    buffer_load_dwordx4 v[20:23], v9, s[24:27], s44 offen offset:1024 sc1
    buffer_load_dwordx4 v[24:27], v9, s[24:27], s44 offen offset:2048 sc1
    buffer_load_dwordx4 v[28:31], v9, s[24:27], s44 offen offset:3072 sc1
    v_mov_b32 v14, 1152
    s_mov_b32 s62, 0
M_pw:
    ds_read_b32 v15, v14
    s_waitcnt lgkmcnt(0)
    v_cmp_gt_u32 vcc, 20, v15
    s_add_u32 s62, s62, 1
    s_cbranch_vccz M_pw_d
    s_cmp_lt_u32 s62, 1000000
    s_cbranch_scc1 M_pw
M_pw_d:
    s_mov_b64 exec, 0xf
    buffer_store_dword v41, v40, s[24:27], s55 offen sc1
    s_mov_b64 exec, -1
    s_mov_b32 s62, 0
    s_waitcnt vmcnt(1)
    s_branch M_ph_c
    s_mov_b32 s62, 0
M_ph:
    buffer_load_dwordx4 v[16:19], v9, s[24:27], s44 offen offset:0 sc1
    buffer_load_dwordx4 v[20:23], v9, s[24:27], s44 offen offset:1024 sc1
    buffer_load_dwordx4 v[24:27], v9, s[24:27], s44 offen offset:2048 sc1
    buffer_load_dwordx4 v[28:31], v9, s[24:27], s44 offen offset:3072 sc1
    s_waitcnt vmcnt(0)
M_ph_c:
    v_pk_add_f32 v[32:33], v[16:17], v[20:21]
    v_pk_add_f32 v[34:35], v[18:19], v[22:23]
    v_pk_add_f32 v[36:37], v[24:25], v[28:29]
    v_pk_add_f32 v[38:39], v[26:27], v[30:31]
    v_permlane16_swap_b32 v32, v33
    v_permlane16_swap_b32 v34, v35
    v_permlane16_swap_b32 v36, v37
    v_permlane16_swap_b32 v38, v39
    v_add_f32 v32, v32, v33
    v_add_f32 v34, v34, v35
    v_add_f32 v36, v36, v37
    v_add_f32 v38, v38, v39
    v_permlane32_swap_b32 v32, v34
    s_nop 0
    v_permlane32_swap_b32 v36, v38
    v_add_f32 v32, v32, v34
    v_add_f32 v36, v36, v38
    v_cmp_u_f32 vcc, v32, v36
    v_mul_f32 v33, 0xbfb8aa3b, v32
    s_cbranch_vccz M_ph_d
    v_max_u32 v34, v16, v17
    v_max3_u32 v34, v34, v18, v19
    v_max3_u32 v34, v34, v20, v21
    v_max3_u32 v34, v34, v22, v23
    v_max3_u32 v34, v34, v24, v25
    v_max3_u32 v34, v34, v26, v27
    v_max3_u32 v34, v34, v28, v29
    v_max3_u32 v34, v34, v30, v31
    v_cmp_eq_u32 vcc, -1, v34
    s_add_u32 s62, s62, 1
    s_cbranch_vccz M_ph_d
    s_cmp_lt_u32 s62, 200000
    s_cbranch_scc1 M_ph
M_ph_d:
    v_exp_f32 v33, v33
    v_mul_f32 v16, v32, v36
    v_add_f32 v33, 1.0, v33
    v_rcp_f32 v33, v33
    s_nop 0
    v_mul_f32 v16, v16, v33
    v_cvt_pk_bf16_f32 v16, v16, v16
    ds_write_b16 v12, v16 offset:1024
    s_waitcnt lgkmcnt(0)
    s_barrier
L_fin:
L_end:
    s_endpgm
.section .rodata,"a"
.p2align 6
.amdhsa_kernel recurrent_scan__spectral_fnet__moe_arch_mod__prompt_kernel
  .amdhsa_next_free_vgpr 128
  .amdhsa_next_free_sgpr 102
  .amdhsa_accum_offset 128
  .amdhsa_group_segment_fixed_size 0
  .amdhsa_kernarg_size 104
  .amdhsa_user_sgpr_count 2
  .amdhsa_user_sgpr_kernarg_segment_ptr 1
  .amdhsa_system_sgpr_workgroup_id_x 1
.end_amdhsa_kernel
```

```asm
; @launch grid=(480,1,1) block=(512,1,1) lds=67072
.amdgcn_target "amdgcn-amd-amdhsa--gfx950"
.text
.globl recurrent_scan__spectral_fnet__moe_arch_mod__prompt_kernel
.p2align 8
.type recurrent_scan__spectral_fnet__moe_arch_mod__prompt_kernel,@function
recurrent_scan__spectral_fnet__moe_arch_mod__prompt_kernel:
    s_cmp_ge_u32 s2, 480
    s_cbranch_scc1 L_end
    s_load_dwordx2 s[4:5], s[0:1], 0
    s_load_dwordx2 s[10:11], s[0:1], 96
    s_load_dwordx8 s[36:43], s[0:1], 48
    s_load_dwordx2 s[8:9], s[0:1], 80
    v_lshrrev_b32 v1, 6, v0
    v_and_b32 v2, 63, v0
    v_readfirstlane_b32 s3, v1
    v_and_b32 v3, 15, v0
    v_lshrrev_b32 v4, 4, v2
    s_cmp_ge_u32 s2, 256
    s_cbranch_scc1 M_first
    s_cmp_lg_u32 s3, 0
    s_cbranch_scc1 L_nopf
    s_getpc_b64 s[6:7]
L_pc:
    s_mov_b32 m0, 66816
    s_bfe_u32 s34, s2, 0x20003
    s_lshl_b32 s34, s34, 12
    v_lshl_add_u32 v8, v0, 7, s34
    v_min_u32 v8, L_end-L_pc, v8
    s_mov_b32 exec_hi, 0
    global_load_lds_dword v8, s[6:7]
    s_mov_b32 exec_hi, -1
L_nopf:
    s_and_b32 s28, s2, 7
    s_bfe_u32 s44, s2, 0x10003
    s_lshr_b32 s45, s2, 4
    s_xor_b32 s30, s45, 15
    s_lshl3_add_u32 s30, s30, s28
    s_cmp_eq_u32 s30, 0
    s_cselect_b32 s46, 1, 0
    s_cmp_eq_u32 s2, 248
    s_cselect_b32 s30, 128, s30
    s_lshl_b32 s31, s3, 8
    s_add_u32 s31, s31, s30
    s_sub_u32 s32, 0, s31
    s_and_b32 s32, s32, 2047
    s_cmp_eq_u32 s44, 0
    s_cselect_b32 s47, s31, s32
    s_cselect_b32 s48, s32, s31
    s_lshl_b32 s49, s47, 11
    s_lshl_b32 s48, s48, 11
    v_lshrrev_b32 v5, 3, v2
    v_and_b32 v5, 2, v5
    v_xor_b32 v5, v5, v2
    v_lshlrev_b32 v5, 4, v5
    s_lshl_b32 s53, s3, 12
    s_lshl_b32 s14, 1, 22
    s_mov_b32 s15, 0x20000
    s_movk_i32 s18, 2048
    s_mov_b32 s19, s15
    s_mov_b32 m0, 41216
    s_cmp_lg_u32 s3, 0
    s_waitcnt lgkmcnt(0)
    s_mov_b64 s[12:13], s[4:5]
    s_load_dword s33, s[10:11], 0
    s_cbranch_scc1 F_nowr
    s_mov_b64 s[16:17], s[36:37]
    buffer_load_dwordx4 v5, s[16:19], 0 offen lds
    buffer_load_dwordx4 v5, s[16:19], 0 offen offset:1024 lds
F_nowr:
    s_mov_b32 m0, s53
    s_mov_b64 s[24:25], s[10:11]
    buffer_load_dwordx4 v5, s[12:15], s49 offen lds
    buffer_load_dwordx4 v5, s[12:15], s49 offen offset:1024 lds
    s_branch F_go
M_first:
    s_cmp_lg_u32 s3, 0
    s_cbranch_scc1 M_entry
    s_setprio 3
    s_lshr_b32 s29, s2, 1
    s_xor_b32 s29, s29, s2
    s_and_b32 s29, s29, 8
    s_mul_i32 s29, s29, 3
    s_xor_b32 s28, s2, s29
    s_bitset0_b32 s28, 8
    v_mul_u32_u24 v8, 7168, v4
    v_lshlrev_b32 v9, 1, v4
    v_xor_b32 v9, v9, v3
    v_lshl_add_u32 v8, v9, 4, v8
    s_and_b32 s34, s28, 7
    s_mulk_i32 s34, 3584
    s_lshr_b32 s35, s28, 3
    s_add_u32 s34, s34, s35
    s_lshl_b32 s34, s34, 8
    s_mov_b32 s14, 7340032
    s_mov_b32 s15, 0x20000
    s_movk_i32 s46, 1280
    s_mov_b32 s45, s34
    s_waitcnt lgkmcnt(0)
    s_mov_b64 s[12:13], s[38:39]
M_burst:
    s_mov_b32 m0, s46
    s_addk_i32 s46, 1024
    buffer_load_dwordx4 v8, s[12:15], s45 offen nt lds
    s_addk_i32 s45, 28672
    v_xor_b32 v8, 128, v8
    s_cmpk_lt_u32 s46, 13568
    s_cbranch_scc1 M_burst
    s_branch M_loader2
F_go:
    s_mov_b32 s26, 268435456
    s_mov_b32 s27, 0x20000
    v_lshlrev_b32 v7, 2, v0
    s_lshl_b32 s34, s2, 11
    s_add_u32 s34, s34, 262144
    v_mov_b32 v6, -1
    buffer_store_dword v6, v7, s[24:27], s34 offen sc1
    v_lshlrev_b32 v126, 4, v2
    s_and_b32 s34, s3, 1
    s_lshr_b32 s35, s3, 1
    v_lshl_add_u32 v119, s34, 3, v126
    s_cmp_eq_u32 s35, 3
    s_cbranch_scc1 F_jobr8
    s_lshl4_add_u32 s54, s44, 1
    s_cmp_eq_u32 s35, 2
    s_cselect_b32 s54, 0, s54
    s_cselect_b32 s57, 4096, 0
    s_cmp_eq_u32 s35, 1
    s_cselect_b32 s55, 0x3a800000, 0
    s_cselect_b32 s58, s46, 0
    s_cselect_b32 s57, 7168, s57
    s_cselect_b32 s55, s55, 0x3d000000
    s_lshl_b32 s34, s34, 4
    v_lshl_add_u32 v109, v4, 2, s34
    v_cvt_f32_u32 v109, v109
    v_add_u32 v119, s57, v119
F_job:
    v_add_u32 v116, s54, v3
    v_cvt_f32_u32 v116, v116
    v_mul_f32 v116, s55, v116
    v_mul_f32 v117, v116, v109
    v_cos_f32 v76, v117
    v_sin_f32 v80, v117
    v_add_f32 v117, v117, v116
    v_cos_f32 v77, v117
    v_sin_f32 v81, v117
    v_add_f32 v117, v117, v116
    v_cos_f32 v78, v117
    v_sin_f32 v82, v117
    v_add_f32 v117, v117, v116
    v_cos_f32 v79, v117
    v_sin_f32 v83, v117
    s_cmp_eq_u32 s35, 0
    s_cbranch_scc1 F_jobf1
    v_cvt_pk_f16_f32 v84, v76, v77
    v_cvt_pk_f16_f32 v85, v78, v79
    v_cvt_pk_f16_f32 v86, v80, v81
    v_cvt_pk_f16_f32 v87, v82, v83
    v_xor_b32 v88, 0x80008000, v86
    v_xor_b32 v89, 0x80008000, v87
    ds_write2st64_b64 v119, v[84:85], v[86:87] offset0:85 offset1:87
    ds_write_b64 v119, v[88:89] offset:45568
    s_cmp_eq_u32 s58, 0
    s_cbranch_scc1 F_jobd
    s_mov_b32 s58, 0
    s_xor_b32 s54, s54, 16
    v_add_u32 v119, 3072, v119
    s_branch F_job
F_jobf1:
    v_cvt_pk_bf16_f32 v84, v76, v77
    v_cvt_pk_bf16_f32 v85, v78, v79
    v_cvt_pk_bf16_f32 v86, -v80, -v81
    v_cvt_pk_bf16_f32 v87, -v82, -v83
    ds_write2st64_b64 v119, v[84:85], v[86:87] offset0:85 offset1:87
    s_branch F_jobd
F_jobr8:
    v_and_b32 v118, 7, v3
    v_cvt_f32_u32 v118, v118
    v_mul_f32 v118, 0x3e000000, v118
    v_and_b32 v117, 1, v4
    v_lshl_add_u32 v117, v117, 1, s34
    v_cvt_f32_u32 v117, v117
    v_mul_f32 v117, v117, v118
    v_add_f32 v117, v117, v117
    v_add_f32 v118, v117, v118
    v_cos_f32 v76, v117
    v_sin_f32 v77, v117
    v_cos_f32 v78, v118
    v_sin_f32 v79, v118
    v_lshrrev_b32 v116, 2, v2
    v_xor_b32 v116, v116, v2
    v_bfe_u32 v116, v116, 3, 1
    v_add_u32 v116, -1, v116
    s_lshl_b32 s34, s44, 31
    v_cvt_pk_f16_f32 v84, v76, v77
    v_cvt_pk_f16_f32 v86, -v77, v76
    v_cvt_pk_f16_f32 v85, v78, v79
    v_cvt_pk_f16_f32 v87, -v79, v78
    v_bitop3_b32 v84, v84, s34, v116 bitop3:0x28
    v_bitop3_b32 v85, v85, s34, v116 bitop3:0x28
    v_bitop3_b32 v86, v86, s34, v116 bitop3:0x28
    v_bitop3_b32 v87, v87, s34, v116 bitop3:0x28
    ds_write2st64_b64 v119, v[84:85], v[86:87] offset0:89 offset1:91
F_jobd:
    s_and_b32 s51, s47, 7
    v_mov_b32 v108, 0
    s_bfe_u32 s34, s47, 0x40003
    v_mov_b32 v109, 0
    s_lshl4_add_u32 s51, s51, s34
    v_mov_b32 v110, 0
    s_lshr_b32 s34, s47, 7
    v_mov_b32 v111, 0
    s_lshl4_add_u32 s51, s51, s34
    v_mov_b32 v7, 56832
    s_lshl3_add_u32 s51, s51, 24576
    ds_write_b128 v7, v[108:111]
    s_lshl_b32 s52, s46, 23
    v_and_b32 v96, 60, v2
    s_sub_u32 s52, 0x3e000000, s52
    v_and_b32 v97, 3, v2
    s_mov_b32 s60, 0x80000000
    v_lshl_add_u32 v96, v96, 1, v97
    s_mov_b32 s61, 0xfffff800
    v_bfe_u32 v97, v2, 4, 1
    s_mov_b32 s71, 0
    v_lshl_add_u32 v96, v97, 2, v96
    v_lshlrev_b32 v96, 3, v96
    v_xor_b32 v97, 32, v96
    v_add_u32 v92, s53, v96
    v_xor_b32 v93, 32, v92
    v_mov_b32 v68, 0x3f803f80
    v_mov_b32 v69, 0x3f803f80
    v_mov_b32 v70, 0x3f803f80
    v_mov_b32 v71, 0x3f803f80
    v_mov_b32 v125, s47
    v_mov_b32 v118, 1
    v_mov_b32 v119, 0
    s_add_u32 m0, s53, 2048
    s_nop 0
    buffer_load_dwordx4 v5, s[12:15], s48 offen lds
    buffer_load_dwordx4 v5, s[12:15], s48 offen offset:1024 lds
    s_waitcnt vmcnt(5) lgkmcnt(0)
    s_barrier
    ds_read_b64_tr_b16 v[24:25], v96 offset:41216
    ds_read_b64_tr_b16 v[26:27], v96 offset:42240
    ds_read_b64_tr_b16 v[28:29], v97 offset:41216
    ds_read_b64_tr_b16 v[30:31], v97 offset:42240
    ds_read_b128 v[32:35], v126 offset:43520
    ds_read_b128 v[36:39], v126 offset:44544
    ds_read_b128 v[40:43], v126 offset:45568
    ds_read_b128 v[44:47], v126 offset:46592
    ds_read_b128 v[48:51], v126 offset:47616
    ds_read_b128 v[52:55], v126 offset:48640
    ds_read_b128 v[56:59], v126 offset:49664
    ds_read_b128 v[60:63], v126 offset:50688
    ds_read_b128 v[64:67], v126 offset:51712
    s_mul_i32 s33, s33, 0x9e3779b1
    s_add_u32 s33, s33, 0x7f4a7c15
    s_mov_b32 s63, 0x3a800000
    v_mov_b32 v117, s33
    s_waitcnt lgkmcnt(9)
    v_mfma_f32_16x16x32_bf16 v[100:103], v[68:71], v[24:27], 0
    v_mfma_f32_16x16x32_bf16 v[100:103], v[68:71], v[28:31], v[100:103]
    s_nop 7
    v_add_f32_dpp v100, v100, v100 row_ror:8 row_mask:0xf bank_mask:0xf
    s_nop 1
    v_add_f32_dpp v100, v100, v100 row_ror:4 row_mask:0xf bank_mask:0xf
    s_nop 1
    v_add_f32_dpp v100, v100, v100 row_ror:2 row_mask:0xf bank_mask:0xf
    s_nop 1
    v_add_f32_dpp v100, v100, v100 row_ror:1 row_mask:0xf bank_mask:0xf
    s_waitcnt vmcnt(3) lgkmcnt(0)
    ds_read_b64_tr_b16 v[8:9], v92 offset:0
    ds_read_b64_tr_b16 v[10:11], v92 offset:1024
    ds_read_b64_tr_b16 v[12:13], v93 offset:0
    ds_read_b64_tr_b16 v[14:15], v93 offset:1024
    s_waitcnt lgkmcnt(2)
    v_mfma_f32_16x16x32_bf16 v[104:107], v[68:71], v[8:11], 0
    v_dot2_f32_bf16 v110, v8, v24, v110
    v_dot2_f32_bf16 v108, v8, v8, v108
    v_dot2_f32_bf16 v110, v9, v25, v110
    v_dot2_f32_bf16 v108, v9, v9, v108
    v_dot2_f32_bf16 v110, v10, v26, v110
    v_dot2_f32_bf16 v108, v10, v10, v108
    v_dot2_f32_bf16 v110, v11, v27, v110
    v_dot2_f32_bf16 v108, v11, v11, v108
    s_waitcnt lgkmcnt(0)
    v_mfma_f32_16x16x32_bf16 v[104:107], v[68:71], v[12:15], v[104:107]
    v_dot2_f32_bf16 v110, v12, v28, v110
    v_dot2_f32_bf16 v108, v12, v12, v108
    v_dot2_f32_bf16 v110, v13, v29, v110
    v_dot2_f32_bf16 v108, v13, v13, v108
    v_dot2_f32_bf16 v110, v14, v30, v110
    v_dot2_f32_bf16 v108, v14, v14, v108
    v_dot2_f32_bf16 v110, v15, v31, v110
    v_dot2_f32_bf16 v108, v15, v15, v108
    v_add_f32_dpp v104, v104, v104 row_ror:8 row_mask:0xf bank_mask:0xf
    s_nop 1
    v_permlane32_swap_b32 v108, v110
    v_add_f32_dpp v104, v104, v104 row_ror:4 row_mask:0xf bank_mask:0xf
    v_add_f32 v108, v108, v110
    s_nop 0
    v_add_f32_dpp v104, v104, v104 row_ror:2 row_mask:0xf bank_mask:0xf
    v_add_f32_dpp v108, v108, v108 row_ror:8 row_mask:0xf bank_mask:0xf
    s_nop 0
    v_add_f32_dpp v104, v104, v104 row_ror:1 row_mask:0xf bank_mask:0xf
    v_add_f32_dpp v108, v108, v108 row_ror:4 row_mask:0xf bank_mask:0xf
    v_mul_f32 v112, 0x3a800000, v104
    s_nop 0
    v_add_f32_dpp v108, v108, v108 row_ror:2 row_mask:0xf bank_mask:0xf
    v_mul_f32 v113, -v112, v112
    s_nop 0
    v_add_f32_dpp v108, v108, v108 row_ror:1 row_mask:0xf bank_mask:0xf
    v_mul_f32 v110, v112, v100
    s_nop 0
    v_add_f32_dpp v108, v108, v108 row_bcast:15 row_mask:0xa bank_mask:0xf
    s_nop 0
    v_readlane_b32 s34, v108, 48
    v_fmamk_f32 v108, v108, 0x3a800000, v113
    v_max_f32 v108, 0, v108
    v_add_f32 v111, 0x3727c5ac, v108
    v_rsq_f32 v111, v111
    v_sub_f32 v110, s34, v110
    v_mul_f32 v110, v110, v111
    v_ashrrev_i32 v115, 31, v110
    v_bitop3_b32 v115, v110, v115, s60 bitop3:0x1e
    v_and_or_b32 v115, v115, s61, v125
    s_mov_b64 exec, 0x10000
    s_waitcnt vmcnt(2)
    ds_max_u32 v7, v115
    ds_add_rtn_u32 v118, v7, v118 offset:8
    v_cvt_pk_bf16_f32 v116, v112, v108
    buffer_store_dwordx2 v[116:117], v119, s[24:27], s51 offen sc1
    s_mov_b64 exec, -1
    ds_read_b32 v114, v7
    v_mul_f32 v111, s52, v111
    v_mul_f32 v113, v112, v111
    v_readlane_b32 s54, v111, 16
    v_readlane_b32 s70, v113, 16
    v_mfma_f32_16x16x32_bf16 v[76:79], v[8:11], v[32:35], 0
    v_mfma_f32_16x16x32_bf16 v[80:83], v[12:15], v[32:35], 0
    v_mfma_f32_16x16x32_bf16 v[84:87], v[8:11], v[36:39], 0
    v_mfma_f32_16x16x32_bf16 v[88:91], v[12:15], v[36:39], 0
    s_waitcnt lgkmcnt(0)
    v_readlane_b32 s34, v118, 16
    s_nop 0
    s_cmp_lg_u32 s34, 7
    s_cbranch_scc0 F_key
F_nokey:
    s_lshr_b32 s58, s3, 2
    v_xor_b32 v94, 0x3d8, v92
    s_lshl4_add_u32 s58, s3, s58
    v_xor_b32 v95, 0x3f8, v92
    s_lshl_b32 s58, s58, 6
    v_and_b32 v72, 0x3d8, v96
    s_and_b32 s59, s3, 3
    v_sub_u32 v72, 1024, v72
    s_lshl3_add_u32 s59, s3, s59
    v_add_u32 v73, -32, v72
    s_lshl_b32 s59, s59, 2
    v_lshrrev_b32 v74, 3, v72
    s_and_b32 s34, s30, 15
    v_lshrrev_b32 v75, 3, v73
    s_sub_u32 s35, 16, s34
    v_bitop3_b32 v72, v72, v74, 32 bitop3:0x78
    s_and_b32 s50, s34, 7
    v_bitop3_b32 v73, v73, v75, 32 bitop3:0x78
    s_cmp_gt_u32 s34, 8
    v_add_u32 v72, s53, v72
    s_cselect_b32 s50, s35, s50
    v_add_u32 v73, s53, v73
    s_and_b32 s34, s34, 8
    v_xor_b32 v74, 1024, v72
    s_lshl4_add_u32 s50, s50, s34
    v_bfe_u32 v120, v3, 1, 2
    s_lshr_b32 s34, s30, 4
    v_xor_b32 v120, v120, v4
    s_add_u32 s50, s50, s34
    v_lshl_add_u32 v120, v3, 2, v120
    s_cmp_eq_u32 s30, 128
    v_lshl_add_u32 v120, v120, 4, s58
    s_cselect_b32 s50, 128, s50
    v_xor_b32 v121, s59, v3
    s_lshl1_add_u32 s29, s50, s44
    v_lshrrev_b32 v16, 1, v4
    s_mul_i32 s50, s29, 8320
    v_lshl_add_u32 v121, v16, 4, v121
    s_lshl_b32 s34, s3, 10
    v_and_b32 v16, 1, v4
    s_add_u32 s50, s50, s34
    v_mul_u32_u24 v16, 1040, v16
    s_add_u32 s50, s50, 1048576
    v_add_lshl_u32 v121, v121, v16, 2
    s_and_b32 s29, s29, 255
    v_and_b32 v17, 7, v3
    s_lshl2_add_u32 s29, s29, 40960
    v_lshrrev_b32 v16, 3, v3
    s_cmp_eq_u32 s44, 0
    v_mul_u32_u24 v122, 128, v17
    s_cselect_b32 s35, 0, 0xc2000000
    v_lshl_add_u32 v122, v16, 6, v122
    v_lshl_add_u32 v122, v4, 4, v122
    v_add_u32 v124, 1, v3
    v_bfe_i32 v124, v124, 4, 1
    v_and_b32 v124, s35, v124
    s_cmp_lg_u32 s71, 0
    s_cbranch_scc1 F_wkey
    s_waitcnt vmcnt(1)
F_wkey_r:
    ds_read_b64_tr_b16 v[24:25], v94 offset:3072
    ds_read_b64_tr_b16 v[26:27], v94 offset:2048
    ds_read_b64_tr_b16 v[28:29], v95 offset:3072
    ds_read_b64_tr_b16 v[30:31], v95 offset:2048
    ds_read_b64_tr_b16 v[16:17], v74 offset:2048
    ds_read_b64_tr_b16 v[18:19], v72 offset:2048
    ds_read_b64_tr_b16 v[20:21], v73 offset:3072
    ds_read_b64_tr_b16 v[22:23], v73 offset:2048
    s_waitcnt lgkmcnt(6)
    v_mfma_f32_16x16x32_bf16 v[104:107], v[68:71], v[24:27], 0
    v_dot2_f32_bf16 v109, v24, v24, v109
    v_dot2_f32_bf16 v109, v25, v25, v109
    v_dot2_f32_bf16 v109, v26, v26, v109
    v_dot2_f32_bf16 v109, v27, v27, v109
    s_waitcnt lgkmcnt(4)
    v_mfma_f32_16x16x32_bf16 v[104:107], v[68:71], v[28:31], v[104:107]
    v_dot2_f32_bf16 v109, v28, v28, v109
    v_dot2_f32_bf16 v109, v29, v29, v109
    v_dot2_f32_bf16 v109, v30, v30, v109
    v_dot2_f32_bf16 v109, v31, v31, v109
    s_mov_b32 exec_lo, 0xeeeeeeee
    s_mov_b32 exec_hi, 0xeeeeeeee
    s_waitcnt lgkmcnt(0)
    v_mov_b32_dpp v16, v24 quad_perm:[0,3,2,1] row_mask:0xf bank_mask:0xf
    v_mov_b32_dpp v17, v25 quad_perm:[0,3,2,1] row_mask:0xf bank_mask:0xf
    v_mov_b32_dpp v18, v26 quad_perm:[0,3,2,1] row_mask:0xf bank_mask:0xf
    v_mov_b32_dpp v19, v27 quad_perm:[0,3,2,1] row_mask:0xf bank_mask:0xf
    v_mov_b32_dpp v20, v28 quad_perm:[0,3,2,1] row_mask:0xf bank_mask:0xf
    v_mov_b32_dpp v21, v29 quad_perm:[0,3,2,1] row_mask:0xf bank_mask:0xf
    v_mov_b32_dpp v22, v30 quad_perm:[0,3,2,1] row_mask:0xf bank_mask:0xf
    v_mov_b32_dpp v23, v31 quad_perm:[0,3,2,1] row_mask:0xf bank_mask:0xf
    s_mov_b64 exec, -1
    v_add_f32_dpp v112, v104, v104 row_ror:8 row_mask:0xf bank_mask:0xf
    v_add_f32_dpp v109, v109, v109 row_ror:8 row_mask:0xf bank_mask:0xf
    v_mfma_f32_16x16x32_bf16 v[92:95], v[16:19], v[32:35], 0
    v_add_f32_dpp v112, v112, v112 row_ror:4 row_mask:0xf bank_mask:0xf
    v_add_f32_dpp v109, v109, v109 row_ror:4 row_mask:0xf bank_mask:0xf
    v_mfma_f32_16x16x32_bf16 v[96:99], v[20:23], v[32:35], 0
    v_add_f32_dpp v112, v112, v112 row_ror:2 row_mask:0xf bank_mask:0xf
    v_add_f32_dpp v109, v109, v109 row_ror:2 row_mask:0xf bank_mask:0xf
    v_mfma_f32_16x16x32_bf16 v[100:103], v[16:19], v[36:39], 0
    v_add_f32_dpp v112, v112, v112 row_ror:1 row_mask:0xf bank_mask:0xf
    v_add_f32_dpp v109, v109, v109 row_ror:1 row_mask:0xf bank_mask:0xf
    v_mfma_f32_16x16x32_bf16 v[104:107], v[20:23], v[36:39], 0
    v_mul_f32 v112, 0x3a800000, v112
    v_add_f32_dpp v109, v109, v109 row_bcast:15 row_mask:0xa bank_mask:0xf
    v_fmaak_f32 v113, v112, v112, 0xb727c5ac
    v_mul_f32 v116, s70, v124
    v_add_f32_dpp v109, v109, v109 row_bcast:31 row_mask:0xc bank_mask:0xf
    v_fma_f32 v109, v109, s63, -v113
    v_max_f32 v109, 0x3727c5ac, v109
    v_rsq_f32 v109, v109
    v_pk_mul_f32 v[84:85], v[84:85], s[54:55] op_sel:[0,0] op_sel_hi:[1,0]
    v_mul_f32 v109, s52, v109
    v_pk_mul_f32 v[86:87], v[86:87], s[54:55] op_sel:[0,0] op_sel_hi:[1,0]
    v_readlane_b32 s55, v109, 48
    s_nop 1
    v_pk_mul_f32 v[88:89], v[88:89], s[54:55] op_sel:[0,0] op_sel_hi:[1,0]
    v_pk_mul_f32 v[90:91], v[90:91], s[54:55] op_sel:[0,0] op_sel_hi:[1,0]
    v_mul_f32 v112, s55, v112
    v_fmac_f32 v116, v112, v124
F_pass:
    v_pk_fma_f32 v[76:77], v[76:77], s[54:55], v[116:117] op_sel:[0,0,0] op_sel_hi:[1,0,0]
    v_pk_fma_f32 v[78:79], v[78:79], s[54:55], v[116:117] op_sel:[0,0,0] op_sel_hi:[1,0,0]
    v_pk_fma_f32 v[80:81], v[80:81], s[54:55], v[116:117] op_sel:[0,0,0] op_sel_hi:[1,0,0]
    v_pk_fma_f32 v[82:83], v[82:83], s[54:55], v[116:117] op_sel:[0,0,0] op_sel_hi:[1,0,0]
    v_pk_fma_f32 v[76:77], v[92:93], s[54:55], v[76:77] op_sel:[0,1,0] op_sel_hi:[1,1,1]
    v_pk_fma_f32 v[78:79], v[94:95], s[54:55], v[78:79] op_sel:[0,1,0] op_sel_hi:[1,1,1]
    v_pk_fma_f32 v[80:81], v[96:97], s[54:55], v[80:81] op_sel:[0,1,0] op_sel_hi:[1,1,1]
    v_pk_fma_f32 v[82:83], v[98:99], s[54:55], v[82:83] op_sel:[0,1,0] op_sel_hi:[1,1,1]
    v_pk_fma_f32 v[84:85], v[100:101], s[54:55], v[84:85] op_sel:[0,1,0] op_sel_hi:[1,1,1]
    v_pk_fma_f32 v[86:87], v[102:103], s[54:55], v[86:87] op_sel:[0,1,0] op_sel_hi:[1,1,1]
    v_pk_fma_f32 v[88:89], v[104:105], s[54:55], v[88:89] op_sel:[0,1,0] op_sel_hi:[1,1,1]
    v_pk_fma_f32 v[90:91], v[106:107], s[54:55], v[90:91] op_sel:[0,1,0] op_sel_hi:[1,1,1]
    v_cvt_pk_f16_f32 v24, v76, v77
    v_cvt_pk_f16_f32 v25, v78, v79
    v_cvt_pk_f16_f32 v26, v80, v81
    v_cvt_pk_f16_f32 v27, v82, v83
    v_cvt_pk_f16_f32 v28, v84, v85
    v_cvt_pk_f16_f32 v29, v86, v87
    v_cvt_pk_f16_f32 v30, v88, v89
    v_cvt_pk_f16_f32 v31, v90, v91
    v_pk_mul_f16 v68, v24, v60
    v_pk_mul_f16 v69, v25, v61
    v_pk_mul_f16 v70, v26, v62
    v_pk_mul_f16 v71, v27, v63
    v_pk_fma_f16 v68, v28, v64, v68
    v_pk_fma_f16 v69, v29, v65, v69
    v_pk_fma_f16 v70, v30, v66, v70
    v_pk_fma_f16 v71, v31, v67, v71
    v_pk_mul_f16 v72, v28, v60
    v_pk_mul_f16 v73, v29, v61
    v_pk_mul_f16 v74, v30, v62
    v_pk_mul_f16 v75, v31, v63
    v_mfma_f32_16x16x32_f16 v[92:95], v[68:71], v[48:51], 0
    v_mfma_f32_16x16x32_f16 v[96:99], v[68:71], v[56:59], 0
    v_pk_fma_f16 v72, v24, v64, v72 neg_lo:[1,0,0] neg_hi:[1,0,0]
    v_pk_fma_f16 v73, v25, v65, v73 neg_lo:[1,0,0] neg_hi:[1,0,0]
    v_pk_fma_f16 v74, v26, v66, v74 neg_lo:[1,0,0] neg_hi:[1,0,0]
    v_pk_fma_f16 v75, v27, v67, v75 neg_lo:[1,0,0] neg_hi:[1,0,0]
    s_nop 1
    v_mfma_f32_16x16x32_f16 v[92:95], v[72:75], v[52:55], v[92:95]
    v_mfma_f32_16x16x32_f16 v[96:99], v[72:75], v[48:51], v[96:99]
    s_nop 7
    v_cvt_pk_f16_f32 v24, v92, v96
    v_cvt_pk_f16_f32 v25, v93, v97
    v_cvt_pk_f16_f32 v26, v94, v98
    v_cvt_pk_f16_f32 v27, v95, v99
    ds_write_b128 v120, v[24:27] offset:32768
    s_waitcnt lgkmcnt(0)
    s_barrier
    ds_read2st64_b32 v[28:29], v121 offset0:128 offset1:132
    ds_read2st64_b32 v[30:31], v121 offset0:136 offset1:140
    s_waitcnt lgkmcnt(0)
    v_mfma_f32_16x16x32_f16 v[100:103], v[28:31], v[40:43], 0
    v_mfma_f32_16x16x32_f16 v[104:107], v[28:31], v[44:47], 0
    s_nop 7
    v_cvt_pk_f16_f32 v68, v100, v104
    v_cvt_pk_f16_f32 v69, v101, v105
    v_cvt_pk_f16_f32 v70, v102, v106
    v_cvt_pk_f16_f32 v71, v103, v107
    buffer_store_dwordx4 v[68:71], v122, s[24:27], s50 offen sc1
    s_cmp_lg_u32 s46, 0
    s_cbranch_scc1 F_second
    s_mov_b32 s34, 0x71605432
    v_bfe_u32 v6, v2, 2, 2
    s_mov_b32 s35, 0x98fedcba
    v_lshl_add_u32 v6, v6, 2, v4
    s_lshl_b32 s56, s45, 2
    v_and_b32 v1, 3, v2
    s_lshr_b64 s[34:35], s[34:35], s56
    v_lshlrev_b32 v1, 4, v1
    s_and_b32 s34, s34, 15
    v_lshl_add_u32 v6, v6, 18, v1
    s_xor_b32 s45, s45, 8
    v_lshrrev_b32 v108, 3, v3
    s_cmp_eq_u32 s44, 0
    v_and_b32 v109, 7, v3
    s_cselect_b32 s45, s45, s34
    v_lshlrev_b32 v123, 14, v108
    s_sub_u32 s34, 0, s28
    v_lshl_add_u32 v123, v4, 20, v123
    s_and_b32 s34, s34, 7
    v_lshl_add_u32 v123, v109, 3, v123
    s_lshr_b32 s35, s45, 1
    s_cmp_lt_u32 s35, s44
    s_cselect_b32 s28, s34, s28
    s_sub_u32 s34, 0, s28
    s_and_b32 s34, s34, 7
    s_sub_u32 s35, 31, s45
    s_cmp_eq_u32 s44, 0
    s_cselect_b32 s56, s28, s34
    s_cselect_b32 s57, s45, s35
    s_lshl4_add_u32 s64, s3, s56
    s_lshl_b32 s64, s64, 11
    s_lshl_b32 s34, s57, 6
    s_add_u32 s64, s64, s34
    s_add_u32 s65, s64, 262144
    s_add_u32 s66, s64, 524288
    s_add_u32 s67, s64, 786432
    s_mov_b64 s[20:21], s[8:9]
    s_mov_b32 s22, 4194304
    s_mov_b32 s23, 0x20000
    s_mov_b32 s16, 0
    s_lshr_b32 s34, s3, 1
    s_lshl2_add_u32 s34, s46, s34
    s_cmp_lg_u32 s34, 0
    s_cbranch_scc1 F_xp0
    s_mov_b32 m0, s53
    s_add_u32 s35, s64, 16384
    buffer_load_dwordx4 v6, s[12:15], s64 offen  lds
    s_add_u32 m0, s53, 1152
    s_add_u32 s35, s64, 16384
    buffer_load_dwordx4 v6, s[12:15], s35 offen  lds
F_xp0:
    v_and_b32 v110, 31, v2
    v_lshrrev_b32 v111, 5, v2
    s_lshl_b32 s61, s44, 31
    s_xor_b32 s60, s61, 0x3a000000
    v_lshrrev_b32 v112, 1, v110
    v_lshl_add_u32 v112, v112, 3, s56
    v_cvt_f32_u32 v112, v112
    v_mul_f32 v112, s60, v112
    v_and_b32 v113, 1, v110
    v_cvt_f32_u32 v114, v113
    s_sub_u32 s58, 16, s3
    s_cmp_eq_u32 s3, 0
    s_cselect_b32 s34, 0, 0x3e800000
    s_cselect_b32 s35, 0, -1
    s_cselect_b32 s58, 8, s58
    v_mul_f32 v114, s34, v114
    v_mul_f32 v117, 0x42000000, v112
    v_lshl_add_u32 v116, v111, 4, s3
    v_cvt_f32_u32 v116, v116
    v_fma_f32 v116, v116, v112, v114
    v_cos_f32 v108, v116
    v_sin_f32 v109, v116
    v_add_f32 v116, v116, v117
    v_cvt_pk_f16_f32 v32, v108, v109
    v_cos_f32 v108, v116
    v_sin_f32 v109, v116
    v_add_f32 v116, v116, v117
    v_cvt_pk_f16_f32 v33, v108, v109
    v_cos_f32 v108, v116
    v_sin_f32 v109, v116
    v_add_f32 v116, v116, v117
    v_cvt_pk_f16_f32 v34, v108, v109
    v_cos_f32 v108, v116
    v_sin_f32 v109, v116
    v_add_f32 v116, v116, v117
    v_cvt_pk_f16_f32 v35, v108, v109
    v_mov_b32 v48, s33
    v_lshlrev_b32 v49, 10, v2
    s_lshl2_add_u32 s34, s46, s3
    s_cmp_ge_u32 s34, 4
    s_cbranch_scc1 F_x5a
    s_lshr_b32 s34, s3, 1
    s_lshl2_add_u32 s34, s46, s34
    s_cmp_lg_u32 s34, 1
    s_cbranch_scc1 F_xp1
    s_mov_b32 m0, s53
    s_add_u32 s35, s64, 16384
    buffer_load_dwordx4 v6, s[12:15], s64 offen  lds
    s_add_u32 m0, s53, 1152
    s_add_u32 s35, s64, 16384
    buffer_load_dwordx4 v6, s[12:15], s35 offen  lds
F_xp1:
    s_waitcnt vmcnt(2)
    s_branch F_x5b
F_x5a:
    s_waitcnt vmcnt(0)
F_x5b:
    s_cmp_lg_u32 s3, 7
    s_barrier
    s_cbranch_scc1 F_noflag
    s_mov_b32 exec_lo, 0xffffffff
    s_mov_b32 exec_hi, 0
    buffer_store_dword v48, v49, s[24:27], s29 offen sc1
    s_mov_b64 exec, -1
F_noflag:
    s_lshr_b32 s34, s3, s46
    s_cmp_lt_u32 s34, 4
    s_cbranch_scc1 F_x5c
    s_lshr_b32 s34, s3, 1
    s_lshl2_add_u32 s34, s46, s34
    s_cmp_lg_u32 s34, 2
    s_cbranch_scc1 F_xp2
    s_mov_b32 m0, s53
    s_add_u32 s35, s64, 16384
    buffer_load_dwordx4 v6, s[12:15], s64 offen  lds
    s_add_u32 m0, s53, 1152
    s_add_u32 s35, s64, 16384
    buffer_load_dwordx4 v6, s[12:15], s35 offen  lds
F_xp2:
F_x5c:
    v_lshrrev_b32 v118, 3, v3
    v_lshlrev_b32 v124, 7, v118
    v_lshl_add_u32 v124, v4, 5, v124
    s_lshl3_add_u32 s59, s56, s3
    s_lshl_b32 s59, s59, 8
    s_add_u32 s59, s59, 24576
    s_mov_b32 s62, 0
F_stats:
    buffer_load_dwordx4 v[24:27], v124, s[24:27], s59 offen sc1
    buffer_load_dwordx4 v[28:31], v124, s[24:27], s59 offen offset:16 sc1
    s_cmp_lg_u32 s62, 0
    s_cbranch_scc1 F_stats_w
F_stats_i:
    v_lshl_add_u32 v116, v111, 4, s58
    v_cvt_f32_u32 v116, v116
    v_fma_f32 v116, v116, v112, -v114
    v_cos_f32 v108, v116
    v_sin_f32 v109, v116
    v_add_f32 v116, v116, v117
    v_cvt_pk_f16_f32 v36, v108, v109
    v_cos_f32 v108, v116
    v_sin_f32 v109, v116
    v_add_f32 v116, v116, v117
    v_cvt_pk_f16_f32 v37, v108, v109
    v_cos_f32 v108, v116
    v_sin_f32 v109, v116
    v_add_f32 v116, v116, v117
    v_cvt_pk_f16_f32 v38, v108, v109
    v_cos_f32 v108, v116
    v_sin_f32 v109, v116
    v_add_f32 v116, v116, v117
    v_cvt_pk_f16_f32 v39, v108, v109
    s_cmp_lg_u32 s3, 0
    s_cbranch_scc1 F_now0
    v_mul_f32 v116, 0x43000000, v112
    v_cos_f32 v108, v116
    v_sin_f32 v109, v116
    v_add_u32 v115, -1, v113
    v_and_b32 v32, v32, v115
    v_bfi_b32 v36, v115, 0, v36
    v_and_b32 v33, v33, v115
    v_bfi_b32 v37, v115, 0, v37
    v_and_b32 v34, v34, v115
    v_bfi_b32 v38, v115, 0, v38
    v_and_b32 v35, v35, v115
    v_bfi_b32 v39, v115, 0, v39
    v_or_b32 v115, v113, v111
    v_add_u32 v115, -1, v115
    v_cvt_pk_f16_f32 v40, v108, v109
    v_and_b32 v40, v40, v115
    v_mov_b32 v41, 0
    v_mov_b32 v57, 0
    v_mov_b32 v42, 0
    v_mov_b32 v58, 0
    v_mov_b32 v43, 0
    v_mov_b32 v59, 0
F_now0:
    s_lshr_b32 s34, s3, 1
    s_lshl2_add_u32 s34, s46, s34
    s_cmp_lg_u32 s34, 3
    s_cbranch_scc1 F_xp3
    s_mov_b32 m0, s53
    s_add_u32 s35, s64, 16384
    buffer_load_dwordx4 v6, s[12:15], s64 offen  lds
    s_add_u32 m0, s53, 1152
    s_add_u32 s35, s64, 16384
    buffer_load_dwordx4 v6, s[12:15], s35 offen  lds
F_xp3:
    s_xor_b32 s60, s61, 0x3d800000
    v_cvt_f32_u32 v117, v3
    v_mul_f32 v117, s60, v117
    v_lshlrev_b32 v116, 1, v4
    v_cvt_f32_u32 v116, v116
    v_mul_f32 v116, v116, v117
    v_add_f32 v117, v116, v117
    v_cos_f32 v108, v116
    v_sin_f32 v109, v116
    v_cos_f32 v114, v117
    v_sin_f32 v115, v117
    v_cvt_pk_f16_f32 v44, v108, v109
    s_mov_b32 s34, 0x3c003c00
    v_cvt_pk_f16_f32 v45, v114, v115
    s_mov_b64 exec, 0xffff
    v_lshl_or_b32 v44, v3, 31, s34
    s_mov_b64 exec, -1
    v_lshl_add_u32 v122, s3, 1, v118
    v_mul_u32_u24 v122, 1280, v122
    v_mul_u32_u24 v108, 272, v4
    v_and_b32 v109, 7, v3
    v_lshlrev_b32 v109, 5, v109
    v_add3_u32 v122, v122, v108, v109
    s_lshr_b32 s34, s3, 1
    s_mul_i32 s34, s34, 272
    s_and_b32 s35, s3, 1
    s_lshl2_add_u32 s34, s35, s34
    v_mul_u32_u24 v121, 2560, v111
    v_lshl_add_u32 v121, v110, 3, v121
    v_add_u32 v121, s34, v121
    s_cmp_eq_u32 s44, 0
    s_cselect_b32 s34, 0, 31
    s_cselect_b32 s35, -1, 0
    s_lshl_b32 s60, s45, 5
    s_add_u32 s35, s35, s60
    v_xor_b32 v108, s34, v110
    v_add_u32 v108, s35, v108
    v_max_i32 v108, 0, v108
    v_bfe_u32 v125, v108, 4, 1
    v_mul_u32_u24 v125, 8320, v125
    v_lshrrev_b32 v109, 6, v108
    v_lshl_add_u32 v125, v109, 10, v125
    v_bfe_u32 v109, v108, 5, 1
    v_lshl_add_u32 v125, v109, 6, v125
    v_and_b32 v108, 15, v108
    v_lshl_add_u32 v125, v108, 2, v125
    v_mul_u32_u24 v120, 16640, v111
    v_add_u32 v120, v120, v125
    s_lshl_b32 s58, s28, 7
    s_add_u32 s58, s58, 1048576
    s_add_u32 s60, s58, 2129920
    s_mul_i32 s34, s3, 266240
    s_add_u32 s58, s58, s34
    s_lshl4_add_u32 s47, s3, s56
    s_lshl_b32 s48, s57, 7
    s_add_u32 s49, s48, 491520
    s_lshl1_add_u32 s48, s48, 753664
    s_add_u32 s52, s48, 128
    s_and_b32 s34, s2, 31
    s_lshl3_add_u32 s34, s34, s3
    s_lshl_b32 s34, s34, 7
    s_add_u32 s34, s34, 40960
    s_add_u32 s42, s10, s34
    s_addc_u32 s43, s11, 0
    s_mov_b32 s40, s33
    s_mov_b32 s41, s33
    s_and_b32 s63, s2, 31
    s_lshl_b32 s63, s63, 7
    s_add_u32 s63, s63, 4096
    v_mul_u32_u24 v108, 1152, v118
    v_lshl_add_u32 v108, v4, 6, v108
    v_and_b32 v109, 7, v3
    v_lshlrev_b32 v109, 3, v109
    v_add3_u32 v108, v108, v109, s53
    s_waitcnt vmcnt(0)
F_xt:
    ds_read_b64 v[8:9], v108 offset:0
    ds_read_b64 v[10:11], v108 offset:256
    ds_read_b64 v[12:13], v108 offset:512
    ds_read_b64 v[14:15], v108 offset:768
    s_waitcnt lgkmcnt(3)
    v_lshlrev_b32 v60, 16, v8
    v_and_b32 v64, 0xffff0000, v8
    v_lshlrev_b32 v68, 16, v9
    v_and_b32 v72, 0xffff0000, v9
    s_waitcnt lgkmcnt(2)
    v_lshlrev_b32 v61, 16, v10
    v_and_b32 v65, 0xffff0000, v10
    v_lshlrev_b32 v69, 16, v11
    v_and_b32 v73, 0xffff0000, v11
    s_waitcnt lgkmcnt(1)
    v_lshlrev_b32 v62, 16, v12
    v_and_b32 v66, 0xffff0000, v12
    v_lshlrev_b32 v70, 16, v13
    v_and_b32 v74, 0xffff0000, v13
    s_waitcnt lgkmcnt(0)
    v_lshlrev_b32 v63, 16, v14
    v_and_b32 v67, 0xffff0000, v14
    v_lshlrev_b32 v71, 16, v15
    v_and_b32 v75, 0xffff0000, v15
F_stats_w:
    s_waitcnt vmcnt(0)
F_stats_c:
    v_xor_b32 v108, s33, v25
    v_xor_b32 v109, s33, v27
    v_xor_b32 v110, s33, v29
    v_xor_b32 v111, s33, v31
    v_or3_b32 v108, v108, v109, v110
    v_or_b32 v108, v108, v111
    v_cmp_ne_u32 vcc, 0, v108
    s_add_u32 s62, s62, 1
    s_cbranch_vccz F_stats_d
    s_sleep 4
    s_cmp_lt_u32 s62, 200000
    s_cbranch_scc1 F_stats
F_stats_d:
    s_cmp_lt_u32 s2, 224
    s_cbranch_scc1 F_npf2
    s_cmp_gt_u32 s3, 1
    s_cbranch_scc1 F_npf2
    s_getpc_b64 s[6:7]
L_pc2:
    s_mov_b32 m0, 66816
    v_lshlrev_b32 v110, 7, v0
    v_min_u32 v110, L_end-L_pc2, v110
    v_mov_b32 v111, s7
    v_add_co_u32 v110, vcc, s6, v110
    s_nop 1
    v_addc_co_u32 v111, vcc, 0, v111, vcc
    global_load_lds_dword v[110:111], off sc1
F_npf2:
    s_cmp_eq_u32 s46, 2
    s_cbranch_scc1 F_npre
    s_load_dwordx16 s[68:83], s[42:43], 0 glc
    s_load_dwordx16 s[84:99], s[42:43], 64 glc
F_npre:
    s_mov_b32 s34, 0xbe38aa3b
    v_mov_b32 v108, 0x3427c5ac
    v_and_b32 v16, 0xffff0000, v24
    v_fmamk_f32 v16, v16, 0x3c800000, v108
    v_and_b32 v17, 0xffff0000, v26
    v_fmamk_f32 v17, v17, 0x3c800000, v108
    v_and_b32 v18, 0xffff0000, v28
    v_fmamk_f32 v18, v18, 0x3c800000, v108
    v_and_b32 v19, 0xffff0000, v30
    v_fmamk_f32 v19, v19, 0x3c800000, v108
    v_rsq_f32 v16, v16
    v_lshlrev_b32 v20, 16, v24
    v_rsq_f32 v17, v17
    v_lshlrev_b32 v21, 16, v26
    v_rsq_f32 v18, v18
    v_lshlrev_b32 v22, 16, v28
    v_rsq_f32 v19, v19
    v_lshlrev_b32 v23, 16, v30
    v_pk_mul_f32 v[20:21], v[20:21], v[16:17] neg_lo:[1,0] neg_hi:[1,0]
    v_pk_mul_f32 v[22:23], v[22:23], v[18:19] neg_lo:[1,0] neg_hi:[1,0]
    v_pk_mul_f32 v[24:25], v[16:17], s[34:35] op_sel:[0,0] op_sel_hi:[1,0]
    v_pk_mul_f32 v[26:27], v[18:19], s[34:35] op_sel:[0,0] op_sel_hi:[1,0]
    v_pk_mul_f32 v[28:29], v[20:21], s[34:35] op_sel:[0,0] op_sel_hi:[1,0]
    v_pk_mul_f32 v[30:31], v[22:23], s[34:35] op_sel:[0,0] op_sel_hi:[1,0]
    v_pk_fma_f32 v[92:93], v[60:61], v[24:25], v[28:29]
    v_pk_fma_f32 v[94:95], v[62:63], v[26:27], v[30:31]
    v_pk_fma_f32 v[96:97], v[64:65], v[24:25], v[28:29]
    v_pk_fma_f32 v[98:99], v[66:67], v[26:27], v[30:31]
    v_pk_fma_f32 v[100:101], v[68:69], v[24:25], v[28:29]
    v_pk_fma_f32 v[102:103], v[70:71], v[26:27], v[30:31]
    v_pk_fma_f32 v[104:105], v[72:73], v[24:25], v[28:29]
    v_pk_fma_f32 v[106:107], v[74:75], v[26:27], v[30:31]
    v_exp_f32 v92, v92
    v_exp_f32 v93, v93
    v_pk_fma_f32 v[76:77], v[60:61], v[16:17], v[20:21]
    v_exp_f32 v94, v94
    v_exp_f32 v95, v95
    v_pk_fma_f32 v[78:79], v[62:63], v[18:19], v[22:23]
    v_exp_f32 v96, v96
    v_exp_f32 v97, v97
    v_pk_fma_f32 v[80:81], v[64:65], v[16:17], v[20:21]
    v_exp_f32 v98, v98
    v_exp_f32 v99, v99
    v_pk_fma_f32 v[82:83], v[66:67], v[18:19], v[22:23]
    v_exp_f32 v100, v100
    v_exp_f32 v101, v101
    v_pk_fma_f32 v[84:85], v[68:69], v[16:17], v[20:21]
    v_exp_f32 v102, v102
    v_exp_f32 v103, v103
    v_pk_fma_f32 v[86:87], v[70:71], v[18:19], v[22:23]
    v_exp_f32 v104, v104
    v_exp_f32 v105, v105
    v_pk_fma_f32 v[88:89], v[72:73], v[16:17], v[20:21]
    v_exp_f32 v106, v106
    v_exp_f32 v107, v107
    v_pk_fma_f32 v[90:91], v[74:75], v[18:19], v[22:23]
    s_mov_b32 s62, 0
    s_cmp_lg_u32 s46, 2
    s_cbranch_scc1 F_poll_w
F_mid:
    v_pk_add_f32 v[92:93], v[92:93], 1.0 op_sel_hi:[1,0]
    v_pk_add_f32 v[94:95], v[94:95], 1.0 op_sel_hi:[1,0]
    v_pk_add_f32 v[96:97], v[96:97], 1.0 op_sel_hi:[1,0]
    v_pk_add_f32 v[98:99], v[98:99], 1.0 op_sel_hi:[1,0]
    v_pk_add_f32 v[100:101], v[100:101], 1.0 op_sel_hi:[1,0]
    v_pk_add_f32 v[102:103], v[102:103], 1.0 op_sel_hi:[1,0]
    v_pk_add_f32 v[104:105], v[104:105], 1.0 op_sel_hi:[1,0]
    v_pk_add_f32 v[106:107], v[106:107], 1.0 op_sel_hi:[1,0]
    v_rcp_f32 v92, v92
    v_rcp_f32 v93, v93
    v_rcp_f32 v94, v94
    v_rcp_f32 v95, v95
    v_rcp_f32 v96, v96
    v_rcp_f32 v97, v97
    v_rcp_f32 v98, v98
    v_rcp_f32 v99, v99
    v_rcp_f32 v100, v100
    v_rcp_f32 v101, v101
    v_rcp_f32 v102, v102
    v_rcp_f32 v103, v103
    v_rcp_f32 v104, v104
    v_rcp_f32 v105, v105
    v_rcp_f32 v106, v106
    v_rcp_f32 v107, v107
    v_pk_mul_f32 v[76:77], v[76:77], v[92:93]
    v_pk_mul_f32 v[78:79], v[78:79], v[94:95]
    v_pk_mul_f32 v[80:81], v[80:81], v[96:97]
    v_pk_mul_f32 v[82:83], v[82:83], v[98:99]
    v_pk_mul_f32 v[84:85], v[84:85], v[100:101]
    v_pk_mul_f32 v[86:87], v[86:87], v[102:103]
    v_pk_mul_f32 v[88:89], v[88:89], v[104:105]
    v_pk_mul_f32 v[90:91], v[90:91], v[106:107]
    s_mov_b32 s62, 0
    s_cmp_eq_u32 s46, 2
    s_cbranch_scc1 F_fetched
    s_branch F_poll_w
F_poll:
    s_load_dwordx16 s[68:83], s[42:43], 0 glc
    s_load_dwordx16 s[84:99], s[42:43], 64 glc
F_poll_w:
    s_waitcnt lgkmcnt(0)
    s_xor_b64 s[68:69], s[68:69], s[40:41]
    s_xor_b64 s[70:71], s[70:71], s[40:41]
    s_or_b64 s[68:69], s[68:69], s[70:71]
    s_xor_b64 s[72:73], s[72:73], s[40:41]
    s_or_b64 s[68:69], s[68:69], s[72:73]
    s_xor_b64 s[74:75], s[74:75], s[40:41]
    s_or_b64 s[68:69], s[68:69], s[74:75]
    s_xor_b64 s[76:77], s[76:77], s[40:41]
    s_or_b64 s[68:69], s[68:69], s[76:77]
    s_xor_b64 s[78:79], s[78:79], s[40:41]
    s_or_b64 s[68:69], s[68:69], s[78:79]
    s_xor_b64 s[80:81], s[80:81], s[40:41]
    s_or_b64 s[68:69], s[68:69], s[80:81]
    s_xor_b64 s[82:83], s[82:83], s[40:41]
    s_or_b64 s[68:69], s[68:69], s[82:83]
    s_xor_b64 s[84:85], s[84:85], s[40:41]
    s_or_b64 s[68:69], s[68:69], s[84:85]
    s_xor_b64 s[86:87], s[86:87], s[40:41]
    s_or_b64 s[68:69], s[68:69], s[86:87]
    s_xor_b64 s[88:89], s[88:89], s[40:41]
    s_or_b64 s[68:69], s[68:69], s[88:89]
    s_xor_b64 s[90:91], s[90:91], s[40:41]
    s_or_b64 s[68:69], s[68:69], s[90:91]
    s_xor_b64 s[92:93], s[92:93], s[40:41]
    s_or_b64 s[68:69], s[68:69], s[92:93]
    s_xor_b64 s[94:95], s[94:95], s[40:41]
    s_or_b64 s[68:69], s[68:69], s[94:95]
    s_xor_b64 s[96:97], s[96:97], s[40:41]
    s_or_b64 s[68:69], s[68:69], s[96:97]
    s_xor_b64 s[98:99], s[98:99], s[40:41]
    s_or_b64 s[68:69], s[68:69], s[98:99]
    s_cbranch_scc0 F_rel
    s_cmp_lg_u32 s46, 0
    s_cbranch_scc1 F_poll_n
    s_mov_b32 s46, 1
    s_load_dwordx16 s[68:83], s[42:43], 0 glc
    s_load_dwordx16 s[84:99], s[42:43], 64 glc
    s_branch F_mid
F_poll_n:
    s_add_u32 s62, s62, 1
    s_sleep 5
    s_cmp_lt_u32 s62, 200000
    s_cbranch_scc1 F_poll
F_rel:
    buffer_load_dword v48, v120, s[24:27], s58 offen sc1
    s_add_u32 s58, s58, 33280
    buffer_load_dword v49, v120, s[24:27], s58 offen sc1
    s_add_u32 s58, s58, 33280
    buffer_load_dword v50, v120, s[24:27], s58 offen sc1
    s_add_u32 s58, s58, 33280
    buffer_load_dword v51, v120, s[24:27], s58 offen sc1
    s_add_u32 s58, s58, 33280
    buffer_load_dword v52, v120, s[24:27], s58 offen sc1
    s_add_u32 s58, s58, 33280
    buffer_load_dword v53, v120, s[24:27], s58 offen sc1
    s_add_u32 s58, s58, 33280
    buffer_load_dword v54, v120, s[24:27], s58 offen sc1
    s_add_u32 s58, s58, 33280
    buffer_load_dword v55, v120, s[24:27], s58 offen sc1
    s_load_dwordx2 s[36:37], s[10:11], s63
    s_cmp_lg_u32 s3, 0
    s_cbranch_scc1 F_novx
    buffer_load_dword v56, v125, s[24:27], s60 offen sc1
F_novx:
    s_cmp_eq_u32 s46, 0
    s_mov_b32 s46, 2
    s_cbranch_scc1 F_mid
F_fetched:
    s_cmp_lg_u32 s3, 0
    s_cbranch_scc1 F_A
    s_waitcnt vmcnt(0)
    v_mfma_f32_32x32x16_f16 v[92:107], v[40:43], v[56:59], 0
    v_mfma_f32_32x32x16_f16 v[92:107], v[32:35], v[48:51], v[92:107]
    s_branch F_A2
F_A:
    s_waitcnt vmcnt(4)
    v_mfma_f32_32x32x16_f16 v[92:107], v[32:35], v[48:51], 0
    s_waitcnt vmcnt(0)
F_A2:
    v_mfma_f32_32x32x16_f16 v[92:107], v[36:39], v[52:55], v[92:107]
    s_waitcnt lgkmcnt(0)
    s_and_b32 s34, s36, 0x77
    s_cmp_eq_u32 s34, s47
    s_cbranch_scc1 F_eh
F_eh_r:
    s_nop 7
    v_cvt_pk_f16_f32 v48, v92, v93
    v_cvt_pk_f16_f32 v49, v94, v95
    ds_write2st64_b32 v121, v48, v49 offset0:128 offset1:133
    v_cvt_pk_f16_f32 v50, v96, v97
    v_cvt_pk_f16_f32 v51, v98, v99
    ds_write2st64_b32 v121, v50, v51 offset0:148 offset1:153
    v_cvt_pk_f16_f32 v52, v100, v101
    v_cvt_pk_f16_f32 v53, v102, v103
    ds_write2st64_b32 v121, v52, v53 offset0:168 offset1:173
    v_cvt_pk_f16_f32 v54, v104, v105
    v_cvt_pk_f16_f32 v55, v106, v107
    ds_write2st64_b32 v121, v54, v55 offset0:188 offset1:193
    s_waitcnt lgkmcnt(0)
    s_barrier
    ds_read_b128 v[48:51], v122 offset:32768
    ds_read_b128 v[52:55], v122 offset:32784
    s_waitcnt lgkmcnt(1)
    v_mfma_f32_16x16x16_f16 v[92:95], v[44:45], v[48:49], 0
    v_mfma_f32_16x16x16_f16 v[96:99], v[44:45], v[50:51], 0
    s_waitcnt lgkmcnt(0)
    v_mfma_f32_16x16x16_f16 v[100:103], v[44:45], v[52:53], 0
    v_mfma_f32_16x16x16_f16 v[104:107], v[44:45], v[54:55], 0
    s_and_b32 s34, s36, 0x77
    s_cmp_lg_u32 s34, s47
    s_cbranch_scc1 F_noh
    s_mul_i32 s50, s33, 28
    s_sub_u32 s50, s50, s68
    s_sub_u32 s50, s50, s69
    s_sub_u32 s50, s50, s70
    s_sub_u32 s50, s50, s71
    s_sub_u32 s50, s50, s72
    s_sub_u32 s50, s50, s73
    s_sub_u32 s50, s50, s74
    s_sub_u32 s50, s50, s75
    s_sub_u32 s50, s50, s76
    s_sub_u32 s50, s50, s77
    s_sub_u32 s50, s50, s78
    s_sub_u32 s50, s50, s79
    s_sub_u32 s50, s50, s80
    s_sub_u32 s50, s50, s81
    s_sub_u32 s50, s50, s84
    s_sub_u32 s50, s50, s85
    s_sub_u32 s50, s50, s86
    s_sub_u32 s50, s50, s87
    s_sub_u32 s50, s50, s88
    s_sub_u32 s50, s50, s89
    s_sub_u32 s50, s50, s90
    s_sub_u32 s50, s50, s91
    s_sub_u32 s50, s50, s92
    s_sub_u32 s50, s50, s93
    s_sub_u32 s50, s50, s94
    s_sub_u32 s50, s50, s95
    s_sub_u32 s50, s50, s96
    s_sub_u32 s50, s50, s97
    s_cmp_eq_u32 s50, 0
    s_cbranch_scc1 F_own
    s_load_dwordx16 s[68:83], s[10:11], s48 glc
    s_load_dwordx16 s[84:99], s[10:11], s52 glc
F_noh:
    s_cmp_eq_u32 s57, 0
    s_cbranch_scc1 F_zero
F_nz:
    v_pk_fma_f32 v[60:61], v[92:93], v[76:77], v[60:61]
    v_pk_fma_f32 v[64:65], v[96:97], v[80:81], v[64:65]
    v_pk_fma_f32 v[68:69], v[100:101], v[84:85], v[68:69]
    v_pk_fma_f32 v[72:73], v[104:105], v[88:89], v[72:73]
    v_cvt_pk_bf16_f32 v32, v60, v64
    v_cvt_pk_bf16_f32 v33, v68, v72
    buffer_store_dwordx2 v[32:33], v123, s[20:23], s64 offen sc1
    v_cvt_pk_bf16_f32 v34, v61, v65
    v_cvt_pk_bf16_f32 v35, v69, v73
    buffer_store_dwordx2 v[34:35], v123, s[20:23], s65 offen sc1
    v_pk_fma_f32 v[62:63], v[94:95], v[78:79], v[62:63]
    v_pk_fma_f32 v[66:67], v[98:99], v[82:83], v[66:67]
    v_pk_fma_f32 v[70:71], v[102:103], v[86:87], v[70:71]
    v_pk_fma_f32 v[74:75], v[106:107], v[90:91], v[74:75]
    v_cvt_pk_bf16_f32 v36, v62, v66
    v_cvt_pk_bf16_f32 v37, v70, v74
    buffer_store_dwordx2 v[36:37], v123, s[20:23], s66 offen sc1
    v_cvt_pk_bf16_f32 v38, v63, v67
    v_cvt_pk_bf16_f32 v39, v71, v75
    buffer_store_dwordx2 v[38:39], v123, s[20:23], s67 offen sc1
    s_mov_b32 s62, 0
    s_cmp_lg_u32 s16, 0
    s_cbranch_scc1 F_own2
F_res:
    s_cmp_eq_u32 s37, s33
    s_cbranch_scc1 F_res_d
    s_load_dwordx2 s[36:37], s[10:11], s63 glc
    s_add_u32 s62, s62, 1
    s_cmp_lt_u32 s62, 200000
    s_waitcnt lgkmcnt(0)
    s_cbranch_scc1 F_res
F_res_d:
    s_and_b32 s34, s36, 0x77
    s_cmp_lg_u32 s34, s47
    s_cbranch_scc1 L_fin
    v_lshrrev_b32 v108, 3, v2
    v_lshlrev_b32 v108, 12, v108
    v_and_b32 v109, 0x70, v126
    v_add_u32 v108, v108, v109
    s_cmp_eq_u32 s50, 0
    s_cbranch_scc1 F_n2_d
    s_mul_i32 s50, s33, 28
    s_mov_b32 s62, 0
F_n2:
    s_waitcnt lgkmcnt(0)
    s_add_u32 s84, s84, s68
    s_add_u32 s84, s84, s69
    s_add_u32 s84, s84, s70
    s_add_u32 s84, s84, s71
    s_add_u32 s84, s84, s72
    s_add_u32 s84, s84, s73
    s_add_u32 s84, s84, s74
    s_add_u32 s84, s84, s75
    s_add_u32 s84, s84, s76
    s_add_u32 s84, s84, s77
    s_add_u32 s84, s84, s78
    s_add_u32 s84, s84, s79
    s_add_u32 s84, s84, s80
    s_add_u32 s84, s84, s81
    s_add_u32 s84, s84, s85
    s_add_u32 s84, s84, s86
    s_add_u32 s84, s84, s87
    s_add_u32 s84, s84, s88
    s_add_u32 s84, s84, s89
    s_add_u32 s84, s84, s90
    s_add_u32 s84, s84, s91
    s_add_u32 s84, s84, s92
    s_add_u32 s84, s84, s93
    s_add_u32 s84, s84, s94
    s_add_u32 s84, s84, s95
    s_add_u32 s84, s84, s96
    s_add_u32 s84, s84, s97
    s_cmp_eq_u32 s84, s50
    s_cbranch_scc1 F_n2_d
    s_load_dwordx16 s[68:83], s[10:11], s48 glc
    s_load_dwordx16 s[84:99], s[10:11], s52 glc
    s_add_u32 s62, s62, 1
    s_cmp_lt_u32 s62, 200000
    s_cbranch_scc1 F_n2
F_n2_d:
    s_mov_b32 s62, 0
F_h2:
    s_mov_b32 s34, s49
    buffer_load_dwordx4 v[8:11], v108, s[24:27], s34 offen sc1
    s_add_u32 s34, s34, 32768
    buffer_load_dwordx4 v[12:15], v108, s[24:27], s34 offen sc1
    s_add_u32 s34, s34, 32768
    buffer_load_dwordx4 v[24:27], v108, s[24:27], s34 offen sc1
    s_add_u32 s34, s34, 32768
    buffer_load_dwordx4 v[28:31], v108, s[24:27], s34 offen sc1
    s_add_u32 s34, s34, 32768
    buffer_load_dwordx4 v[48:51], v108, s[24:27], s34 offen sc1
    s_add_u32 s34, s34, 32768
    buffer_load_dwordx4 v[52:55], v108, s[24:27], s34 offen sc1
    s_add_u32 s34, s34, 32768
    buffer_load_dwordx4 v[56:59], v108, s[24:27], s34 offen sc1
    s_cmp_lg_u32 s62, 0
    s_cbranch_scc1 F_h2_w
F_own2:
    s_bfe_u32 s38, s36, 0x20007
    s_bfe_u32 s39, s36, 0x20009
    s_bfe_u32 s51, s36, 0x10003
    s_set_gpr_idx_on s38, 1
    v_mov_b32 v40, v92
    v_mov_b32 v41, v96
    v_mov_b32 v42, v100
    v_mov_b32 v43, v104
    v_mov_b32 v44, v16
    v_mov_b32 v45, v20
    s_set_gpr_idx_off
    s_lshl1_add_u32 s34, s39, s51
    s_lshl_b32 s44, s34, 3
    v_add_u32 v114, s53, v126
    ds_write_b128 v114, v[40:43] offset:2560
    v_and_b32 v113, 7, v2
    v_lshl_add_u32 v113, v113, 2, v4
    s_lshl4_add_u32 s34, s44, s53
    v_lshl_add_u32 v112, v113, 2, s34
    ds_read_b32 v112, v112 offset:2560
    s_lshl2_add_u32 s34, s38, s39
    s_lshl_b32 s34, s34, 6
    s_mul_i32 s35, s51, 1152
    s_add_u32 s34, s34, s35
    s_add_u32 s34, s34, s53
    v_lshlrev_b32 v113, 1, v113
    v_add_u32 v110, s34, v113
    ds_read_u16 v110, v110
    v_readlane_b32 s45, v44, s44
    v_readlane_b32 s46, v45, s44
    s_and_b32 s34, s36, 0xfffff800
    s_ashr_i32 s35, s34, 31
    s_orn2_b32 s35, 0x80000000, s35
    s_xor_b32 s34, s34, s35
    v_mov_b32 v109, 0xbfb8aa3b
    v_mul_f32 v109, s34, v109
    v_exp_f32 v109, v109
    s_waitcnt lgkmcnt(0)
    v_lshlrev_b32 v110, 16, v110
    v_mov_b32 v111, s46
    v_add_f32 v109, 1.0, v109
    v_rcp_f32 v109, v109
    v_fmac_f32 v111, s45, v110
    v_mul_f32 v109, 0x41000000, v109
    s_and_b32 s38, s36, 2047
    s_lshl_b32 s38, s38, 11
    s_lshl_b32 s34, s57, 6
    s_add_u32 s38, s38, s34
    s_cmp_eq_u32 s16, 0
    s_cbranch_scc1 F_h2_w
    s_waitcnt vmcnt(4)
    v_pk_add_f32 v[88:89], v[8:9], v[12:13]
    v_pk_add_f32 v[90:91], v[10:11], v[14:15]
    v_pk_add_f32 v[88:89], v[88:89], v[24:25]
    v_pk_add_f32 v[90:91], v[90:91], v[26:27]
    v_pk_add_f32 v[88:89], v[88:89], v[28:29]
    v_pk_add_f32 v[90:91], v[90:91], v[30:31]
    v_pk_add_f32 v[88:89], v[88:89], v[48:49]
    v_pk_add_f32 v[90:91], v[90:91], v[50:51]
    v_pk_add_f32 v[88:89], v[88:89], v[52:53]
    v_pk_add_f32 v[90:91], v[90:91], v[54:55]
    v_pk_add_f32 v[88:89], v[88:89], v[56:57]
    v_pk_add_f32 v[90:91], v[90:91], v[58:59]
    s_nop 0
    v_permlane16_swap_b32 v88, v89
    v_permlane16_swap_b32 v90, v91
    v_add_f32 v88, v88, v89
    v_add_f32 v90, v90, v91
    s_nop 1
    v_permlane32_swap_b32 v88, v90
    v_add_f32 v88, v88, v90
    s_nop 1
    v_add_f32_dpp v88, v88, v88 row_ror:8 row_mask:0xf bank_mask:0xf
    v_cmp_u_f32 vcc, v88, v88
    v_fma_f32 v88, v88, v109, v111
    s_cbranch_vccz F_h2_d
    s_branch F_h2_x
F_h2_w:
    s_waitcnt vmcnt(5)
    v_pk_add_f32 v[88:89], v[8:9], v[12:13]
    v_pk_add_f32 v[90:91], v[10:11], v[14:15]
    s_waitcnt vmcnt(4)
    v_pk_add_f32 v[88:89], v[88:89], v[24:25]
    v_pk_add_f32 v[90:91], v[90:91], v[26:27]
    s_waitcnt vmcnt(3)
    v_pk_add_f32 v[88:89], v[88:89], v[28:29]
    v_pk_add_f32 v[90:91], v[90:91], v[30:31]
    s_waitcnt vmcnt(2)
    v_pk_add_f32 v[88:89], v[88:89], v[48:49]
    v_pk_add_f32 v[90:91], v[90:91], v[50:51]
    s_waitcnt vmcnt(1)
    v_pk_add_f32 v[88:89], v[88:89], v[52:53]
    v_pk_add_f32 v[90:91], v[90:91], v[54:55]
    s_waitcnt vmcnt(0)
    v_pk_add_f32 v[88:89], v[88:89], v[56:57]
    v_pk_add_f32 v[90:91], v[90:91], v[58:59]
    s_nop 0
    v_permlane16_swap_b32 v88, v89
    v_permlane16_swap_b32 v90, v91
    v_add_f32 v88, v88, v89
    v_add_f32 v90, v90, v91
    s_nop 1
    v_permlane32_swap_b32 v88, v90
    v_add_f32 v88, v88, v90
    s_nop 1
    v_add_f32_dpp v88, v88, v88 row_ror:8 row_mask:0xf bank_mask:0xf
    v_cmp_u_f32 vcc, v88, v88
    v_fma_f32 v88, v88, v109, v111
    s_cbranch_vccnz F_h2_x
F_h2_d:
    v_mul_f32 v89, 0xbe38aa3b, v88
    v_exp_f32 v89, v89
    v_mul_f32 v88, v88, v112
    v_add_f32 v89, 1.0, v89
    v_rcp_f32 v89, v89
    s_mov_b32 exec_lo, 0x00ff00ff
    s_mov_b32 exec_hi, 0x00ff00ff
    v_fmac_f32 v110, v88, v89
    v_cvt_pk_bf16_f32 v110, v110, v110
    buffer_store_short v110, v113, s[20:23], s38 offen sc1
    s_cmp_lg_u32 s57, 0
    s_cbranch_scc1 L_fin
    s_mov_b64 exec, 1
    v_mov_b32 v108, 0
    v_mov_b32 v109, s33
    buffer_store_dword v109, v108, s[24:27], 0 offen sc1
    s_branch L_fin
F_own:
    s_cmp_lg_u32 s37, s33
    s_cbranch_scc1 F_noh
    v_lshrrev_b32 v108, 3, v2
    v_lshlrev_b32 v108, 12, v108
    v_and_b32 v109, 0x70, v126
    v_add_u32 v108, v108, v109
    s_mov_b32 s34, s49
    buffer_load_dwordx4 v[8:11], v108, s[24:27], s34 offen sc1
    s_add_u32 s34, s34, 32768
    buffer_load_dwordx4 v[12:15], v108, s[24:27], s34 offen sc1
    s_add_u32 s34, s34, 32768
    buffer_load_dwordx4 v[24:27], v108, s[24:27], s34 offen sc1
    s_add_u32 s34, s34, 32768
    buffer_load_dwordx4 v[28:31], v108, s[24:27], s34 offen sc1
    s_add_u32 s34, s34, 32768
    buffer_load_dwordx4 v[48:51], v108, s[24:27], s34 offen sc1
    s_add_u32 s34, s34, 32768
    buffer_load_dwordx4 v[52:55], v108, s[24:27], s34 offen sc1
    s_add_u32 s34, s34, 32768
    buffer_load_dwordx4 v[56:59], v108, s[24:27], s34 offen sc1
    s_mov_b32 s16, 1
    s_branch F_noh
F_eh:
    s_load_dwordx16 s[68:83], s[10:11], s48 glc
    s_load_dwordx16 s[84:99], s[10:11], s52 glc
    s_branch F_eh_r
F_h2_x:
    v_max3_u32 v89, v8, v9, v10
    v_max3_u32 v89, v89, v11, v12
    v_max3_u32 v89, v89, v13, v14
    v_max3_u32 v89, v89, v15, v24
    v_max3_u32 v89, v89, v25, v26
    v_max3_u32 v89, v89, v27, v28
    v_max3_u32 v89, v89, v29, v30
    v_max3_u32 v89, v89, v31, v48
    v_max3_u32 v89, v89, v49, v50
    v_max3_u32 v89, v89, v51, v52
    v_max3_u32 v89, v89, v53, v54
    v_max3_u32 v89, v89, v55, v56
    v_max3_u32 v89, v89, v57, v58
    v_max_u32 v89, v89, v59
    v_cmp_eq_u32 vcc, -1, v89
    s_add_u32 s62, s62, 1
    s_cbranch_vccz F_h2_d
    s_cmp_lt_u32 s62, 200000
    s_cbranch_scc1 F_h2
    s_branch F_h2_d
F_zero:
    s_mov_b32 exec_lo, 0x01010101
    s_mov_b32 exec_hi, 0x01010101
    s_nop 2
    v_mov_b32 v92, 0
    v_mov_b32 v93, 0
    v_mov_b32 v94, 0
    v_mov_b32 v95, 0
    s_mov_b64 exec, -1
    s_branch F_nz
F_second:
    ds_read_b128 v[60:63], v126 offset:53760
    ds_read_b128 v[64:67], v126 offset:54784
    s_mov_b32 s46, 0
    s_mul_i32 s34, s44, 16640
    s_add_u32 s50, s50, 8320
    s_sub_u32 s50, s50, s34
    v_add_u32 v113, 1, v3
    v_bfe_i32 v113, v113, 4, 1
    v_and_b32 v113, 0xc2000000, v113
    v_xor_b32 v124, v113, v124
    v_xor_b32 v32, 0x80000000, v32
    v_xor_b32 v33, 0x80000000, v33
    v_xor_b32 v34, 0x80000000, v34
    v_xor_b32 v35, 0x80000000, v35
    v_xor_b32 v36, 0x80000000, v36
    v_xor_b32 v37, 0x80000000, v37
    v_xor_b32 v38, 0x80000000, v38
    v_xor_b32 v39, 0x80000000, v39
    v_mul_f32 v116, s70, v124
    v_fmac_f32 v116, v112, v124
    v_mfma_f32_16x16x32_bf16 v[76:79], v[8:11], v[32:35], 0
    v_mfma_f32_16x16x32_bf16 v[80:83], v[12:15], v[32:35], 0
    v_mfma_f32_16x16x32_bf16 v[84:87], v[8:11], v[36:39], 0
    v_mfma_f32_16x16x32_bf16 v[88:91], v[12:15], v[36:39], 0
    v_mfma_f32_16x16x32_bf16 v[92:95], v[16:19], v[32:35], 0
    v_mfma_f32_16x16x32_bf16 v[96:99], v[20:23], v[32:35], 0
    v_mfma_f32_16x16x32_bf16 v[100:103], v[16:19], v[36:39], 0
    v_mfma_f32_16x16x32_bf16 v[104:107], v[20:23], v[36:39], 0
    s_nop 2
    v_pk_mul_f32 v[84:85], v[84:85], s[54:55] op_sel:[0,0] op_sel_hi:[1,0]
    v_pk_mul_f32 v[86:87], v[86:87], s[54:55] op_sel:[0,0] op_sel_hi:[1,0]
    v_pk_mul_f32 v[88:89], v[88:89], s[54:55] op_sel:[0,0] op_sel_hi:[1,0]
    v_pk_mul_f32 v[90:91], v[90:91], s[54:55] op_sel:[0,0] op_sel_hi:[1,0]
    s_waitcnt lgkmcnt(0)
    s_barrier
    s_branch F_pass
F_key:
    v_mov_b32 v115, s33
    v_lshlrev_b32 v108, 11, v2
    s_lshl3_add_u32 s35, s2, 8192
    s_mov_b32 exec_lo, 0xff
    s_mov_b32 exec_hi, 0x0
    buffer_store_dwordx2 v[114:115], v108, s[24:27], s35 offen sc1
    s_mov_b64 exec, -1
    s_mov_b32 s71, 1
    s_branch F_nokey
F_wkey:
    s_waitcnt vmcnt(2)
    s_branch F_wkey_r
M_entry:
    s_sub_u32 s28, s2, 256
    s_lshr_b32 s29, s28, 1
    s_xor_b32 s29, s29, s28
    s_and_b32 s29, s29, 8
    s_mul_i32 s29, s29, 3
    s_xor_b32 s28, s28, s29
    s_lshr_b32 s29, s28, 4
    s_bfe_u32 s30, s28, 0x20001
    s_lshl2_add_u32 s29, s29, s30
    s_and_b32 s30, s28, 1
    s_lshl_b32 s30, s30, 1
    s_bitcmp1_b32 s28, 3
    s_addc_u32 s30, s30, 0
    s_setprio 3
    v_mov_b32 v7, 1152
    s_mov_b32 s26, 268435456
    s_mov_b32 s27, 0x20000
    v_mov_b32 v8, 0
    v_mov_b32 v9, 0
    v_mov_b32 v10, 0
    v_mov_b32 v11, 0
    v_mov_b32 v114, 0
    ds_write_b128 v7, v[8:11]
    ds_write_b128 v7, v[8:11] offset:16
    ds_write_b128 v7, v[8:11] offset:32
    v_mov_b32 v8, 0x3f803f80
    v_mov_b32 v9, 0x3f803f80
    v_lshlrev_b32 v10, 3, v2
    ds_write_b64 v10, v[8:9] offset:512
    s_waitcnt lgkmcnt(0)
    s_load_dword s16, s[10:11], 0
    s_mul_i32 s12, s3, 320
    s_min_u32 s12, s12, 2048
    s_add_u32 s18, s12, 7872
    s_and_b32 s13, s28, 7
    s_lshl_b32 s13, s13, 11
    s_add_u32 s12, s12, s13
    s_add_u32 s12, s12, 7872
    s_add_u32 s12, s10, s12
    s_addc_u32 s13, s11, 0
    s_barrier
    s_waitcnt lgkmcnt(0)
    s_mul_i32 s16, s16, 0x9e3779b1
    s_add_u32 s16, s16, 0x7f4a7c15
    s_mul_i32 s15, s16, 40
    s_mov_b32 s17, 0
    s_sub_u32 s31, s3, 2
    s_cmp_lt_u32 s31, 4
    s_cbranch_scc1 M_pre
    v_mov_b32 v8, 1152
    s_mov_b32 s62, 0
M_pg:
    ds_read_b32 v9, v8
    s_waitcnt lgkmcnt(0)
    v_cmp_gt_u32 vcc, 8, v9
    s_add_u32 s62, s62, 1
    s_cbranch_vccz M_pg_d
    s_sleep 1
    s_cmp_lt_u32 s62, 1000000
    s_cbranch_scc1 M_pg
M_pg_d:
    s_branch M_scan0
M_pre:
    s_and_b32 s46, s28, 7
    s_lshl2_add_u32 s6, s46, s31
    s_lshl_b32 s6, s6, 6
    s_lshr_b32 s44, s28, 3
    s_lshr_b32 s34, s31, 1
    s_lshl1_add_u32 s44, s44, s34
    s_lshl4_add_u32 s44, s44, s46
    s_and_b32 s34, s31, 1
    s_lshl1_add_u32 s44, s44, s34
    s_lshl_b32 s44, s44, 7
    v_lshrrev_b32 v114, 5, v2
    v_mul_u32_u24 v114, 0x4800, v114
    v_xor_b32 v114, s44, v114
    v_and_b32 v115, 31, v2
    v_lshl_add_u32 v114, v115, 2, v114
    s_mov_b32 s44, 262144
    s_lshl2_add_u32 s45, s29, s30
    s_lshl_b32 s45, s45, 10
    s_lshl_b32 s34, s31, 8
    s_add_u32 s45, s45, s34
    s_add_u32 s45, s45, 491520
    s_lshl_b32 s34, s31, 6
    v_lshl_add_u32 v113, v2, 2, s34
    s_mov_b32 s7, s45
    v_bfe_u32 v8, v2, 2, 2
    v_lshl_add_u32 v9, v4, 2, v8
    v_and_b32 v10, 7, v9
    v_lshlrev_b32 v10, 1, v10
    v_bfe_u32 v11, v2, 1, 1
    s_lshl_b32 s34, s31, 2
    v_or_b32 v12, s34, v11
    v_xor_b32 v12, v12, v10
    v_lshlrev_b32 v12, 4, v12
    v_lshl_add_u32 v12, v9, 8, v12
    v_and_b32 v13, 1, v2
    v_lshl_add_u32 v12, v13, 3, v12
    v_xor_b32 v126, 32, v12
    s_lshl_b32 s34, s31, 3
    v_or_b32 v120, s34, v11
    v_xor_b32 v120, v120, v10
    v_lshlrev_b32 v120, 4, v120
    v_lshl_add_u32 v120, v9, 9, v120
    v_lshl_add_u32 v120, v13, 3, v120
    v_xor_b32 v121, 32, v120
    v_xor_b32 v122, 64, v120
    v_xor_b32 v123, 96, v120
    v_lshlrev_b32 v14, 4, v4
    v_and_b32 v15, 1, v2
    v_lshl_add_u32 v15, v15, 9, v14
    v_mov_b32 v8, 1152
    s_mov_b32 s62, 0
M_wg6:
    ds_read_b32 v9, v8
    s_waitcnt lgkmcnt(0)
    v_cmp_gt_u32 vcc, 6, v9
    s_add_u32 s62, s62, 1
    s_cbranch_vccz M_wg6_d
    s_sleep 1
    s_cmp_lt_u32 s62, 1000000
    s_cbranch_scc1 M_wg6
M_wg6_d:
    ds_read_b64_tr_b16 v[16:17], v12 offset:1280
    ds_read_b64_tr_b16 v[18:19], v12 offset:5376
    ds_read_b64_tr_b16 v[32:33], v126 offset:1280
    ds_read_b64_tr_b16 v[34:35], v126 offset:5376
    ds_read_b64_tr_b16 v[20:21], v12 offset:9472
    ds_read_b64_tr_b16 v[22:23], v12 offset:13568
    ds_read_b64_tr_b16 v[36:37], v126 offset:9472
    ds_read_b64_tr_b16 v[38:39], v126 offset:13568
    ds_read_b64_tr_b16 v[24:25], v12 offset:17664
    ds_read_b64_tr_b16 v[26:27], v12 offset:21760
    ds_read_b64_tr_b16 v[40:41], v126 offset:17664
    ds_read_b64_tr_b16 v[42:43], v126 offset:21760
    v_mov_b32 v8, 1
    s_waitcnt lgkmcnt(0)
    s_mov_b64 exec, 1
    ds_add_u32 v7, v8 offset:4
    s_mov_b64 exec, -1
    v_mov_b32 v8, 1152
    s_mov_b32 s62, 0
M_wg:
    ds_read_b32 v9, v8
    s_waitcnt lgkmcnt(0)
    v_cmp_gt_u32 vcc, 8, v9
    s_add_u32 s62, s62, 1
    s_cbranch_vccz M_wg_d
    s_sleep 1
    s_cmp_lt_u32 s62, 1000000
    s_cbranch_scc1 M_wg
M_wg_d:
    ds_read_b64_tr_b16 v[28:29], v12 offset:25856
    ds_read_b64_tr_b16 v[30:31], v12 offset:29952
    ds_read_b64_tr_b16 v[44:45], v126 offset:25856
    ds_read_b64_tr_b16 v[46:47], v126 offset:29952
M_scan0:
    s_lshl_b32 s15, s16, 3
    s_mov_b32 s19, 0
    v_mov_b32 v10, 0
    s_load_dwordx16 s[20:35], s[12:13], 0
    s_load_dwordx16 s[36:51], s[12:13], 64
    s_load_dwordx16 s[52:67], s[12:13], 128
    s_load_dwordx16 s[68:83], s[12:13], 192
    s_load_dwordx16 s[84:99], s[12:13], 256
    v_mov_b32 v8, 1
    s_mov_b64 exec, 1
    s_waitcnt lgkmcnt(0)
    ds_add_u32 v7, v8 offset:24
    s_mov_b64 exec, -1
    s_branch M_scan1
M_scan:
    s_waitcnt lgkmcnt(0)
M_scan1:
    s_add_u32 s14, s21, s23
    s_add_u32 s14, s14, s25
    s_add_u32 s14, s14, s27
    s_add_u32 s14, s14, s29
    s_add_u32 s14, s14, s31
    s_add_u32 s14, s14, s33
    s_add_u32 s14, s14, s35
    s_cmp_lg_u32 s14, s15
    s_cbranch_scc1 M_sec0
    v_max_u32 v10, s20, v10
    v_max_u32 v10, s22, v10
    v_max_u32 v10, s24, v10
    v_max_u32 v10, s26, v10
    v_max_u32 v10, s28, v10
    v_max_u32 v10, s30, v10
    v_max_u32 v10, s32, v10
    v_max_u32 v10, s34, v10
    s_bitset1_b32 s19, 0
    s_mov_b32 s21, 0
M_sec0:
    s_add_u32 s14, s37, s39
    s_add_u32 s14, s14, s41
    s_add_u32 s14, s14, s43
    s_add_u32 s14, s14, s45
    s_add_u32 s14, s14, s47
    s_add_u32 s14, s14, s49
    s_add_u32 s14, s14, s51
    s_cmp_lg_u32 s14, s15
    s_cbranch_scc1 M_sec1
    v_max_u32 v10, s36, v10
    v_max_u32 v10, s38, v10
    v_max_u32 v10, s40, v10
    v_max_u32 v10, s42, v10
    v_max_u32 v10, s44, v10
    v_max_u32 v10, s46, v10
    v_max_u32 v10, s48, v10
    v_max_u32 v10, s50, v10
    s_bitset1_b32 s19, 1
    s_mov_b32 s37, 0
M_sec1:
    s_add_u32 s14, s53, s55
    s_add_u32 s14, s14, s57
    s_add_u32 s14, s14, s59
    s_add_u32 s14, s14, s61
    s_add_u32 s14, s14, s63
    s_add_u32 s14, s14, s65
    s_add_u32 s14, s14, s67
    s_cmp_lg_u32 s14, s15
    s_cbranch_scc1 M_sec2
    v_max_u32 v10, s52, v10
    v_max_u32 v10, s54, v10
    v_max_u32 v10, s56, v10
    v_max_u32 v10, s58, v10
    v_max_u32 v10, s60, v10
    v_max_u32 v10, s62, v10
    v_max_u32 v10, s64, v10
    v_max_u32 v10, s66, v10
    s_bitset1_b32 s19, 2
    s_mov_b32 s53, 0
M_sec2:
    s_add_u32 s14, s69, s71
    s_add_u32 s14, s14, s73
    s_add_u32 s14, s14, s75
    s_add_u32 s14, s14, s77
    s_add_u32 s14, s14, s79
    s_add_u32 s14, s14, s81
    s_add_u32 s14, s14, s83
    s_cmp_lg_u32 s14, s15
    s_cbranch_scc1 M_sec3
    v_max_u32 v10, s68, v10
    v_max_u32 v10, s70, v10
    v_max_u32 v10, s72, v10
    v_max_u32 v10, s74, v10
    v_max_u32 v10, s76, v10
    v_max_u32 v10, s78, v10
    v_max_u32 v10, s80, v10
    v_max_u32 v10, s82, v10
    s_bitset1_b32 s19, 3
    s_mov_b32 s69, 0
M_sec3:
    s_add_u32 s14, s85, s87
    s_add_u32 s14, s14, s89
    s_add_u32 s14, s14, s91
    s_add_u32 s14, s14, s93
    s_add_u32 s14, s14, s95
    s_add_u32 s14, s14, s97
    s_add_u32 s14, s14, s99
    s_cmp_lg_u32 s14, s15
    s_cbranch_scc1 M_sec4
    v_max_u32 v10, s84, v10
    v_max_u32 v10, s86, v10
    v_max_u32 v10, s88, v10
    v_max_u32 v10, s90, v10
    v_max_u32 v10, s92, v10
    v_max_u32 v10, s94, v10
    v_max_u32 v10, s96, v10
    v_max_u32 v10, s98, v10
    s_bitset1_b32 s19, 4
    s_mov_b32 s85, 0
M_sec4:
    s_cmp_eq_u32 s19, 31
    s_cbranch_scc1 M_scan_d
    s_add_u32 s17, s17, 1
    s_add_u32 s14, s2, s17
    s_and_b32 s14, s14, 7
    s_lshl_b32 s14, s14, 11
    s_add_u32 s14, s14, s18
    s_add_u32 s12, s10, s14
    s_addc_u32 s13, s11, 0
    s_sleep 2
    s_cmp_ge_u32 s17, 8
    s_cbranch_scc1 M_scan_u
    s_bitcmp1_b32 s19, 0
    s_cbranch_scc1 M_rla0
    s_load_dwordx16 s[20:35], s[12:13], 0
M_rla0:
    s_bitcmp1_b32 s19, 1
    s_cbranch_scc1 M_rla1
    s_load_dwordx16 s[36:51], s[12:13], 64
M_rla1:
    s_bitcmp1_b32 s19, 2
    s_cbranch_scc1 M_rla2
    s_load_dwordx16 s[52:67], s[12:13], 128
M_rla2:
    s_bitcmp1_b32 s19, 3
    s_cbranch_scc1 M_rla3
    s_load_dwordx16 s[68:83], s[12:13], 192
M_rla3:
    s_bitcmp1_b32 s19, 4
    s_cbranch_scc1 M_rla4
    s_load_dwordx16 s[84:99], s[12:13], 256
M_rla4:
    s_branch M_scan
M_scan_u:
    s_bitcmp1_b32 s19, 0
    s_cbranch_scc1 M_rlb0
    s_load_dwordx16 s[20:35], s[12:13], 0 glc
M_rlb0:
    s_bitcmp1_b32 s19, 1
    s_cbranch_scc1 M_rlb1
    s_load_dwordx16 s[36:51], s[12:13], 64 glc
M_rlb1:
    s_bitcmp1_b32 s19, 2
    s_cbranch_scc1 M_rlb2
    s_load_dwordx16 s[52:67], s[12:13], 128 glc
M_rlb2:
    s_bitcmp1_b32 s19, 3
    s_cbranch_scc1 M_rlb3
    s_load_dwordx16 s[68:83], s[12:13], 192 glc
M_rlb3:
    s_bitcmp1_b32 s19, 4
    s_cbranch_scc1 M_rlb4
    s_load_dwordx16 s[84:99], s[12:13], 256 glc
M_rlb4:
    s_cmp_lt_u32 s17, 200000
    s_cbranch_scc1 M_scan
    s_waitcnt lgkmcnt(0)
M_scan_d:
    v_mov_b32 v8, 1
    s_mov_b64 exec, 1
    ds_max_u32 v7, v10 offset:16
    ds_add_u32 v7, v8 offset:20
    s_mov_b64 exec, -1
    s_sub_u32 s31, s3, 2
    s_cmp_lt_u32 s31, 4
    s_cbranch_scc1 M_comp
    s_mov_b32 s33, s16
    s_sub_u32 s28, s2, 256
    s_lshr_b32 s29, s28, 1
    s_xor_b32 s29, s29, s28
    s_and_b32 s29, s29, 8
    s_mul_i32 s29, s29, 3
    s_xor_b32 s28, s28, s29
    s_lshr_b32 s29, s28, 4
    s_bfe_u32 s30, s28, 0x20001
    s_lshl2_add_u32 s29, s29, s30
    s_and_b32 s30, s28, 1
    s_lshl_b32 s30, s30, 1
    s_bitcmp1_b32 s28, 3
    s_addc_u32 s30, s30, 0
    s_mov_b64 s[24:25], s[10:11]
    s_mov_b32 s26, 268435456
    s_mov_b32 s27, 0x20000
    s_cmp_ge_u32 s3, 6
    s_cbranch_scc1 M_agent
    s_cmp_ge_u32 s3, 6
    s_cbranch_scc1 L_fin
    s_cmp_eq_u32 s3, 1
    s_branch M_poller
M_agent:
    s_and_b32 s47, s28, 7
    s_lshl_b32 s47, s47, 8
    s_mov_b32 s49, 0
    s_mov_b32 s62, 0
M_ag:
    ds_read_b64 v[8:9], v7 offset:16
    s_waitcnt lgkmcnt(0)
    v_readfirstlane_b32 s48, v8
    v_readfirstlane_b32 s46, v9
    s_nop 0
    s_cmp_ge_u32 s46, 7
    s_cbranch_scc1 L_fin
    s_cmp_eq_u32 s48, s49
    s_cbranch_scc1 M_ag_n
    s_mov_b32 s49, s48
    s_and_b32 s34, s48, 2047
    s_lshl_b32 s34, s34, 11
    s_add_u32 s34, s34, s47
    s_load_dword s54, s[4:5], s34
    s_add_u32 s34, s34, 64
    s_load_dword s55, s[4:5], s34
    s_add_u32 s34, s34, 64
    s_load_dword s56, s[4:5], s34
    s_add_u32 s34, s34, 64
    s_load_dword s57, s[4:5], s34
    s_and_b32 s50, s48, 7
    s_bfe_u32 s34, s48, 0x40003
    s_lshl4_add_u32 s50, s50, s34
    s_bfe_u32 s34, s48, 0x40007
    s_lshl4_add_u32 s50, s50, s34
    s_lshl3_add_u32 s50, s50, 24576
    s_load_dwordx2 s[52:53], s[10:11], s50
M_ag_n:
    s_add_u32 s62, s62, 1
    s_cmp_lt_u32 s62, 1000000
    s_cbranch_scc1 M_ag
    s_branch L_fin
M_loader2:
    v_mov_b32 v7, 1152
    s_mov_b32 s26, 268435456
    s_mov_b32 s27, 0x20000
    v_xor_b32 v18, 128, v8
    s_lshr_b32 s29, s28, 4
    s_bfe_u32 s30, s28, 0x20001
    s_lshl2_add_u32 s29, s29, s30
    s_and_b32 s30, s28, 1
    s_lshl_b32 s30, s30, 1
    s_bitcmp1_b32 s28, 3
    s_addc_u32 s30, s30, 0
    s_mov_b64 s[24:25], s[10:11]
    s_mov_b32 s16, s40
    s_and_b32 s17, s41, 0xffff
    s_mov_b32 s18, 7340032
    s_mov_b32 s19, 0x20000
    s_mov_b32 s47, 3
    s_barrier
M_ld3:
    s_mov_b32 m0, s46
    s_add_u32 s46, s46, 1024
    buffer_load_dwordx4 v8, s[12:15], s45 offen nt lds
    s_add_u32 s45, s45, 28672
    s_waitcnt vmcnt(12)
    s_mov_b32 m0, s46
    s_add_u32 s46, s46, 1024
    buffer_load_dwordx4 v18, s[12:15], s45 offen nt lds
    s_add_u32 s45, s45, 28672
    s_waitcnt vmcnt(12)
    s_mov_b32 m0, s46
    s_add_u32 s46, s46, 1024
    buffer_load_dwordx4 v8, s[12:15], s45 offen nt lds
    s_add_u32 s45, s45, 28672
    s_waitcnt vmcnt(12)
    s_mov_b32 m0, s46
    s_add_u32 s46, s46, 1024
    buffer_load_dwordx4 v18, s[12:15], s45 offen nt lds
    s_add_u32 s45, s45, 28672
    s_waitcnt vmcnt(12)
    s_add_u32 s47, s47, 1
    s_getreg_b32 s35, hwreg(HW_REG_IB_STS)
    s_bfe_u32 s48, s35, 0x20016
    s_and_b32 s35, s35, 15
    s_lshl4_add_u32 s35, s48, s35
    s_add_u32 s35, s35, 3
    s_lshr_b32 s35, s35, 2
    s_sub_u32 s35, s47, s35
    v_mov_b32 v16, s35
    s_mov_b64 exec, 1
    ds_max_i32 v7, v16
    s_mov_b64 exec, -1
    s_cmp_lt_u32 s47, 5
    s_cbranch_scc1 M_ld3
M_ld5:
    s_mov_b32 m0, s46
    s_add_u32 s46, s46, 1024
    buffer_load_dwordx4 v8, s[12:15], s45 offen nt lds
    s_add_u32 s45, s45, 28672
    s_waitcnt vmcnt(28)
    s_mov_b32 m0, s46
    s_add_u32 s46, s46, 1024
    buffer_load_dwordx4 v18, s[12:15], s45 offen nt lds
    s_add_u32 s45, s45, 28672
    s_waitcnt vmcnt(28)
    s_mov_b32 m0, s46
    s_add_u32 s46, s46, 1024
    buffer_load_dwordx4 v8, s[12:15], s45 offen nt lds
    s_add_u32 s45, s45, 28672
    s_waitcnt vmcnt(28)
    s_mov_b32 m0, s46
    s_add_u32 s46, s46, 1024
    buffer_load_dwordx4 v18, s[12:15], s45 offen nt lds
    s_add_u32 s45, s45, 28672
    s_waitcnt vmcnt(28)
    s_add_u32 s47, s47, 1
    s_getreg_b32 s35, hwreg(HW_REG_IB_STS)
    s_bfe_u32 s48, s35, 0x20016
    s_and_b32 s35, s35, 15
    s_lshl4_add_u32 s35, s48, s35
    s_add_u32 s35, s35, 3
    s_lshr_b32 s35, s35, 2
    s_sub_u32 s35, s47, s35
    v_mov_b32 v16, s35
    s_mov_b64 exec, 1
    ds_max_i32 v7, v16
    s_mov_b64 exec, -1
    s_cmp_lt_u32 s47, 8
    s_cbranch_scc1 M_ld5
    s_mov_b32 s20, s42
    s_and_b32 s21, s43, 0xffff
    s_mov_b32 s22, 7340032
    s_mov_b32 s23, 0x20000
    v_lshrrev_b32 v9, 5, v2
    v_and_b32 v10, 31, v2
    v_add_u32 v11, 0, v9
    v_lshlrev_b32 v12, 1, v11
    v_xor_b32 v12, v12, v10
    v_lshlrev_b32 v12, 4, v12
    v_lshl_add_u32 v12, v11, 11, v12
    v_add_u32 v11, 2, v9
    v_lshlrev_b32 v13, 1, v11
    v_xor_b32 v13, v13, v10
    v_lshlrev_b32 v13, 4, v13
    v_lshl_add_u32 v13, v11, 11, v13
    v_add_u32 v11, 4, v9
    v_lshlrev_b32 v14, 1, v11
    v_xor_b32 v14, v14, v10
    v_lshlrev_b32 v14, 4, v14
    v_lshl_add_u32 v14, v11, 11, v14
    v_add_u32 v11, 6, v9
    v_lshlrev_b32 v15, 1, v11
    v_xor_b32 v15, v15, v10
    v_lshlrev_b32 v15, 4, v15
    v_lshl_add_u32 v15, v11, 11, v15
    s_lshl_b32 s44, s29, 17
    s_lshl_b32 s35, s30, 9
    s_add_u32 s44, s44, s35
    s_mov_b32 s46, 34048
    s_xor_b32 s45, s34, 512
M_ld8:
    s_mov_b32 m0, s46
    s_add_u32 s46, s46, 1024
    buffer_load_dwordx4 v8, s[16:19], s45 offen nt lds
    s_add_u32 s45, s45, 28672
    s_waitcnt vmcnt(28)
    s_mov_b32 m0, s46
    s_add_u32 s46, s46, 1024
    buffer_load_dwordx4 v18, s[16:19], s45 offen nt lds
    s_add_u32 s45, s45, 28672
    s_waitcnt vmcnt(28)
    s_mov_b32 m0, s46
    s_add_u32 s46, s46, 1024
    buffer_load_dwordx4 v8, s[16:19], s45 offen nt lds
    s_add_u32 s45, s45, 28672
    s_waitcnt vmcnt(28)
    s_mov_b32 m0, s46
    s_add_u32 s46, s46, 1024
    buffer_load_dwordx4 v18, s[16:19], s45 offen nt lds
    s_add_u32 s45, s45, 28672
    s_waitcnt vmcnt(28)
    s_add_u32 s47, s47, 1
    s_getreg_b32 s35, hwreg(HW_REG_IB_STS)
    s_bfe_u32 s48, s35, 0x20016
    s_and_b32 s35, s35, 15
    s_lshl4_add_u32 s35, s48, s35
    s_add_u32 s35, s35, 3
    s_lshr_b32 s35, s35, 2
    s_sub_u32 s35, s47, s35
    v_mov_b32 v16, s35
    s_mov_b64 exec, 1
    ds_max_i32 v7, v16
    s_mov_b64 exec, -1
    s_cmp_lt_u32 s47, 16
    s_cbranch_scc1 M_ld8
    v_mov_b32 v20, 1156
    s_mov_b32 s62, 0
M_wgc:
    ds_read_b32 v21, v20
    s_waitcnt lgkmcnt(0)
    v_cmp_gt_u32 vcc, 4, v21
    s_add_u32 s62, s62, 1
    s_cbranch_vccz M_wgc_d
    s_sleep 1
    s_cmp_lt_u32 s62, 1000000
    s_cbranch_scc1 M_wgc
M_wgc_d:
    s_mov_b32 s46, 1280
M_ld16:
    s_mov_b32 m0, s46
    s_add_u32 s46, s46, 1024
    buffer_load_dwordx4 v12, s[20:23], s44 offen nt lds
    s_waitcnt vmcnt(28)
    s_mov_b32 m0, s46
    s_add_u32 s46, s46, 1024
    buffer_load_dwordx4 v13, s[20:23], s44 offen nt lds
    s_waitcnt vmcnt(28)
    s_mov_b32 m0, s46
    s_add_u32 s46, s46, 1024
    buffer_load_dwordx4 v14, s[20:23], s44 offen nt lds
    s_waitcnt vmcnt(28)
    s_mov_b32 m0, s46
    s_add_u32 s46, s46, 1024
    buffer_load_dwordx4 v15, s[20:23], s44 offen nt lds
    s_waitcnt vmcnt(28)
    s_add_u32 s44, s44, 16384
    s_add_u32 s47, s47, 1
    s_getreg_b32 s35, hwreg(HW_REG_IB_STS)
    s_bfe_u32 s48, s35, 0x20016
    s_and_b32 s35, s35, 15
    s_lshl4_add_u32 s35, s48, s35
    s_add_u32 s35, s35, 3
    s_lshr_b32 s35, s35, 2
    s_sub_u32 s35, s47, s35
    v_mov_b32 v16, s35
    s_mov_b64 exec, 1
    ds_max_i32 v7, v16
    s_mov_b64 exec, -1
    s_cmp_lt_u32 s47, 22
    s_cbranch_scc1 M_ld16
    v_mov_b32 v20, 1176
    s_mov_b32 s62, 0
M_wgd:
    ds_read_b32 v21, v20
    s_waitcnt lgkmcnt(0)
    v_cmp_gt_u32 vcc, 7, v21
    s_add_u32 s62, s62, 1
    s_cbranch_vccz M_wgd_d
    s_sleep 1
    s_cmp_lt_u32 s62, 1000000
    s_cbranch_scc1 M_wgd
M_wgd_d:
M_ld22:
    s_mov_b32 m0, s46
    s_add_u32 s46, s46, 1024
    buffer_load_dwordx4 v12, s[20:23], s44 offen nt lds
    s_waitcnt vmcnt(28)
    s_mov_b32 m0, s46
    s_add_u32 s46, s46, 1024
    buffer_load_dwordx4 v13, s[20:23], s44 offen nt lds
    s_waitcnt vmcnt(28)
    s_mov_b32 m0, s46
    s_add_u32 s46, s46, 1024
    buffer_load_dwordx4 v14, s[20:23], s44 offen nt lds
    s_waitcnt vmcnt(28)
    s_mov_b32 m0, s46
    s_add_u32 s46, s46, 1024
    buffer_load_dwordx4 v15, s[20:23], s44 offen nt lds
    s_waitcnt vmcnt(28)
    s_add_u32 s44, s44, 16384
    s_add_u32 s47, s47, 1
    s_getreg_b32 s35, hwreg(HW_REG_IB_STS)
    s_bfe_u32 s48, s35, 0x20016
    s_and_b32 s35, s35, 15
    s_lshl4_add_u32 s35, s48, s35
    s_add_u32 s35, s35, 3
    s_lshr_b32 s35, s35, 2
    s_sub_u32 s35, s47, s35
    v_mov_b32 v16, s35
    s_mov_b64 exec, 1
    ds_max_i32 v7, v16
    s_mov_b64 exec, -1
    s_cmp_lt_u32 s47, 24
    s_cbranch_scc1 M_ld22
    s_mov_b64 exec, 1
    v_mov_b32 v16, 18
    s_waitcnt vmcnt(24)
    ds_max_i32 v7, v16
    v_mov_b32 v16, 19
    s_waitcnt vmcnt(20)
    ds_max_i32 v7, v16
    v_mov_b32 v16, 20
    s_waitcnt vmcnt(16)
    ds_max_i32 v7, v16
    v_mov_b32 v16, 21
    s_waitcnt vmcnt(12)
    ds_max_i32 v7, v16
    v_mov_b32 v16, 22
    s_waitcnt vmcnt(8)
    ds_max_i32 v7, v16
    v_mov_b32 v16, 23
    s_waitcnt vmcnt(4)
    ds_max_i32 v7, v16
    v_mov_b32 v16, 24
    s_waitcnt vmcnt(0)
    ds_write_b32 v7, v16
    s_waitcnt lgkmcnt(0)
    s_barrier
    s_branch L_fin
M_comp:
    s_mov_b32 s62, 0
M_box:
    ds_read_b64 v[8:9], v7 offset:16
    s_waitcnt lgkmcnt(0)
    v_cmp_gt_u32 vcc, 7, v9
    s_add_u32 s62, s62, 1
    s_cbranch_vccz M_box_d
    s_cmp_lt_u32 s62, 1000000
    s_cbranch_scc1 M_box
M_box_d:
    v_readfirstlane_b32 s48, v8
    s_nop 0
    s_and_b32 s34, s48, 2047
    s_lshl_b32 s34, s34, 11
    s_add_u32 s34, s34, s6
    s_load_dwordx16 s[64:79], s[4:5], s34
    s_and_b32 s50, s48, 7
    s_bfe_u32 s34, s48, 0x40003
    s_lshl4_add_u32 s50, s50, s34
    s_bfe_u32 s34, s48, 0x40007
    s_lshl4_add_u32 s50, s50, s34
    s_lshl3_add_u32 s50, s50, 24576
    s_load_dwordx2 s[52:53], s[10:11], s50
    s_mov_b32 s33, s16
    s_mov_b64 s[24:25], s[10:11]
    s_mov_b32 s26, 268435456
    s_mov_b32 s27, 0x20000
    s_mov_b32 s44, 262144
    s_mov_b32 s45, s7
    v_mov_b32 v8, 1
    s_waitcnt lgkmcnt(0)
    v_writelane_b32 v11, s64, 0
    v_writelane_b32 v11, s65, 1
    v_writelane_b32 v11, s66, 4
    v_writelane_b32 v11, s67, 5
    v_writelane_b32 v11, s68, 8
    v_writelane_b32 v11, s69, 9
    v_writelane_b32 v11, s70, 12
    v_writelane_b32 v11, s71, 13
    v_writelane_b32 v11, s72, 2
    v_writelane_b32 v11, s73, 3
    v_writelane_b32 v11, s74, 6
    v_writelane_b32 v11, s75, 7
    v_writelane_b32 v11, s76, 10
    v_writelane_b32 v11, s77, 11
    v_writelane_b32 v11, s78, 14
    v_writelane_b32 v11, s79, 15
    s_mov_b64 exec, 0xffff
    ds_write_b32 v113, v11 offset:0
    s_mov_b64 exec, 1
    ds_add_u32 v7, v8 offset:8
    s_mov_b64 exec, -1
    s_mov_b32 s62, 0
M_wx:
    ds_read_b128 v[8:11], v7
    s_waitcnt lgkmcnt(0)
    v_cmp_gt_u32 vcc, 4, v10
    s_add_u32 s62, s62, 1
    s_cbranch_vccz M_wx_d
    s_cmp_lt_u32 s62, 1000000
    s_cbranch_scc1 M_wx
M_wx_d:
    ds_read_b128 v[80:83], v15 offset:0
    ds_read_b128 v[84:87], v15 offset:64
    ds_read_b128 v[88:91], v15 offset:128
    ds_read_b128 v[92:95], v15 offset:192
    v_readfirstlane_b32 s56, v8
    s_nop 0
    s_cmp_ge_u32 s56, 10
    s_cbranch_scc1 M_wu0_k
    s_mov_b32 s62, 0
M_wu0:
    ds_read_b32 v8, v7
    s_waitcnt lgkmcnt(0)
    v_cmp_gt_u32 vcc, 10, v8
    s_add_u32 s62, s62, 1
    s_cbranch_vccz M_wu0_d
    s_sleep 1
    s_cmp_lt_u32 s62, 1000000
    s_cbranch_scc1 M_wu0
M_wu0_d:
    v_readfirstlane_b32 s56, v8
M_wu0_k:
    ds_read_b64_tr_b16 v[48:49], v12 offset:34048
    ds_read_b64_tr_b16 v[50:51], v12 offset:38144
    ds_read_b64_tr_b16 v[64:65], v126 offset:34048
    ds_read_b64_tr_b16 v[66:67], v126 offset:38144
    s_waitcnt lgkmcnt(4)
    v_mfma_f32_16x16x32_bf16 v[96:99], v[80:83], v[16:19], 0
    v_mfma_f32_16x16x32_bf16 v[104:107], v[80:83], v[32:35], 0
    v_mfma_f32_16x16x32_bf16 v[96:99], v[84:87], v[20:23], v[96:99]
    v_mfma_f32_16x16x32_bf16 v[104:107], v[84:87], v[36:39], v[104:107]
    v_mfma_f32_16x16x32_bf16 v[96:99], v[88:91], v[24:27], v[96:99]
    v_mfma_f32_16x16x32_bf16 v[104:107], v[88:91], v[40:43], v[104:107]
    v_mfma_f32_16x16x32_bf16 v[96:99], v[92:95], v[28:31], v[96:99]
    v_mfma_f32_16x16x32_bf16 v[104:107], v[92:95], v[44:47], v[104:107]
    s_mov_b32 s62, 0
M_sta:
    s_cmp_eq_u32 s53, s33
    s_cbranch_scc1 M_sta_d
    s_load_dwordx2 s[52:53], s[10:11], s50 glc
    s_add_u32 s62, s62, 1
    s_cmp_lt_u32 s62, 200000
    s_waitcnt lgkmcnt(0)
    s_cbranch_scc1 M_sta
M_sta_d:
    s_lshl_b32 s54, s52, 16
    s_and_b32 s52, s52, 0xffff0000
    v_mov_b32 v124, 0x3727c5ac
    v_add_f32 v124, s52, v124
    v_cvt_pk_bf16_f32 v124, v124, v124
    v_lshlrev_b32 v124, 16, v124
    v_sqrt_f32 v124, v124
    s_nop 0
    v_cvt_pk_bf16_f32 v124, v124, v124
    v_lshlrev_b32 v124, 16, v124
    v_rcp_f32 v124, v124
    s_cmp_ge_u32 s56, 12
    s_cbranch_scc1 M_wu1_k
    s_mov_b32 s62, 0
M_wu1:
    ds_read_b32 v8, v7
    s_waitcnt lgkmcnt(0)
    v_cmp_gt_u32 vcc, 12, v8
    s_add_u32 s62, s62, 1
    s_cbranch_vccz M_wu1_d
    s_sleep 1
    s_cmp_lt_u32 s62, 1000000
    s_cbranch_scc1 M_wu1
M_wu1_d:
    v_readfirstlane_b32 s56, v8
M_wu1_k:
    ds_read_b64_tr_b16 v[52:53], v12 offset:42240
    ds_read_b64_tr_b16 v[54:55], v12 offset:46336
    ds_read_b64_tr_b16 v[68:69], v126 offset:42240
    ds_read_b64_tr_b16 v[70:71], v126 offset:46336
    s_waitcnt lgkmcnt(4)
    v_mfma_f32_16x16x32_bf16 v[100:103], v[80:83], v[48:51], 0
    v_mfma_f32_16x16x32_bf16 v[108:111], v[80:83], v[64:67], 0
    s_cmp_ge_u32 s56, 14
    s_cbranch_scc1 M_wu2_k
    s_mov_b32 s62, 0
M_wu2:
    ds_read_b32 v8, v7
    s_waitcnt lgkmcnt(0)
    v_cmp_gt_u32 vcc, 14, v8
    s_add_u32 s62, s62, 1
    s_cbranch_vccz M_wu2_d
    s_sleep 1
    s_cmp_lt_u32 s62, 1000000
    s_cbranch_scc1 M_wu2
M_wu2_d:
    v_readfirstlane_b32 s56, v8
M_wu2_k:
    ds_read_b64_tr_b16 v[56:57], v12 offset:50432
    ds_read_b64_tr_b16 v[58:59], v12 offset:54528
    ds_read_b64_tr_b16 v[72:73], v126 offset:50432
    ds_read_b64_tr_b16 v[74:75], v126 offset:54528
    s_waitcnt lgkmcnt(4)
    v_mfma_f32_16x16x32_bf16 v[100:103], v[84:87], v[52:55], v[100:103]
    v_mfma_f32_16x16x32_bf16 v[108:111], v[84:87], v[68:71], v[108:111]
    s_cmp_ge_u32 s56, 16
    s_cbranch_scc1 M_wu3_k
    s_mov_b32 s62, 0
M_wu3:
    ds_read_b32 v8, v7
    s_waitcnt lgkmcnt(0)
    v_cmp_gt_u32 vcc, 16, v8
    s_add_u32 s62, s62, 1
    s_cbranch_vccz M_wu3_d
    s_cmp_lt_u32 s62, 1000000
    s_cbranch_scc1 M_wu3
M_wu3_d:
    v_readfirstlane_b32 s56, v8
M_wu3_k:
    ds_read_b64_tr_b16 v[60:61], v12 offset:58624
    ds_read_b64_tr_b16 v[62:63], v12 offset:62720
    ds_read_b64_tr_b16 v[76:77], v126 offset:58624
    ds_read_b64_tr_b16 v[78:79], v126 offset:62720
    s_waitcnt lgkmcnt(4)
    v_mfma_f32_16x16x32_bf16 v[100:103], v[88:91], v[56:59], v[100:103]
    v_mfma_f32_16x16x32_bf16 v[108:111], v[88:91], v[72:75], v[108:111]
    s_waitcnt lgkmcnt(2)
    v_mfma_f32_16x16x32_bf16 v[100:103], v[92:95], v[60:63], v[100:103]
    s_waitcnt lgkmcnt(0)
    v_mfma_f32_16x16x32_bf16 v[108:111], v[92:95], v[76:79], v[108:111]
    v_mov_b32 v9, 1
    v_mov_b32_dpp v96, v104 quad_perm:[0,1,2,3] row_mask:0x2 bank_mask:0xf
    v_mov_b32_dpp v97, v105 quad_perm:[0,1,2,3] row_mask:0x2 bank_mask:0xf
    s_nop 2
    v_mov_b32_dpp v96, v100 quad_perm:[0,1,2,3] row_mask:0x4 bank_mask:0xf
    v_mov_b32_dpp v97, v101 quad_perm:[0,1,2,3] row_mask:0x4 bank_mask:0xf
    s_nop 0
    v_mov_b32_dpp v96, v108 quad_perm:[0,1,2,3] row_mask:0x8 bank_mask:0xf
    v_mov_b32_dpp v97, v109 quad_perm:[0,1,2,3] row_mask:0x8 bank_mask:0xf
    v_fma_f32 v96, -v97, s54, v96
    v_mul_f32 v96, v96, v124
    buffer_store_dword v96, v114, s[24:27], s44 offen sc1
    s_mov_b64 exec, 1
    ds_add_u32 v7, v9 offset:12
    s_mov_b64 exec, -1
    v_mov_b32 v8, 1152
    s_mov_b32 s62, 0
M_wd0:
    ds_read_b32 v9, v8
    s_waitcnt lgkmcnt(0)
    v_cmp_gt_u32 vcc, 20, v9
    s_add_u32 s62, s62, 1
    s_cbranch_vccz M_wd0_d
    s_sleep 1
    s_cmp_lt_u32 s62, 1000000
    s_cbranch_scc1 M_wd0
M_wd0_d:
    ds_read_b64_tr_b16 v[16:17], v120 offset:1280
    ds_read_b64_tr_b16 v[18:19], v120 offset:9472
    ds_read_b64_tr_b16 v[24:25], v121 offset:1280
    ds_read_b64_tr_b16 v[26:27], v121 offset:9472
    ds_read_b64_tr_b16 v[32:33], v122 offset:1280
    ds_read_b64_tr_b16 v[34:35], v122 offset:9472
    ds_read_b64_tr_b16 v[40:41], v123 offset:1280
    ds_read_b64_tr_b16 v[42:43], v123 offset:9472
    v_mov_b32 v8, 1152
    s_mov_b32 s62, 0
M_wd1:
    ds_read_b32 v9, v8
    s_waitcnt lgkmcnt(0)
    v_cmp_gt_u32 vcc, 24, v9
    s_add_u32 s62, s62, 1
    s_cbranch_vccz M_wd1_d
    s_cmp_lt_u32 s62, 1000000
    s_cbranch_scc1 M_wd1
M_wd1_d:
    ds_read_b64_tr_b16 v[20:21], v120 offset:17664
    ds_read_b64_tr_b16 v[22:23], v120 offset:25856
    ds_read_b64_tr_b16 v[28:29], v121 offset:17664
    ds_read_b64_tr_b16 v[30:31], v121 offset:25856
    ds_read_b64_tr_b16 v[36:37], v122 offset:17664
    ds_read_b64_tr_b16 v[38:39], v122 offset:25856
    ds_read_b64_tr_b16 v[44:45], v123 offset:17664
    s_waitcnt lgkmcnt(4)
    ds_read_b64_tr_b16 v[46:47], v123 offset:25856
    v_lshlrev_b32 v8, 2, v2
    s_waitcnt lgkmcnt(0)
    s_barrier
    ds_read_b128 v[80:83], v14 offset:1024
    ds_read_b128 v[84:87], v14 offset:1088
    s_waitcnt lgkmcnt(1)
    v_mfma_f32_16x16x32_bf16 v[48:51], v[80:83], v[16:19], 0
    v_mfma_f32_16x16x32_bf16 v[52:55], v[80:83], v[24:27], 0
    v_mfma_f32_16x16x32_bf16 v[56:59], v[80:83], v[32:35], 0
    v_mfma_f32_16x16x32_bf16 v[60:63], v[80:83], v[40:43], 0
    s_waitcnt lgkmcnt(0)
    v_mfma_f32_16x16x32_bf16 v[48:51], v[84:87], v[20:23], v[48:51]
    v_mfma_f32_16x16x32_bf16 v[52:55], v[84:87], v[28:31], v[52:55]
    v_mfma_f32_16x16x32_bf16 v[56:59], v[84:87], v[36:39], v[56:59]
    v_mfma_f32_16x16x32_bf16 v[60:63], v[84:87], v[44:47], v[60:63]
    s_nop 5
    v_mov_b32_dpp v48, v52 quad_perm:[0,1,2,3] row_mask:0x2 bank_mask:0xf
    s_nop 1
    v_mov_b32_dpp v48, v56 quad_perm:[0,1,2,3] row_mask:0x4 bank_mask:0xf
    s_nop 1
    v_mov_b32_dpp v48, v60 quad_perm:[0,1,2,3] row_mask:0x8 bank_mask:0xf
    buffer_store_dword v48, v8, s[24:27], s45 offen sc1
    s_branch L_fin
M_poller:
    s_cmp_ge_u32 s28, 64
    s_cbranch_scc1 M_nores
    s_mov_b32 s62, 0
M_pbox:
    ds_read_b64 v[8:9], v7 offset:16
    s_waitcnt lgkmcnt(0)
    v_cmp_gt_u32 vcc, 7, v9
    s_add_u32 s62, s62, 1
    s_cbranch_vccz M_pbox_d
    s_cmp_lt_u32 s62, 1000000
    s_cbranch_scc1 M_pbox
M_pbox_d:
    v_readfirstlane_b32 s48, v8
    v_mov_b32 v9, s33
    v_mov_b32 v10, 0
    s_lshr_b32 s34, s28, 5
    s_add_u32 s34, s34, s28
    s_and_b32 s34, s34, 31
    s_lshl_b32 s34, s34, 7
    s_add_u32 s34, s34, 4096
    s_mov_b64 exec, 1
    buffer_store_dwordx2 v[8:9], v10, s[24:27], s34 offen sc1
    s_mov_b64 exec, -1
M_nores:
    v_lshlrev_b32 v9, 4, v2
    v_and_b32 v12, 8, v2
    v_lshl_add_u32 v12, v12, 2, v4
    v_and_b32 v11, 3, v2
    v_lshl_add_u32 v12, v11, 3, v12
    v_and_b32 v11, 4, v2
    v_add_lshl_u32 v12, v12, v11, 1
    s_lshl_b32 s44, s29, 12
    s_add_u32 s44, s44, 262144
    s_lshl2_add_u32 s46, s29, s30
    s_lshl_b32 s46, s46, 7
    s_add_u32 s46, s46, 720896
    s_lshl_b32 s47, s33, 4
    s_lshr_b32 s35, s28, 3
    s_cmp_ge_u32 s35, 14
    s_cselect_b32 s34, 18, 0
    s_add_u32 s35, s35, s34
    s_and_b32 s34, s28, 7
    s_lshl_b32 s34, s34, 8
    s_add_u32 s34, s34, s35
    s_lshl2_add_u32 s55, s34, 753664
    v_lshlrev_b32 v40, 8, v2
    v_mov_b32 v41, s33
    s_and_b32 s34, s28, 0xe8
    s_lshl_b32 s34, s34, 5
    s_bfe_u32 s35, s28, 0x10004
    s_lshl3_add_u32 s34, s35, s34
    s_and_b32 s35, s28, 7
    s_add_u32 s34, s34, s35
    s_lshl2_add_u32 s54, s34, 720896
    v_and_b32 v42, 8, v2
    v_add_lshl_u32 v42, v42, v2, 7
    v_mov_b32 v14, 1172
    s_mov_b32 s62, 0
M_pu:
    ds_read_b32 v15, v14
    s_waitcnt lgkmcnt(0)
    v_cmp_gt_u32 vcc, 7, v15
    s_add_u32 s62, s62, 1
    s_cbranch_vccz M_pu_d
    s_sleep 1
    s_cmp_lt_u32 s62, 1000000
    s_cbranch_scc1 M_pu
M_pu_d:
    v_mov_b32 v14, 1152
    s_mov_b32 s62, 0
M_pv:
    ds_read_b32 v15, v14
    s_waitcnt lgkmcnt(0)
    v_cmp_gt_u32 vcc, 14, v15
    s_add_u32 s62, s62, 1
    s_cbranch_vccz M_pv_d
    s_sleep 1
    s_cmp_lt_u32 s62, 1000000
    s_cbranch_scc1 M_pv
M_pv_d:
    s_mov_b64 exec, 0xffff
    buffer_store_dword v41, v42, s[24:27], s54 offen sc1
    s_mov_b64 exec, -1
    s_mov_b32 s62, 0
M_hint:
    s_load_dwordx16 s[64:79], s[10:11], s46 glc
    s_waitcnt lgkmcnt(0)
    s_add_u32 s64, s64, s65
    s_add_u32 s64, s64, s66
    s_add_u32 s64, s64, s67
    s_add_u32 s64, s64, s68
    s_add_u32 s64, s64, s69
    s_add_u32 s64, s64, s70
    s_add_u32 s64, s64, s71
    s_add_u32 s64, s64, s72
    s_add_u32 s64, s64, s73
    s_add_u32 s64, s64, s74
    s_add_u32 s64, s64, s75
    s_add_u32 s64, s64, s76
    s_add_u32 s64, s64, s77
    s_add_u32 s64, s64, s78
    s_add_u32 s64, s64, s79
    s_cmp_eq_u32 s64, s47
    s_cbranch_scc1 M_hint_d
    s_add_u32 s62, s62, 1
    s_cmp_lt_u32 s62, 200000
    s_cbranch_scc1 M_hint
M_hint_d:
    buffer_load_dwordx4 v[16:19], v9, s[24:27], s44 offen offset:0 sc1
    buffer_load_dwordx4 v[20:23], v9, s[24:27], s44 offen offset:1024 sc1
    buffer_load_dwordx4 v[24:27], v9, s[24:27], s44 offen offset:2048 sc1
    buffer_load_dwordx4 v[28:31], v9, s[24:27], s44 offen offset:3072 sc1
    v_mov_b32 v14, 1152
    s_mov_b32 s62, 0
M_pw:
    ds_read_b32 v15, v14
    s_waitcnt lgkmcnt(0)
    v_cmp_gt_u32 vcc, 20, v15
    s_add_u32 s62, s62, 1
    s_cbranch_vccz M_pw_d
    s_cmp_lt_u32 s62, 1000000
    s_cbranch_scc1 M_pw
M_pw_d:
    s_mov_b64 exec, 0xf
    buffer_store_dword v41, v40, s[24:27], s55 offen sc1
    s_mov_b64 exec, -1
    s_mov_b32 s62, 0
    s_waitcnt vmcnt(1)
    s_branch M_ph_c
    s_mov_b32 s62, 0
M_ph:
    buffer_load_dwordx4 v[16:19], v9, s[24:27], s44 offen offset:0 sc1
    buffer_load_dwordx4 v[20:23], v9, s[24:27], s44 offen offset:1024 sc1
    buffer_load_dwordx4 v[24:27], v9, s[24:27], s44 offen offset:2048 sc1
    buffer_load_dwordx4 v[28:31], v9, s[24:27], s44 offen offset:3072 sc1
    s_waitcnt vmcnt(0)
M_ph_c:
    v_pk_add_f32 v[32:33], v[16:17], v[20:21]
    v_pk_add_f32 v[34:35], v[18:19], v[22:23]
    v_pk_add_f32 v[36:37], v[24:25], v[28:29]
    v_pk_add_f32 v[38:39], v[26:27], v[30:31]
    v_permlane16_swap_b32 v32, v33
    v_permlane16_swap_b32 v34, v35
    v_permlane16_swap_b32 v36, v37
    v_permlane16_swap_b32 v38, v39
    v_add_f32 v32, v32, v33
    v_add_f32 v34, v34, v35
    v_add_f32 v36, v36, v37
    v_add_f32 v38, v38, v39
    v_permlane32_swap_b32 v32, v34
    s_nop 0
    v_permlane32_swap_b32 v36, v38
    v_add_f32 v32, v32, v34
    v_add_f32 v36, v36, v38
    v_cmp_u_f32 vcc, v32, v36
    v_mul_f32 v33, 0xbfb8aa3b, v32
    s_cbranch_vccz M_ph_d
    v_max_u32 v34, v16, v17
    v_max3_u32 v34, v34, v18, v19
    v_max3_u32 v34, v34, v20, v21
    v_max3_u32 v34, v34, v22, v23
    v_max3_u32 v34, v34, v24, v25
    v_max3_u32 v34, v34, v26, v27
    v_max3_u32 v34, v34, v28, v29
    v_max3_u32 v34, v34, v30, v31
    v_cmp_eq_u32 vcc, -1, v34
    s_add_u32 s62, s62, 1
    s_cbranch_vccz M_ph_d
    s_cmp_lt_u32 s62, 200000
    s_cbranch_scc1 M_ph
M_ph_d:
    v_exp_f32 v33, v33
    v_mul_f32 v16, v32, v36
    v_add_f32 v33, 1.0, v33
    v_rcp_f32 v33, v33
    s_nop 0
    v_mul_f32 v16, v16, v33
    v_cvt_pk_bf16_f32 v16, v16, v16
    ds_write_b16 v12, v16 offset:1024
    s_waitcnt lgkmcnt(0)
    s_barrier
L_fin:
L_end:
    s_endpgm
.section .rodata,"a"
.p2align 6
.amdhsa_kernel recurrent_scan__spectral_fnet__moe_arch_mod__prompt_kernel
  .amdhsa_next_free_vgpr 128
  .amdhsa_next_free_sgpr 102
  .amdhsa_accum_offset 128
  .amdhsa_group_segment_fixed_size 0
  .amdhsa_kernarg_size 104
  .amdhsa_user_sgpr_count 2
  .amdhsa_user_sgpr_kernarg_segment_ptr 1
  .amdhsa_system_sgpr_workgroup_id_x 1
.end_amdhsa_kernel
```

```asm
; @launch grid=(480,1,1) block=(512,1,1) lds=67072
.amdgcn_target "amdgcn-amd-amdhsa--gfx950"
.text
.globl recurrent_scan__spectral_fnet__moe_arch_mod__prompt_kernel
.p2align 8
.type recurrent_scan__spectral_fnet__moe_arch_mod__prompt_kernel,@function
recurrent_scan__spectral_fnet__moe_arch_mod__prompt_kernel:
    s_cmp_ge_u32 s2, 480
    s_cbranch_scc1 L_end
    s_load_dwordx2 s[4:5], s[0:1], 0
    s_load_dwordx2 s[10:11], s[0:1], 96
    s_load_dwordx8 s[36:43], s[0:1], 48
    s_load_dwordx2 s[8:9], s[0:1], 80
    v_lshrrev_b32 v1, 6, v0
    v_and_b32 v2, 63, v0
    v_readfirstlane_b32 s3, v1
    v_and_b32 v3, 15, v0
    v_lshrrev_b32 v4, 4, v2
    s_cmp_ge_u32 s2, 256
    s_cbranch_scc1 M_first
    s_cmp_lg_u32 s3, 0
    s_cbranch_scc1 L_nopf
    s_getpc_b64 s[6:7]
L_pc:
    s_mov_b32 m0, 66816
    s_bfe_u32 s34, s2, 0x20003
    s_lshl_b32 s34, s34, 12
    v_lshl_add_u32 v8, v0, 7, s34
    v_min_u32 v8, L_end-L_pc, v8
    s_mov_b32 exec_hi, 0
    global_load_lds_dword v8, s[6:7]
    s_mov_b32 exec_hi, -1
L_nopf:
    s_and_b32 s28, s2, 7
    s_bfe_u32 s44, s2, 0x10003
    s_lshr_b32 s45, s2, 4
    s_xor_b32 s30, s45, 15
    s_lshl3_add_u32 s30, s30, s28
    s_cmp_eq_u32 s30, 0
    s_cselect_b32 s46, 1, 0
    s_cmp_eq_u32 s2, 248
    s_cselect_b32 s30, 128, s30
    s_lshl_b32 s31, s3, 8
    s_add_u32 s31, s31, s30
    s_sub_u32 s32, 0, s31
    s_and_b32 s32, s32, 2047
    s_cmp_eq_u32 s44, 0
    s_cselect_b32 s47, s31, s32
    s_cselect_b32 s48, s32, s31
    s_lshl_b32 s49, s47, 11
    s_lshl_b32 s48, s48, 11
    v_lshrrev_b32 v5, 3, v2
    v_and_b32 v5, 2, v5
    v_xor_b32 v5, v5, v2
    v_lshlrev_b32 v5, 4, v5
    s_lshl_b32 s53, s3, 12
    s_lshl_b32 s14, 1, 22
    s_mov_b32 s15, 0x20000
    s_movk_i32 s18, 2048
    s_mov_b32 s19, s15
    s_mov_b32 m0, 41216
    s_cmp_lg_u32 s3, 0
    s_waitcnt lgkmcnt(0)
    s_mov_b64 s[12:13], s[4:5]
    s_load_dword s33, s[10:11], 0
    s_cbranch_scc1 F_nowr
    s_mov_b64 s[16:17], s[36:37]
    buffer_load_dwordx4 v5, s[16:19], 0 offen lds
    buffer_load_dwordx4 v5, s[16:19], 0 offen offset:1024 lds
F_nowr:
    s_mov_b32 m0, s53
    s_mov_b64 s[24:25], s[10:11]
    buffer_load_dwordx4 v5, s[12:15], s49 offen lds
    buffer_load_dwordx4 v5, s[12:15], s49 offen offset:1024 lds
    s_branch F_go
M_first:
    s_cmp_lg_u32 s3, 0
    s_cbranch_scc1 M_entry
    s_setprio 3
    s_lshr_b32 s29, s2, 1
    s_xor_b32 s29, s29, s2
    s_and_b32 s29, s29, 8
    s_mul_i32 s29, s29, 3
    s_xor_b32 s28, s2, s29
    s_bitset0_b32 s28, 8
    v_mul_u32_u24 v8, 7168, v4
    v_lshlrev_b32 v9, 1, v4
    v_xor_b32 v9, v9, v3
    v_lshl_add_u32 v8, v9, 4, v8
    s_and_b32 s34, s28, 7
    s_mulk_i32 s34, 3584
    s_lshr_b32 s35, s28, 3
    s_add_u32 s34, s34, s35
    s_lshl_b32 s34, s34, 8
    s_mov_b32 s14, 7340032
    s_mov_b32 s15, 0x20000
    s_movk_i32 s46, 1280
    s_mov_b32 s45, s34
    s_waitcnt lgkmcnt(0)
    s_mov_b64 s[12:13], s[38:39]
M_burst:
    s_mov_b32 m0, s46
    s_addk_i32 s46, 1024
    buffer_load_dwordx4 v8, s[12:15], s45 offen nt lds
    s_addk_i32 s45, 28672
    v_xor_b32 v8, 128, v8
    s_cmpk_lt_u32 s46, 13568
    s_cbranch_scc1 M_burst
    s_branch M_loader2
F_go:
    s_mov_b32 s26, 268435456
    s_mov_b32 s27, 0x20000
    v_lshlrev_b32 v7, 2, v0
    s_lshl_b32 s34, s2, 11
    s_add_u32 s34, s34, 262144
    v_mov_b32 v6, -1
    buffer_store_dword v6, v7, s[24:27], s34 offen sc1
    v_lshlrev_b32 v126, 4, v2
    s_and_b32 s34, s3, 1
    s_lshr_b32 s35, s3, 1
    v_lshl_add_u32 v119, s34, 3, v126
    s_cmp_eq_u32 s35, 3
    s_cbranch_scc1 F_jobr8
    s_lshl4_add_u32 s54, s44, 1
    s_cmp_eq_u32 s35, 2
    s_cselect_b32 s54, 0, s54
    s_cselect_b32 s57, 4096, 0
    s_cmp_eq_u32 s35, 1
    s_cselect_b32 s55, 0x3a800000, 0
    s_cselect_b32 s58, s46, 0
    s_cselect_b32 s57, 7168, s57
    s_cselect_b32 s55, s55, 0x3d000000
    s_lshl_b32 s34, s34, 4
    v_lshl_add_u32 v109, v4, 2, s34
    v_cvt_f32_u32 v109, v109
    v_add_u32 v119, s57, v119
F_job:
    v_add_u32 v116, s54, v3
    v_cvt_f32_u32 v116, v116
    v_mul_f32 v116, s55, v116
    v_mul_f32 v117, v116, v109
    v_cos_f32 v76, v117
    v_sin_f32 v80, v117
    v_add_f32 v117, v117, v116
    v_cos_f32 v77, v117
    v_sin_f32 v81, v117
    v_add_f32 v117, v117, v116
    v_cos_f32 v78, v117
    v_sin_f32 v82, v117
    v_add_f32 v117, v117, v116
    v_cos_f32 v79, v117
    v_sin_f32 v83, v117
    s_cmp_eq_u32 s35, 0
    s_cbranch_scc1 F_jobf1
    v_cvt_pk_f16_f32 v84, v76, v77
    v_cvt_pk_f16_f32 v85, v78, v79
    v_cvt_pk_f16_f32 v86, v80, v81
    v_cvt_pk_f16_f32 v87, v82, v83
    v_xor_b32 v88, 0x80008000, v86
    v_xor_b32 v89, 0x80008000, v87
    ds_write2st64_b64 v119, v[84:85], v[86:87] offset0:85 offset1:87
    ds_write_b64 v119, v[88:89] offset:45568
    s_cmp_eq_u32 s58, 0
    s_cbranch_scc1 F_jobd
    s_mov_b32 s58, 0
    s_xor_b32 s54, s54, 16
    v_add_u32 v119, 3072, v119
    s_branch F_job
F_jobf1:
    v_cvt_pk_bf16_f32 v84, v76, v77
    v_cvt_pk_bf16_f32 v85, v78, v79
    v_cvt_pk_bf16_f32 v86, -v80, -v81
    v_cvt_pk_bf16_f32 v87, -v82, -v83
    ds_write2st64_b64 v119, v[84:85], v[86:87] offset0:85 offset1:87
    s_branch F_jobd
F_jobr8:
    v_and_b32 v118, 7, v3
    v_cvt_f32_u32 v118, v118
    v_mul_f32 v118, 0x3e000000, v118
    v_and_b32 v117, 1, v4
    v_lshl_add_u32 v117, v117, 1, s34
    v_cvt_f32_u32 v117, v117
    v_mul_f32 v117, v117, v118
    v_add_f32 v117, v117, v117
    v_add_f32 v118, v117, v118
    v_cos_f32 v76, v117
    v_sin_f32 v77, v117
    v_cos_f32 v78, v118
    v_sin_f32 v79, v118
    v_lshrrev_b32 v116, 2, v2
    v_xor_b32 v116, v116, v2
    v_bfe_u32 v116, v116, 3, 1
    v_add_u32 v116, -1, v116
    s_lshl_b32 s34, s44, 31
    v_cvt_pk_f16_f32 v84, v76, v77
    v_cvt_pk_f16_f32 v86, -v77, v76
    v_cvt_pk_f16_f32 v85, v78, v79
    v_cvt_pk_f16_f32 v87, -v79, v78
    v_bitop3_b32 v84, v84, s34, v116 bitop3:0x28
    v_bitop3_b32 v85, v85, s34, v116 bitop3:0x28
    v_bitop3_b32 v86, v86, s34, v116 bitop3:0x28
    v_bitop3_b32 v87, v87, s34, v116 bitop3:0x28
    ds_write2st64_b64 v119, v[84:85], v[86:87] offset0:89 offset1:91
F_jobd:
    s_and_b32 s51, s47, 7
    v_mov_b32 v108, 0
    s_bfe_u32 s34, s47, 0x40003
    v_mov_b32 v109, 0
    s_lshl4_add_u32 s51, s51, s34
    v_mov_b32 v110, 0
    s_lshr_b32 s34, s47, 7
    v_mov_b32 v111, 0
    s_lshl4_add_u32 s51, s51, s34
    v_mov_b32 v7, 56832
    s_lshl3_add_u32 s51, s51, 24576
    ds_write_b128 v7, v[108:111]
    s_lshl_b32 s52, s46, 23
    v_and_b32 v96, 60, v2
    s_sub_u32 s52, 0x3e000000, s52
    v_and_b32 v97, 3, v2
    s_mov_b32 s60, 0x80000000
    v_lshl_add_u32 v96, v96, 1, v97
    s_mov_b32 s61, 0xfffff800
    v_bfe_u32 v97, v2, 4, 1
    s_mov_b32 s71, 0
    v_lshl_add_u32 v96, v97, 2, v96
    v_lshlrev_b32 v96, 3, v96
    v_xor_b32 v97, 32, v96
    v_add_u32 v92, s53, v96
    v_xor_b32 v93, 32, v92
    v_mov_b32 v68, 0x3f803f80
    v_mov_b32 v69, 0x3f803f80
    v_mov_b32 v70, 0x3f803f80
    v_mov_b32 v71, 0x3f803f80
    v_mov_b32 v125, s47
    v_mov_b32 v118, 1
    v_mov_b32 v119, 0
    s_waitcnt vmcnt(3) lgkmcnt(0)
    s_barrier
    ds_read_b64_tr_b16 v[24:25], v96 offset:41216
    ds_read_b64_tr_b16 v[26:27], v96 offset:42240
    ds_read_b64_tr_b16 v[28:29], v97 offset:41216
    ds_read_b64_tr_b16 v[30:31], v97 offset:42240
    ds_read_b128 v[32:35], v126 offset:43520
    ds_read_b128 v[36:39], v126 offset:44544
    ds_read_b128 v[40:43], v126 offset:45568
    ds_read_b128 v[44:47], v126 offset:46592
    ds_read_b128 v[48:51], v126 offset:47616
    ds_read_b128 v[52:55], v126 offset:48640
    ds_read_b128 v[56:59], v126 offset:49664
    ds_read_b128 v[60:63], v126 offset:50688
    ds_read_b128 v[64:67], v126 offset:51712
    s_mul_i32 s33, s33, 0x9e3779b1
    s_add_u32 s33, s33, 0x7f4a7c15
    s_mov_b32 s63, 0x3a800000
    v_mov_b32 v117, s33
    s_waitcnt lgkmcnt(9)
    v_mfma_f32_16x16x32_bf16 v[100:103], v[68:71], v[24:27], 0
    v_mfma_f32_16x16x32_bf16 v[100:103], v[68:71], v[28:31], v[100:103]
    s_nop 7
    v_add_f32_dpp v100, v100, v100 row_ror:8 row_mask:0xf bank_mask:0xf
    s_nop 1
    v_add_f32_dpp v100, v100, v100 row_ror:4 row_mask:0xf bank_mask:0xf
    s_nop 1
    v_add_f32_dpp v100, v100, v100 row_ror:2 row_mask:0xf bank_mask:0xf
    s_nop 1
    v_add_f32_dpp v100, v100, v100 row_ror:1 row_mask:0xf bank_mask:0xf
    s_waitcnt vmcnt(1) lgkmcnt(0)
    s_add_u32 m0, s53, 2048
    s_nop 0
    buffer_load_dwordx4 v5, s[12:15], s48 offen lds
    buffer_load_dwordx4 v5, s[12:15], s48 offen offset:1024 lds
    ds_read_b64_tr_b16 v[8:9], v92 offset:0
    ds_read_b64_tr_b16 v[10:11], v92 offset:1024
    ds_read_b64_tr_b16 v[12:13], v93 offset:0
    ds_read_b64_tr_b16 v[14:15], v93 offset:1024
    s_waitcnt lgkmcnt(2)
    v_mfma_f32_16x16x32_bf16 v[104:107], v[68:71], v[8:11], 0
    v_dot2_f32_bf16 v110, v8, v24, v110
    v_dot2_f32_bf16 v108, v8, v8, v108
    v_dot2_f32_bf16 v110, v9, v25, v110
    v_dot2_f32_bf16 v108, v9, v9, v108
    v_dot2_f32_bf16 v110, v10, v26, v110
    v_dot2_f32_bf16 v108, v10, v10, v108
    v_dot2_f32_bf16 v110, v11, v27, v110
    v_dot2_f32_bf16 v108, v11, v11, v108
    s_waitcnt lgkmcnt(0)
    v_mfma_f32_16x16x32_bf16 v[104:107], v[68:71], v[12:15], v[104:107]
    v_dot2_f32_bf16 v110, v12, v28, v110
    v_dot2_f32_bf16 v108, v12, v12, v108
    v_dot2_f32_bf16 v110, v13, v29, v110
    v_dot2_f32_bf16 v108, v13, v13, v108
    v_dot2_f32_bf16 v110, v14, v30, v110
    v_dot2_f32_bf16 v108, v14, v14, v108
    v_dot2_f32_bf16 v110, v15, v31, v110
    v_dot2_f32_bf16 v108, v15, v15, v108
    v_add_f32_dpp v104, v104, v104 row_ror:8 row_mask:0xf bank_mask:0xf
    s_nop 1
    v_permlane32_swap_b32 v108, v110
    v_add_f32_dpp v104, v104, v104 row_ror:4 row_mask:0xf bank_mask:0xf
    v_add_f32 v108, v108, v110
    s_nop 0
    v_add_f32_dpp v104, v104, v104 row_ror:2 row_mask:0xf bank_mask:0xf
    v_add_f32_dpp v108, v108, v108 row_ror:8 row_mask:0xf bank_mask:0xf
    s_nop 0
    v_add_f32_dpp v104, v104, v104 row_ror:1 row_mask:0xf bank_mask:0xf
    v_add_f32_dpp v108, v108, v108 row_ror:4 row_mask:0xf bank_mask:0xf
    v_mul_f32 v112, 0x3a800000, v104
    s_nop 0
    v_add_f32_dpp v108, v108, v108 row_ror:2 row_mask:0xf bank_mask:0xf
    v_mul_f32 v113, -v112, v112
    s_nop 0
    v_add_f32_dpp v108, v108, v108 row_ror:1 row_mask:0xf bank_mask:0xf
    v_mul_f32 v110, v112, v100
    s_nop 0
    v_add_f32_dpp v108, v108, v108 row_bcast:15 row_mask:0xa bank_mask:0xf
    s_nop 0
    v_readlane_b32 s34, v108, 48
    v_fmamk_f32 v108, v108, 0x3a800000, v113
    v_max_f32 v108, 0, v108
    v_add_f32 v111, 0x3727c5ac, v108
    v_rsq_f32 v111, v111
    v_sub_f32 v110, s34, v110
    v_mul_f32 v110, v110, v111
    v_ashrrev_i32 v115, 31, v110
    v_bitop3_b32 v115, v110, v115, s60 bitop3:0x1e
    v_and_or_b32 v115, v115, s61, v125
    s_mov_b64 exec, 0x10000
    s_waitcnt vmcnt(2)
    ds_max_u32 v7, v115
    ds_add_rtn_u32 v118, v7, v118 offset:8
    v_cvt_pk_bf16_f32 v116, v112, v108
    buffer_store_dwordx2 v[116:117], v119, s[24:27], s51 offen sc1
    s_mov_b64 exec, -1
    ds_read_b32 v114, v7
    v_mul_f32 v111, s52, v111
    v_mul_f32 v113, v112, v111
    v_readlane_b32 s54, v111, 16
    v_readlane_b32 s70, v113, 16
    v_mfma_f32_16x16x32_bf16 v[76:79], v[8:11], v[32:35], 0
    v_mfma_f32_16x16x32_bf16 v[80:83], v[12:15], v[32:35], 0
    v_mfma_f32_16x16x32_bf16 v[84:87], v[8:11], v[36:39], 0
    v_mfma_f32_16x16x32_bf16 v[88:91], v[12:15], v[36:39], 0
    s_waitcnt lgkmcnt(0)
    v_readlane_b32 s34, v118, 16
    s_nop 0
    s_cmp_lg_u32 s34, 7
    s_cbranch_scc0 F_key
F_nokey:
    s_lshr_b32 s58, s3, 2
    v_xor_b32 v94, 0x3d8, v92
    s_lshl4_add_u32 s58, s3, s58
    v_xor_b32 v95, 0x3f8, v92
    s_lshl_b32 s58, s58, 6
    v_and_b32 v72, 0x3d8, v96
    s_and_b32 s59, s3, 3
    v_sub_u32 v72, 1024, v72
    s_lshl3_add_u32 s59, s3, s59
    v_add_u32 v73, -32, v72
    s_lshl_b32 s59, s59, 2
    v_lshrrev_b32 v74, 3, v72
    s_and_b32 s34, s30, 15
    v_lshrrev_b32 v75, 3, v73
    s_sub_u32 s35, 16, s34
    v_bitop3_b32 v72, v72, v74, 32 bitop3:0x78
    s_and_b32 s50, s34, 7
    v_bitop3_b32 v73, v73, v75, 32 bitop3:0x78
    s_cmp_gt_u32 s34, 8
    v_add_u32 v72, s53, v72
    s_cselect_b32 s50, s35, s50
    v_add_u32 v73, s53, v73
    s_and_b32 s34, s34, 8
    v_xor_b32 v74, 1024, v72
    s_lshl4_add_u32 s50, s50, s34
    v_bfe_u32 v120, v3, 1, 2
    s_lshr_b32 s34, s30, 4
    v_xor_b32 v120, v120, v4
    s_add_u32 s50, s50, s34
    v_lshl_add_u32 v120, v3, 2, v120
    s_cmp_eq_u32 s30, 128
    v_lshl_add_u32 v120, v120, 4, s58
    s_cselect_b32 s50, 128, s50
    v_xor_b32 v121, s59, v3
    s_lshl1_add_u32 s29, s50, s44
    v_lshrrev_b32 v16, 1, v4
    s_mul_i32 s50, s29, 8320
    v_lshl_add_u32 v121, v16, 4, v121
    s_lshl_b32 s34, s3, 10
    v_and_b32 v16, 1, v4
    s_add_u32 s50, s50, s34
    v_mul_u32_u24 v16, 1040, v16
    s_add_u32 s50, s50, 1048576
    v_add_lshl_u32 v121, v121, v16, 2
    s_and_b32 s29, s29, 255
    v_and_b32 v17, 7, v3
    s_lshl2_add_u32 s29, s29, 40960
    v_lshrrev_b32 v16, 3, v3
    s_cmp_eq_u32 s44, 0
    v_mul_u32_u24 v122, 128, v17
    s_cselect_b32 s35, 0, 0xc2000000
    v_lshl_add_u32 v122, v16, 6, v122
    v_lshl_add_u32 v122, v4, 4, v122
    v_add_u32 v124, 1, v3
    v_bfe_i32 v124, v124, 4, 1
    v_and_b32 v124, s35, v124
    s_cmp_lg_u32 s71, 0
    s_cbranch_scc1 F_wkey
    s_waitcnt vmcnt(1)
F_wkey_r:
    ds_read_b64_tr_b16 v[24:25], v94 offset:3072
    ds_read_b64_tr_b16 v[26:27], v94 offset:2048
    ds_read_b64_tr_b16 v[28:29], v95 offset:3072
    ds_read_b64_tr_b16 v[30:31], v95 offset:2048
    ds_read_b64_tr_b16 v[16:17], v74 offset:2048
    ds_read_b64_tr_b16 v[18:19], v72 offset:2048
    ds_read_b64_tr_b16 v[20:21], v73 offset:3072
    ds_read_b64_tr_b16 v[22:23], v73 offset:2048
    s_waitcnt lgkmcnt(6)
    v_mfma_f32_16x16x32_bf16 v[104:107], v[68:71], v[24:27], 0
    v_dot2_f32_bf16 v109, v24, v24, v109
    v_dot2_f32_bf16 v109, v25, v25, v109
    v_dot2_f32_bf16 v109, v26, v26, v109
    v_dot2_f32_bf16 v109, v27, v27, v109
    s_waitcnt lgkmcnt(4)
    v_mfma_f32_16x16x32_bf16 v[104:107], v[68:71], v[28:31], v[104:107]
    v_dot2_f32_bf16 v109, v28, v28, v109
    v_dot2_f32_bf16 v109, v29, v29, v109
    v_dot2_f32_bf16 v109, v30, v30, v109
    v_dot2_f32_bf16 v109, v31, v31, v109
    s_mov_b32 exec_lo, 0xeeeeeeee
    s_mov_b32 exec_hi, 0xeeeeeeee
    s_waitcnt lgkmcnt(0)
    v_mov_b32_dpp v16, v24 quad_perm:[0,3,2,1] row_mask:0xf bank_mask:0xf
    v_mov_b32_dpp v17, v25 quad_perm:[0,3,2,1] row_mask:0xf bank_mask:0xf
    v_mov_b32_dpp v18, v26 quad_perm:[0,3,2,1] row_mask:0xf bank_mask:0xf
    v_mov_b32_dpp v19, v27 quad_perm:[0,3,2,1] row_mask:0xf bank_mask:0xf
    v_mov_b32_dpp v20, v28 quad_perm:[0,3,2,1] row_mask:0xf bank_mask:0xf
    v_mov_b32_dpp v21, v29 quad_perm:[0,3,2,1] row_mask:0xf bank_mask:0xf
    v_mov_b32_dpp v22, v30 quad_perm:[0,3,2,1] row_mask:0xf bank_mask:0xf
    v_mov_b32_dpp v23, v31 quad_perm:[0,3,2,1] row_mask:0xf bank_mask:0xf
    s_mov_b64 exec, -1
    v_add_f32_dpp v112, v104, v104 row_ror:8 row_mask:0xf bank_mask:0xf
    v_add_f32_dpp v109, v109, v109 row_ror:8 row_mask:0xf bank_mask:0xf
    v_mfma_f32_16x16x32_bf16 v[92:95], v[16:19], v[32:35], 0
    v_add_f32_dpp v112, v112, v112 row_ror:4 row_mask:0xf bank_mask:0xf
    v_add_f32_dpp v109, v109, v109 row_ror:4 row_mask:0xf bank_mask:0xf
    v_mfma_f32_16x16x32_bf16 v[96:99], v[20:23], v[32:35], 0
    v_add_f32_dpp v112, v112, v112 row_ror:2 row_mask:0xf bank_mask:0xf
    v_add_f32_dpp v109, v109, v109 row_ror:2 row_mask:0xf bank_mask:0xf
    v_mfma_f32_16x16x32_bf16 v[100:103], v[16:19], v[36:39], 0
    v_add_f32_dpp v112, v112, v112 row_ror:1 row_mask:0xf bank_mask:0xf
    v_add_f32_dpp v109, v109, v109 row_ror:1 row_mask:0xf bank_mask:0xf
    v_mfma_f32_16x16x32_bf16 v[104:107], v[20:23], v[36:39], 0
    v_mul_f32 v112, 0x3a800000, v112
    v_add_f32_dpp v109, v109, v109 row_bcast:15 row_mask:0xa bank_mask:0xf
    v_fmaak_f32 v113, v112, v112, 0xb727c5ac
    v_mul_f32 v116, s70, v124
    v_add_f32_dpp v109, v109, v109 row_bcast:31 row_mask:0xc bank_mask:0xf
    v_fma_f32 v109, v109, s63, -v113
    v_max_f32 v109, 0x3727c5ac, v109
    v_rsq_f32 v109, v109
    v_pk_mul_f32 v[84:85], v[84:85], s[54:55] op_sel:[0,0] op_sel_hi:[1,0]
    v_mul_f32 v109, s52, v109
    v_pk_mul_f32 v[86:87], v[86:87], s[54:55] op_sel:[0,0] op_sel_hi:[1,0]
    v_readlane_b32 s55, v109, 48
    s_nop 1
    v_pk_mul_f32 v[88:89], v[88:89], s[54:55] op_sel:[0,0] op_sel_hi:[1,0]
    v_pk_mul_f32 v[90:91], v[90:91], s[54:55] op_sel:[0,0] op_sel_hi:[1,0]
    v_mul_f32 v112, s55, v112
    v_fmac_f32 v116, v112, v124
F_pass:
    v_pk_fma_f32 v[76:77], v[76:77], s[54:55], v[116:117] op_sel:[0,0,0] op_sel_hi:[1,0,0]
    v_pk_fma_f32 v[78:79], v[78:79], s[54:55], v[116:117] op_sel:[0,0,0] op_sel_hi:[1,0,0]
    v_pk_fma_f32 v[80:81], v[80:81], s[54:55], v[116:117] op_sel:[0,0,0] op_sel_hi:[1,0,0]
    v_pk_fma_f32 v[82:83], v[82:83], s[54:55], v[116:117] op_sel:[0,0,0] op_sel_hi:[1,0,0]
    v_pk_fma_f32 v[76:77], v[92:93], s[54:55], v[76:77] op_sel:[0,1,0] op_sel_hi:[1,1,1]
    v_pk_fma_f32 v[78:79], v[94:95], s[54:55], v[78:79] op_sel:[0,1,0] op_sel_hi:[1,1,1]
    v_pk_fma_f32 v[80:81], v[96:97], s[54:55], v[80:81] op_sel:[0,1,0] op_sel_hi:[1,1,1]
    v_pk_fma_f32 v[82:83], v[98:99], s[54:55], v[82:83] op_sel:[0,1,0] op_sel_hi:[1,1,1]
    v_pk_fma_f32 v[84:85], v[100:101], s[54:55], v[84:85] op_sel:[0,1,0] op_sel_hi:[1,1,1]
    v_pk_fma_f32 v[86:87], v[102:103], s[54:55], v[86:87] op_sel:[0,1,0] op_sel_hi:[1,1,1]
    v_pk_fma_f32 v[88:89], v[104:105], s[54:55], v[88:89] op_sel:[0,1,0] op_sel_hi:[1,1,1]
    v_pk_fma_f32 v[90:91], v[106:107], s[54:55], v[90:91] op_sel:[0,1,0] op_sel_hi:[1,1,1]
    v_cvt_pk_f16_f32 v24, v76, v77
    v_cvt_pk_f16_f32 v25, v78, v79
    v_cvt_pk_f16_f32 v26, v80, v81
    v_cvt_pk_f16_f32 v27, v82, v83
    v_cvt_pk_f16_f32 v28, v84, v85
    v_cvt_pk_f16_f32 v29, v86, v87
    v_cvt_pk_f16_f32 v30, v88, v89
    v_cvt_pk_f16_f32 v31, v90, v91
    v_pk_mul_f16 v68, v24, v60
    v_pk_mul_f16 v69, v25, v61
    v_pk_mul_f16 v70, v26, v62
    v_pk_mul_f16 v71, v27, v63
    v_pk_fma_f16 v68, v28, v64, v68
    v_pk_fma_f16 v69, v29, v65, v69
    v_pk_fma_f16 v70, v30, v66, v70
    v_pk_fma_f16 v71, v31, v67, v71
    v_pk_mul_f16 v72, v28, v60
    v_pk_mul_f16 v73, v29, v61
    v_pk_mul_f16 v74, v30, v62
    v_pk_mul_f16 v75, v31, v63
    v_mfma_f32_16x16x32_f16 v[92:95], v[68:71], v[48:51], 0
    v_mfma_f32_16x16x32_f16 v[96:99], v[68:71], v[56:59], 0
    v_pk_fma_f16 v72, v24, v64, v72 neg_lo:[1,0,0] neg_hi:[1,0,0]
    v_pk_fma_f16 v73, v25, v65, v73 neg_lo:[1,0,0] neg_hi:[1,0,0]
    v_pk_fma_f16 v74, v26, v66, v74 neg_lo:[1,0,0] neg_hi:[1,0,0]
    v_pk_fma_f16 v75, v27, v67, v75 neg_lo:[1,0,0] neg_hi:[1,0,0]
    s_nop 1
    v_mfma_f32_16x16x32_f16 v[92:95], v[72:75], v[52:55], v[92:95]
    v_mfma_f32_16x16x32_f16 v[96:99], v[72:75], v[48:51], v[96:99]
    s_nop 7
    v_cvt_pk_f16_f32 v24, v92, v96
    v_cvt_pk_f16_f32 v25, v93, v97
    v_cvt_pk_f16_f32 v26, v94, v98
    v_cvt_pk_f16_f32 v27, v95, v99
    ds_write_b128 v120, v[24:27] offset:32768
    s_waitcnt lgkmcnt(0)
    s_barrier
    ds_read2st64_b32 v[28:29], v121 offset0:128 offset1:132
    ds_read2st64_b32 v[30:31], v121 offset0:136 offset1:140
    s_waitcnt lgkmcnt(0)
    v_mfma_f32_16x16x32_f16 v[100:103], v[28:31], v[40:43], 0
    v_mfma_f32_16x16x32_f16 v[104:107], v[28:31], v[44:47], 0
    s_nop 7
    v_cvt_pk_f16_f32 v68, v100, v104
    v_cvt_pk_f16_f32 v69, v101, v105
    v_cvt_pk_f16_f32 v70, v102, v106
    v_cvt_pk_f16_f32 v71, v103, v107
    buffer_store_dwordx4 v[68:71], v122, s[24:27], s50 offen sc1
    s_cmp_lg_u32 s46, 0
    s_cbranch_scc1 F_second
    s_mov_b32 s34, 0x71605432
    v_bfe_u32 v6, v2, 2, 2
    s_mov_b32 s35, 0x98fedcba
    v_lshl_add_u32 v6, v6, 2, v4
    s_lshl_b32 s56, s45, 2
    v_and_b32 v1, 3, v2
    s_lshr_b64 s[34:35], s[34:35], s56
    v_lshlrev_b32 v1, 4, v1
    s_and_b32 s34, s34, 15
    v_lshl_add_u32 v6, v6, 18, v1
    s_xor_b32 s45, s45, 8
    v_lshrrev_b32 v108, 3, v3
    s_cmp_eq_u32 s44, 0
    v_and_b32 v109, 7, v3
    s_cselect_b32 s45, s45, s34
    v_lshlrev_b32 v123, 14, v108
    s_sub_u32 s34, 0, s28
    v_lshl_add_u32 v123, v4, 20, v123
    s_and_b32 s34, s34, 7
    v_lshl_add_u32 v123, v109, 3, v123
    s_lshr_b32 s35, s45, 1
    s_cmp_lt_u32 s35, s44
    s_cselect_b32 s28, s34, s28
    s_sub_u32 s34, 0, s28
    s_and_b32 s34, s34, 7
    s_sub_u32 s35, 31, s45
    s_cmp_eq_u32 s44, 0
    s_cselect_b32 s56, s28, s34
    s_cselect_b32 s57, s45, s35
    s_lshl4_add_u32 s64, s3, s56
    s_lshl_b32 s64, s64, 11
    s_lshl_b32 s34, s57, 6
    s_add_u32 s64, s64, s34
    s_add_u32 s65, s64, 262144
    s_add_u32 s66, s64, 524288
    s_add_u32 s67, s64, 786432
    s_mov_b64 s[20:21], s[8:9]
    s_mov_b32 s22, 4194304
    s_mov_b32 s23, 0x20000
    s_mov_b32 s16, 0
    s_lshr_b32 s34, s3, 1
    s_lshl2_add_u32 s34, s46, s34
    s_cmp_lg_u32 s34, 0
    s_cbranch_scc1 F_xp0
    s_mov_b32 m0, s53
    s_add_u32 s35, s64, 16384
    buffer_load_dwordx4 v6, s[12:15], s64 offen  lds
    s_add_u32 m0, s53, 1152
    s_add_u32 s35, s64, 16384
    buffer_load_dwordx4 v6, s[12:15], s35 offen  lds
F_xp0:
    v_and_b32 v110, 31, v2
    v_lshrrev_b32 v111, 5, v2
    s_lshl_b32 s61, s44, 31
    s_xor_b32 s60, s61, 0x3a000000
    v_lshrrev_b32 v112, 1, v110
    v_lshl_add_u32 v112, v112, 3, s56
    v_cvt_f32_u32 v112, v112
    v_mul_f32 v112, s60, v112
    v_and_b32 v113, 1, v110
    v_cvt_f32_u32 v114, v113
    s_sub_u32 s58, 16, s3
    s_cmp_eq_u32 s3, 0
    s_cselect_b32 s34, 0, 0x3e800000
    s_cselect_b32 s35, 0, -1
    s_cselect_b32 s58, 8, s58
    v_mul_f32 v114, s34, v114
    v_mul_f32 v117, 0x42000000, v112
    v_lshl_add_u32 v116, v111, 4, s3
    v_cvt_f32_u32 v116, v116
    v_fma_f32 v116, v116, v112, v114
    v_cos_f32 v108, v116
    v_sin_f32 v109, v116
    v_add_f32 v116, v116, v117
    v_cvt_pk_f16_f32 v32, v108, v109
    v_cos_f32 v108, v116
    v_sin_f32 v109, v116
    v_add_f32 v116, v116, v117
    v_cvt_pk_f16_f32 v33, v108, v109
    v_cos_f32 v108, v116
    v_sin_f32 v109, v116
    v_add_f32 v116, v116, v117
    v_cvt_pk_f16_f32 v34, v108, v109
    v_cos_f32 v108, v116
    v_sin_f32 v109, v116
    v_add_f32 v116, v116, v117
    v_cvt_pk_f16_f32 v35, v108, v109
    v_mov_b32 v48, s33
    v_lshlrev_b32 v49, 10, v2
    s_lshl2_add_u32 s34, s46, s3
    s_cmp_ge_u32 s34, 4
    s_cbranch_scc1 F_x5a
    s_lshr_b32 s34, s3, 1
    s_lshl2_add_u32 s34, s46, s34
    s_cmp_lg_u32 s34, 1
    s_cbranch_scc1 F_xp1
    s_mov_b32 m0, s53
    s_add_u32 s35, s64, 16384
    buffer_load_dwordx4 v6, s[12:15], s64 offen  lds
    s_add_u32 m0, s53, 1152
    s_add_u32 s35, s64, 16384
    buffer_load_dwordx4 v6, s[12:15], s35 offen  lds
F_xp1:
    s_waitcnt vmcnt(2)
    s_branch F_x5b
F_x5a:
    s_waitcnt vmcnt(0)
F_x5b:
    s_cmp_lg_u32 s3, 7
    s_barrier
    s_cbranch_scc1 F_noflag
    s_mov_b32 exec_lo, 0xffffffff
    s_mov_b32 exec_hi, 0
    buffer_store_dword v48, v49, s[24:27], s29 offen sc1
    s_mov_b64 exec, -1
F_noflag:
    s_lshr_b32 s34, s3, s46
    s_cmp_lt_u32 s34, 4
    s_cbranch_scc1 F_x5c
    s_lshr_b32 s34, s3, 1
    s_lshl2_add_u32 s34, s46, s34
    s_cmp_lg_u32 s34, 2
    s_cbranch_scc1 F_xp2
    s_mov_b32 m0, s53
    s_add_u32 s35, s64, 16384
    buffer_load_dwordx4 v6, s[12:15], s64 offen  lds
    s_add_u32 m0, s53, 1152
    s_add_u32 s35, s64, 16384
    buffer_load_dwordx4 v6, s[12:15], s35 offen  lds
F_xp2:
F_x5c:
    v_lshrrev_b32 v118, 3, v3
    v_lshlrev_b32 v124, 7, v118
    v_lshl_add_u32 v124, v4, 5, v124
    s_lshl3_add_u32 s59, s56, s3
    s_lshl_b32 s59, s59, 8
    s_add_u32 s59, s59, 24576
    s_mov_b32 s62, 0
F_stats:
    buffer_load_dwordx4 v[24:27], v124, s[24:27], s59 offen sc1
    buffer_load_dwordx4 v[28:31], v124, s[24:27], s59 offen offset:16 sc1
    s_cmp_lg_u32 s62, 0
    s_cbranch_scc1 F_stats_w
F_stats_i:
    v_lshl_add_u32 v116, v111, 4, s58
    v_cvt_f32_u32 v116, v116
    v_fma_f32 v116, v116, v112, -v114
    v_cos_f32 v108, v116
    v_sin_f32 v109, v116
    v_add_f32 v116, v116, v117
    v_cvt_pk_f16_f32 v36, v108, v109
    v_cos_f32 v108, v116
    v_sin_f32 v109, v116
    v_add_f32 v116, v116, v117
    v_cvt_pk_f16_f32 v37, v108, v109
    v_cos_f32 v108, v116
    v_sin_f32 v109, v116
    v_add_f32 v116, v116, v117
    v_cvt_pk_f16_f32 v38, v108, v109
    v_cos_f32 v108, v116
    v_sin_f32 v109, v116
    v_add_f32 v116, v116, v117
    v_cvt_pk_f16_f32 v39, v108, v109
    s_cmp_lg_u32 s3, 0
    s_cbranch_scc1 F_now0
    v_mul_f32 v116, 0x43000000, v112
    v_cos_f32 v108, v116
    v_sin_f32 v109, v116
    v_add_u32 v115, -1, v113
    v_and_b32 v32, v32, v115
    v_bfi_b32 v36, v115, 0, v36
    v_and_b32 v33, v33, v115
    v_bfi_b32 v37, v115, 0, v37
    v_and_b32 v34, v34, v115
    v_bfi_b32 v38, v115, 0, v38
    v_and_b32 v35, v35, v115
    v_bfi_b32 v39, v115, 0, v39
    v_or_b32 v115, v113, v111
    v_add_u32 v115, -1, v115
    v_cvt_pk_f16_f32 v40, v108, v109
    v_and_b32 v40, v40, v115
    v_mov_b32 v41, 0
    v_mov_b32 v57, 0
    v_mov_b32 v42, 0
    v_mov_b32 v58, 0
    v_mov_b32 v43, 0
    v_mov_b32 v59, 0
F_now0:
    s_lshr_b32 s34, s3, 1
    s_lshl2_add_u32 s34, s46, s34
    s_cmp_lg_u32 s34, 3
    s_cbranch_scc1 F_xp3
    s_mov_b32 m0, s53
    s_add_u32 s35, s64, 16384
    buffer_load_dwordx4 v6, s[12:15], s64 offen  lds
    s_add_u32 m0, s53, 1152
    s_add_u32 s35, s64, 16384
    buffer_load_dwordx4 v6, s[12:15], s35 offen  lds
F_xp3:
    s_xor_b32 s60, s61, 0x3d800000
    v_cvt_f32_u32 v117, v3
    v_mul_f32 v117, s60, v117
    v_lshlrev_b32 v116, 1, v4
    v_cvt_f32_u32 v116, v116
    v_mul_f32 v116, v116, v117
    v_add_f32 v117, v116, v117
    v_cos_f32 v108, v116
    v_sin_f32 v109, v116
    v_cos_f32 v114, v117
    v_sin_f32 v115, v117
    v_cvt_pk_f16_f32 v44, v108, v109
    s_mov_b32 s34, 0x3c003c00
    v_cvt_pk_f16_f32 v45, v114, v115
    s_mov_b64 exec, 0xffff
    v_lshl_or_b32 v44, v3, 31, s34
    s_mov_b64 exec, -1
    v_lshl_add_u32 v122, s3, 1, v118
    v_mul_u32_u24 v122, 1280, v122
    v_mul_u32_u24 v108, 272, v4
    v_and_b32 v109, 7, v3
    v_lshlrev_b32 v109, 5, v109
    v_add3_u32 v122, v122, v108, v109
    s_lshr_b32 s34, s3, 1
    s_mul_i32 s34, s34, 272
    s_and_b32 s35, s3, 1
    s_lshl2_add_u32 s34, s35, s34
    v_mul_u32_u24 v121, 2560, v111
    v_lshl_add_u32 v121, v110, 3, v121
    v_add_u32 v121, s34, v121
    s_cmp_eq_u32 s44, 0
    s_cselect_b32 s34, 0, 31
    s_cselect_b32 s35, -1, 0
    s_lshl_b32 s60, s45, 5
    s_add_u32 s35, s35, s60
    v_xor_b32 v108, s34, v110
    v_add_u32 v108, s35, v108
    v_max_i32 v108, 0, v108
    v_bfe_u32 v125, v108, 4, 1
    v_mul_u32_u24 v125, 8320, v125
    v_lshrrev_b32 v109, 6, v108
    v_lshl_add_u32 v125, v109, 10, v125
    v_bfe_u32 v109, v108, 5, 1
    v_lshl_add_u32 v125, v109, 6, v125
    v_and_b32 v108, 15, v108
    v_lshl_add_u32 v125, v108, 2, v125
    v_mul_u32_u24 v120, 16640, v111
    v_add_u32 v120, v120, v125
    s_lshl_b32 s58, s28, 7
    s_add_u32 s58, s58, 1048576
    s_add_u32 s60, s58, 2129920
    s_mul_i32 s34, s3, 266240
    s_add_u32 s58, s58, s34
    s_lshl4_add_u32 s47, s3, s56
    s_lshl_b32 s48, s57, 7
    s_add_u32 s49, s48, 491520
    s_lshl1_add_u32 s48, s48, 753664
    s_add_u32 s52, s48, 128
    s_and_b32 s34, s2, 31
    s_lshl3_add_u32 s34, s34, s3
    s_lshl_b32 s34, s34, 7
    s_add_u32 s34, s34, 40960
    s_add_u32 s42, s10, s34
    s_addc_u32 s43, s11, 0
    s_mov_b32 s40, s33
    s_mov_b32 s41, s33
    s_and_b32 s63, s2, 31
    s_lshl_b32 s63, s63, 7
    s_add_u32 s63, s63, 4096
    v_mul_u32_u24 v108, 1152, v118
    v_lshl_add_u32 v108, v4, 6, v108
    v_and_b32 v109, 7, v3
    v_lshlrev_b32 v109, 3, v109
    v_add3_u32 v108, v108, v109, s53
    s_waitcnt vmcnt(0)
F_xt:
    ds_read_b64 v[8:9], v108 offset:0
    ds_read_b64 v[10:11], v108 offset:256
    ds_read_b64 v[12:13], v108 offset:512
    ds_read_b64 v[14:15], v108 offset:768
    s_waitcnt lgkmcnt(3)
    v_lshlrev_b32 v60, 16, v8
    v_and_b32 v64, 0xffff0000, v8
    v_lshlrev_b32 v68, 16, v9
    v_and_b32 v72, 0xffff0000, v9
    s_waitcnt lgkmcnt(2)
    v_lshlrev_b32 v61, 16, v10
    v_and_b32 v65, 0xffff0000, v10
    v_lshlrev_b32 v69, 16, v11
    v_and_b32 v73, 0xffff0000, v11
    s_waitcnt lgkmcnt(1)
    v_lshlrev_b32 v62, 16, v12
    v_and_b32 v66, 0xffff0000, v12
    v_lshlrev_b32 v70, 16, v13
    v_and_b32 v74, 0xffff0000, v13
    s_waitcnt lgkmcnt(0)
    v_lshlrev_b32 v63, 16, v14
    v_and_b32 v67, 0xffff0000, v14
    v_lshlrev_b32 v71, 16, v15
    v_and_b32 v75, 0xffff0000, v15
F_stats_w:
    s_waitcnt vmcnt(0)
F_stats_c:
    v_xor_b32 v108, s33, v25
    v_xor_b32 v109, s33, v27
    v_xor_b32 v110, s33, v29
    v_xor_b32 v111, s33, v31
    v_or3_b32 v108, v108, v109, v110
    v_or_b32 v108, v108, v111
    v_cmp_ne_u32 vcc, 0, v108
    s_add_u32 s62, s62, 1
    s_cbranch_vccz F_stats_d
    s_sleep 4
    s_cmp_lt_u32 s62, 200000
    s_cbranch_scc1 F_stats
F_stats_d:
    s_cmp_lt_u32 s2, 224
    s_cbranch_scc1 F_npf2
    s_cmp_gt_u32 s3, 1
    s_cbranch_scc1 F_npf2
    s_getpc_b64 s[6:7]
L_pc2:
    s_mov_b32 m0, 66816
    v_lshlrev_b32 v110, 7, v0
    v_min_u32 v110, L_end-L_pc2, v110
    v_mov_b32 v111, s7
    v_add_co_u32 v110, vcc, s6, v110
    s_nop 1
    v_addc_co_u32 v111, vcc, 0, v111, vcc
    global_load_lds_dword v[110:111], off sc1
F_npf2:
    s_cmp_eq_u32 s46, 2
    s_cbranch_scc1 F_npre
    s_load_dwordx16 s[68:83], s[42:43], 0 glc
    s_load_dwordx16 s[84:99], s[42:43], 64 glc
F_npre:
    s_mov_b32 s34, 0xbe38aa3b
    v_mov_b32 v108, 0x3427c5ac
    v_and_b32 v16, 0xffff0000, v24
    v_fmamk_f32 v16, v16, 0x3c800000, v108
    v_and_b32 v17, 0xffff0000, v26
    v_fmamk_f32 v17, v17, 0x3c800000, v108
    v_and_b32 v18, 0xffff0000, v28
    v_fmamk_f32 v18, v18, 0x3c800000, v108
    v_and_b32 v19, 0xffff0000, v30
    v_fmamk_f32 v19, v19, 0x3c800000, v108
    v_rsq_f32 v16, v16
    v_lshlrev_b32 v20, 16, v24
    v_rsq_f32 v17, v17
    v_lshlrev_b32 v21, 16, v26
    v_rsq_f32 v18, v18
    v_lshlrev_b32 v22, 16, v28
    v_rsq_f32 v19, v19
    v_lshlrev_b32 v23, 16, v30
    v_pk_mul_f32 v[20:21], v[20:21], v[16:17] neg_lo:[1,0] neg_hi:[1,0]
    v_pk_mul_f32 v[22:23], v[22:23], v[18:19] neg_lo:[1,0] neg_hi:[1,0]
    v_pk_mul_f32 v[24:25], v[16:17], s[34:35] op_sel:[0,0] op_sel_hi:[1,0]
    v_pk_mul_f32 v[26:27], v[18:19], s[34:35] op_sel:[0,0] op_sel_hi:[1,0]
    v_pk_mul_f32 v[28:29], v[20:21], s[34:35] op_sel:[0,0] op_sel_hi:[1,0]
    v_pk_mul_f32 v[30:31], v[22:23], s[34:35] op_sel:[0,0] op_sel_hi:[1,0]
    v_pk_fma_f32 v[92:93], v[60:61], v[24:25], v[28:29]
    v_pk_fma_f32 v[94:95], v[62:63], v[26:27], v[30:31]
    v_pk_fma_f32 v[96:97], v[64:65], v[24:25], v[28:29]
    v_pk_fma_f32 v[98:99], v[66:67], v[26:27], v[30:31]
    v_pk_fma_f32 v[100:101], v[68:69], v[24:25], v[28:29]
    v_pk_fma_f32 v[102:103], v[70:71], v[26:27], v[30:31]
    v_pk_fma_f32 v[104:105], v[72:73], v[24:25], v[28:29]
    v_pk_fma_f32 v[106:107], v[74:75], v[26:27], v[30:31]
    v_exp_f32 v92, v92
    v_exp_f32 v93, v93
    v_pk_fma_f32 v[76:77], v[60:61], v[16:17], v[20:21]
    v_exp_f32 v94, v94
    v_exp_f32 v95, v95
    v_pk_fma_f32 v[78:79], v[62:63], v[18:19], v[22:23]
    v_exp_f32 v96, v96
    v_exp_f32 v97, v97
    v_pk_fma_f32 v[80:81], v[64:65], v[16:17], v[20:21]
    v_exp_f32 v98, v98
    v_exp_f32 v99, v99
    v_pk_fma_f32 v[82:83], v[66:67], v[18:19], v[22:23]
    v_exp_f32 v100, v100
    v_exp_f32 v101, v101
    v_pk_fma_f32 v[84:85], v[68:69], v[16:17], v[20:21]
    v_exp_f32 v102, v102
    v_exp_f32 v103, v103
    v_pk_fma_f32 v[86:87], v[70:71], v[18:19], v[22:23]
    v_exp_f32 v104, v104
    v_exp_f32 v105, v105
    v_pk_fma_f32 v[88:89], v[72:73], v[16:17], v[20:21]
    v_exp_f32 v106, v106
    v_exp_f32 v107, v107
    v_pk_fma_f32 v[90:91], v[74:75], v[18:19], v[22:23]
    s_mov_b32 s62, 0
    s_cmp_lg_u32 s46, 2
    s_cbranch_scc1 F_poll_w
F_mid:
    v_pk_add_f32 v[92:93], v[92:93], 1.0 op_sel_hi:[1,0]
    v_pk_add_f32 v[94:95], v[94:95], 1.0 op_sel_hi:[1,0]
    v_pk_add_f32 v[96:97], v[96:97], 1.0 op_sel_hi:[1,0]
    v_pk_add_f32 v[98:99], v[98:99], 1.0 op_sel_hi:[1,0]
    v_pk_add_f32 v[100:101], v[100:101], 1.0 op_sel_hi:[1,0]
    v_pk_add_f32 v[102:103], v[102:103], 1.0 op_sel_hi:[1,0]
    v_pk_add_f32 v[104:105], v[104:105], 1.0 op_sel_hi:[1,0]
    v_pk_add_f32 v[106:107], v[106:107], 1.0 op_sel_hi:[1,0]
    v_rcp_f32 v92, v92
    v_rcp_f32 v93, v93
    v_rcp_f32 v94, v94
    v_rcp_f32 v95, v95
    v_rcp_f32 v96, v96
    v_rcp_f32 v97, v97
    v_rcp_f32 v98, v98
    v_rcp_f32 v99, v99
    v_rcp_f32 v100, v100
    v_rcp_f32 v101, v101
    v_rcp_f32 v102, v102
    v_rcp_f32 v103, v103
    v_rcp_f32 v104, v104
    v_rcp_f32 v105, v105
    v_rcp_f32 v106, v106
    v_rcp_f32 v107, v107
    v_pk_mul_f32 v[76:77], v[76:77], v[92:93]
    v_pk_mul_f32 v[78:79], v[78:79], v[94:95]
    v_pk_mul_f32 v[80:81], v[80:81], v[96:97]
    v_pk_mul_f32 v[82:83], v[82:83], v[98:99]
    v_pk_mul_f32 v[84:85], v[84:85], v[100:101]
    v_pk_mul_f32 v[86:87], v[86:87], v[102:103]
    v_pk_mul_f32 v[88:89], v[88:89], v[104:105]
    v_pk_mul_f32 v[90:91], v[90:91], v[106:107]
    s_mov_b32 s62, 0
    s_cmp_eq_u32 s46, 2
    s_cbranch_scc1 F_fetched
    s_branch F_poll_w
F_poll:
    s_load_dwordx16 s[68:83], s[42:43], 0 glc
    s_load_dwordx16 s[84:99], s[42:43], 64 glc
F_poll_w:
    s_waitcnt lgkmcnt(0)
    s_xor_b64 s[68:69], s[68:69], s[40:41]
    s_xor_b64 s[70:71], s[70:71], s[40:41]
    s_or_b64 s[68:69], s[68:69], s[70:71]
    s_xor_b64 s[72:73], s[72:73], s[40:41]
    s_or_b64 s[68:69], s[68:69], s[72:73]
    s_xor_b64 s[74:75], s[74:75], s[40:41]
    s_or_b64 s[68:69], s[68:69], s[74:75]
    s_xor_b64 s[76:77], s[76:77], s[40:41]
    s_or_b64 s[68:69], s[68:69], s[76:77]
    s_xor_b64 s[78:79], s[78:79], s[40:41]
    s_or_b64 s[68:69], s[68:69], s[78:79]
    s_xor_b64 s[80:81], s[80:81], s[40:41]
    s_or_b64 s[68:69], s[68:69], s[80:81]
    s_xor_b64 s[82:83], s[82:83], s[40:41]
    s_or_b64 s[68:69], s[68:69], s[82:83]
    s_xor_b64 s[84:85], s[84:85], s[40:41]
    s_or_b64 s[68:69], s[68:69], s[84:85]
    s_xor_b64 s[86:87], s[86:87], s[40:41]
    s_or_b64 s[68:69], s[68:69], s[86:87]
    s_xor_b64 s[88:89], s[88:89], s[40:41]
    s_or_b64 s[68:69], s[68:69], s[88:89]
    s_xor_b64 s[90:91], s[90:91], s[40:41]
    s_or_b64 s[68:69], s[68:69], s[90:91]
    s_xor_b64 s[92:93], s[92:93], s[40:41]
    s_or_b64 s[68:69], s[68:69], s[92:93]
    s_xor_b64 s[94:95], s[94:95], s[40:41]
    s_or_b64 s[68:69], s[68:69], s[94:95]
    s_xor_b64 s[96:97], s[96:97], s[40:41]
    s_or_b64 s[68:69], s[68:69], s[96:97]
    s_xor_b64 s[98:99], s[98:99], s[40:41]
    s_or_b64 s[68:69], s[68:69], s[98:99]
    s_cbranch_scc0 F_rel
    s_cmp_lg_u32 s46, 0
    s_cbranch_scc1 F_poll_n
    s_mov_b32 s46, 1
    s_load_dwordx16 s[68:83], s[42:43], 0 glc
    s_load_dwordx16 s[84:99], s[42:43], 64 glc
    s_branch F_mid
F_poll_n:
    s_add_u32 s62, s62, 1
    s_sleep 5
    s_cmp_lt_u32 s62, 200000
    s_cbranch_scc1 F_poll
F_rel:
    buffer_load_dword v48, v120, s[24:27], s58 offen sc1
    s_add_u32 s58, s58, 33280
    buffer_load_dword v49, v120, s[24:27], s58 offen sc1
    s_add_u32 s58, s58, 33280
    buffer_load_dword v50, v120, s[24:27], s58 offen sc1
    s_add_u32 s58, s58, 33280
    buffer_load_dword v51, v120, s[24:27], s58 offen sc1
    s_add_u32 s58, s58, 33280
    buffer_load_dword v52, v120, s[24:27], s58 offen sc1
    s_add_u32 s58, s58, 33280
    buffer_load_dword v53, v120, s[24:27], s58 offen sc1
    s_add_u32 s58, s58, 33280
    buffer_load_dword v54, v120, s[24:27], s58 offen sc1
    s_add_u32 s58, s58, 33280
    buffer_load_dword v55, v120, s[24:27], s58 offen sc1
    s_load_dwordx2 s[36:37], s[10:11], s63
    s_cmp_lg_u32 s3, 0
    s_cbranch_scc1 F_novx
    buffer_load_dword v56, v125, s[24:27], s60 offen sc1
F_novx:
    s_cmp_eq_u32 s46, 0
    s_mov_b32 s46, 2
    s_cbranch_scc1 F_mid
F_fetched:
    s_cmp_lg_u32 s3, 0
    s_cbranch_scc1 F_A
    s_waitcnt vmcnt(0)
    v_mfma_f32_32x32x16_f16 v[92:107], v[40:43], v[56:59], 0
    v_mfma_f32_32x32x16_f16 v[92:107], v[32:35], v[48:51], v[92:107]
    s_branch F_A2
F_A:
    s_waitcnt vmcnt(4)
    v_mfma_f32_32x32x16_f16 v[92:107], v[32:35], v[48:51], 0
    s_waitcnt vmcnt(0)
F_A2:
    v_mfma_f32_32x32x16_f16 v[92:107], v[36:39], v[52:55], v[92:107]
    s_waitcnt lgkmcnt(0)
    s_and_b32 s34, s36, 0x77
    s_cmp_eq_u32 s34, s47
    s_cbranch_scc1 F_eh
F_eh_r:
    s_nop 7
    v_cvt_pk_f16_f32 v48, v92, v93
    v_cvt_pk_f16_f32 v49, v94, v95
    ds_write2st64_b32 v121, v48, v49 offset0:128 offset1:133
    v_cvt_pk_f16_f32 v50, v96, v97
    v_cvt_pk_f16_f32 v51, v98, v99
    ds_write2st64_b32 v121, v50, v51 offset0:148 offset1:153
    v_cvt_pk_f16_f32 v52, v100, v101
    v_cvt_pk_f16_f32 v53, v102, v103
    ds_write2st64_b32 v121, v52, v53 offset0:168 offset1:173
    v_cvt_pk_f16_f32 v54, v104, v105
    v_cvt_pk_f16_f32 v55, v106, v107
    ds_write2st64_b32 v121, v54, v55 offset0:188 offset1:193
    s_waitcnt lgkmcnt(0)
    s_barrier
    ds_read_b128 v[48:51], v122 offset:32768
    ds_read_b128 v[52:55], v122 offset:32784
    s_waitcnt lgkmcnt(1)
    v_mfma_f32_16x16x16_f16 v[92:95], v[44:45], v[48:49], 0
    v_mfma_f32_16x16x16_f16 v[96:99], v[44:45], v[50:51], 0
    s_waitcnt lgkmcnt(0)
    v_mfma_f32_16x16x16_f16 v[100:103], v[44:45], v[52:53], 0
    v_mfma_f32_16x16x16_f16 v[104:107], v[44:45], v[54:55], 0
    s_and_b32 s34, s36, 0x77
    s_cmp_lg_u32 s34, s47
    s_cbranch_scc1 F_noh
    s_mul_i32 s50, s33, 28
    s_sub_u32 s50, s50, s68
    s_sub_u32 s50, s50, s69
    s_sub_u32 s50, s50, s70
    s_sub_u32 s50, s50, s71
    s_sub_u32 s50, s50, s72
    s_sub_u32 s50, s50, s73
    s_sub_u32 s50, s50, s74
    s_sub_u32 s50, s50, s75
    s_sub_u32 s50, s50, s76
    s_sub_u32 s50, s50, s77
    s_sub_u32 s50, s50, s78
    s_sub_u32 s50, s50, s79
    s_sub_u32 s50, s50, s80
    s_sub_u32 s50, s50, s81
    s_sub_u32 s50, s50, s84
    s_sub_u32 s50, s50, s85
    s_sub_u32 s50, s50, s86
    s_sub_u32 s50, s50, s87
    s_sub_u32 s50, s50, s88
    s_sub_u32 s50, s50, s89
    s_sub_u32 s50, s50, s90
    s_sub_u32 s50, s50, s91
    s_sub_u32 s50, s50, s92
    s_sub_u32 s50, s50, s93
    s_sub_u32 s50, s50, s94
    s_sub_u32 s50, s50, s95
    s_sub_u32 s50, s50, s96
    s_sub_u32 s50, s50, s97
    s_cmp_eq_u32 s50, 0
    s_cbranch_scc1 F_own
    s_load_dwordx16 s[68:83], s[10:11], s48 glc
    s_load_dwordx16 s[84:99], s[10:11], s52 glc
F_noh:
    s_cmp_eq_u32 s57, 0
    s_cbranch_scc1 F_zero
F_nz:
    v_pk_fma_f32 v[60:61], v[92:93], v[76:77], v[60:61]
    v_pk_fma_f32 v[64:65], v[96:97], v[80:81], v[64:65]
    v_pk_fma_f32 v[68:69], v[100:101], v[84:85], v[68:69]
    v_pk_fma_f32 v[72:73], v[104:105], v[88:89], v[72:73]
    v_cvt_pk_bf16_f32 v32, v60, v64
    v_cvt_pk_bf16_f32 v33, v68, v72
    buffer_store_dwordx2 v[32:33], v123, s[20:23], s64 offen sc1
    v_cvt_pk_bf16_f32 v34, v61, v65
    v_cvt_pk_bf16_f32 v35, v69, v73
    buffer_store_dwordx2 v[34:35], v123, s[20:23], s65 offen sc1
    v_pk_fma_f32 v[62:63], v[94:95], v[78:79], v[62:63]
    v_pk_fma_f32 v[66:67], v[98:99], v[82:83], v[66:67]
    v_pk_fma_f32 v[70:71], v[102:103], v[86:87], v[70:71]
    v_pk_fma_f32 v[74:75], v[106:107], v[90:91], v[74:75]
    v_cvt_pk_bf16_f32 v36, v62, v66
    v_cvt_pk_bf16_f32 v37, v70, v74
    buffer_store_dwordx2 v[36:37], v123, s[20:23], s66 offen sc1
    v_cvt_pk_bf16_f32 v38, v63, v67
    v_cvt_pk_bf16_f32 v39, v71, v75
    buffer_store_dwordx2 v[38:39], v123, s[20:23], s67 offen sc1
    s_mov_b32 s62, 0
    s_cmp_lg_u32 s16, 0
    s_cbranch_scc1 F_own2
F_res:
    s_cmp_eq_u32 s37, s33
    s_cbranch_scc1 F_res_d
    s_load_dwordx2 s[36:37], s[10:11], s63 glc
    s_add_u32 s62, s62, 1
    s_cmp_lt_u32 s62, 200000
    s_waitcnt lgkmcnt(0)
    s_cbranch_scc1 F_res
F_res_d:
    s_and_b32 s34, s36, 0x77
    s_cmp_lg_u32 s34, s47
    s_cbranch_scc1 L_fin
    v_lshrrev_b32 v108, 3, v2
    v_lshlrev_b32 v108, 12, v108
    v_and_b32 v109, 0x70, v126
    v_add_u32 v108, v108, v109
    s_cmp_eq_u32 s50, 0
    s_cbranch_scc1 F_n2_d
    s_mul_i32 s50, s33, 28
    s_mov_b32 s62, 0
F_n2:
    s_waitcnt lgkmcnt(0)
    s_add_u32 s84, s84, s68
    s_add_u32 s84, s84, s69
    s_add_u32 s84, s84, s70
    s_add_u32 s84, s84, s71
    s_add_u32 s84, s84, s72
    s_add_u32 s84, s84, s73
    s_add_u32 s84, s84, s74
    s_add_u32 s84, s84, s75
    s_add_u32 s84, s84, s76
    s_add_u32 s84, s84, s77
    s_add_u32 s84, s84, s78
    s_add_u32 s84, s84, s79
    s_add_u32 s84, s84, s80
    s_add_u32 s84, s84, s81
    s_add_u32 s84, s84, s85
    s_add_u32 s84, s84, s86
    s_add_u32 s84, s84, s87
    s_add_u32 s84, s84, s88
    s_add_u32 s84, s84, s89
    s_add_u32 s84, s84, s90
    s_add_u32 s84, s84, s91
    s_add_u32 s84, s84, s92
    s_add_u32 s84, s84, s93
    s_add_u32 s84, s84, s94
    s_add_u32 s84, s84, s95
    s_add_u32 s84, s84, s96
    s_add_u32 s84, s84, s97
    s_cmp_eq_u32 s84, s50
    s_cbranch_scc1 F_n2_d
    s_load_dwordx16 s[68:83], s[10:11], s48 glc
    s_load_dwordx16 s[84:99], s[10:11], s52 glc
    s_add_u32 s62, s62, 1
    s_cmp_lt_u32 s62, 200000
    s_cbranch_scc1 F_n2
F_n2_d:
    s_mov_b32 s62, 0
F_h2:
    s_mov_b32 s34, s49
    buffer_load_dwordx4 v[8:11], v108, s[24:27], s34 offen sc1
    s_add_u32 s34, s34, 32768
    buffer_load_dwordx4 v[12:15], v108, s[24:27], s34 offen sc1
    s_add_u32 s34, s34, 32768
    buffer_load_dwordx4 v[24:27], v108, s[24:27], s34 offen sc1
    s_add_u32 s34, s34, 32768
    buffer_load_dwordx4 v[28:31], v108, s[24:27], s34 offen sc1
    s_add_u32 s34, s34, 32768
    buffer_load_dwordx4 v[48:51], v108, s[24:27], s34 offen sc1
    s_add_u32 s34, s34, 32768
    buffer_load_dwordx4 v[52:55], v108, s[24:27], s34 offen sc1
    s_add_u32 s34, s34, 32768
    buffer_load_dwordx4 v[56:59], v108, s[24:27], s34 offen sc1
    s_cmp_lg_u32 s62, 0
    s_cbranch_scc1 F_h2_w
F_own2:
    s_bfe_u32 s38, s36, 0x20007
    s_bfe_u32 s39, s36, 0x20009
    s_bfe_u32 s51, s36, 0x10003
    s_set_gpr_idx_on s38, 1
    v_mov_b32 v40, v92
    v_mov_b32 v41, v96
    v_mov_b32 v42, v100
    v_mov_b32 v43, v104
    v_mov_b32 v44, v16
    v_mov_b32 v45, v20
    s_set_gpr_idx_off
    s_lshl1_add_u32 s34, s39, s51
    s_lshl_b32 s44, s34, 3
    v_add_u32 v114, s53, v126
    ds_write_b128 v114, v[40:43] offset:2560
    v_and_b32 v113, 7, v2
    v_lshl_add_u32 v113, v113, 2, v4
    s_lshl4_add_u32 s34, s44, s53
    v_lshl_add_u32 v112, v113, 2, s34
    ds_read_b32 v112, v112 offset:2560
    s_lshl2_add_u32 s34, s38, s39
    s_lshl_b32 s34, s34, 6
    s_mul_i32 s35, s51, 1152
    s_add_u32 s34, s34, s35
    s_add_u32 s34, s34, s53
    v_lshlrev_b32 v113, 1, v113
    v_add_u32 v110, s34, v113
    ds_read_u16 v110, v110
    v_readlane_b32 s45, v44, s44
    v_readlane_b32 s46, v45, s44
    s_and_b32 s34, s36, 0xfffff800
    s_ashr_i32 s35, s34, 31
    s_orn2_b32 s35, 0x80000000, s35
    s_xor_b32 s34, s34, s35
    v_mov_b32 v109, 0xbfb8aa3b
    v_mul_f32 v109, s34, v109
    v_exp_f32 v109, v109
    s_waitcnt lgkmcnt(0)
    v_lshlrev_b32 v110, 16, v110
    v_mov_b32 v111, s46
    v_add_f32 v109, 1.0, v109
    v_rcp_f32 v109, v109
    v_fmac_f32 v111, s45, v110
    v_mul_f32 v109, 0x41000000, v109
    s_and_b32 s38, s36, 2047
    s_lshl_b32 s38, s38, 11
    s_lshl_b32 s34, s57, 6
    s_add_u32 s38, s38, s34
    s_cmp_eq_u32 s16, 0
    s_cbranch_scc1 F_h2_w
    s_waitcnt vmcnt(4)
    v_pk_add_f32 v[88:89], v[8:9], v[12:13]
    v_pk_add_f32 v[90:91], v[10:11], v[14:15]
    v_pk_add_f32 v[88:89], v[88:89], v[24:25]
    v_pk_add_f32 v[90:91], v[90:91], v[26:27]
    v_pk_add_f32 v[88:89], v[88:89], v[28:29]
    v_pk_add_f32 v[90:91], v[90:91], v[30:31]
    v_pk_add_f32 v[88:89], v[88:89], v[48:49]
    v_pk_add_f32 v[90:91], v[90:91], v[50:51]
    v_pk_add_f32 v[88:89], v[88:89], v[52:53]
    v_pk_add_f32 v[90:91], v[90:91], v[54:55]
    v_pk_add_f32 v[88:89], v[88:89], v[56:57]
    v_pk_add_f32 v[90:91], v[90:91], v[58:59]
    s_nop 0
    v_permlane16_swap_b32 v88, v89
    v_permlane16_swap_b32 v90, v91
    v_add_f32 v88, v88, v89
    v_add_f32 v90, v90, v91
    s_nop 1
    v_permlane32_swap_b32 v88, v90
    v_add_f32 v88, v88, v90
    s_nop 1
    v_add_f32_dpp v88, v88, v88 row_ror:8 row_mask:0xf bank_mask:0xf
    v_cmp_u_f32 vcc, v88, v88
    v_fma_f32 v88, v88, v109, v111
    s_cbranch_vccz F_h2_d
    s_branch F_h2_x
F_h2_w:
    s_waitcnt vmcnt(5)
    v_pk_add_f32 v[88:89], v[8:9], v[12:13]
    v_pk_add_f32 v[90:91], v[10:11], v[14:15]
    s_waitcnt vmcnt(4)
    v_pk_add_f32 v[88:89], v[88:89], v[24:25]
    v_pk_add_f32 v[90:91], v[90:91], v[26:27]
    s_waitcnt vmcnt(3)
    v_pk_add_f32 v[88:89], v[88:89], v[28:29]
    v_pk_add_f32 v[90:91], v[90:91], v[30:31]
    s_waitcnt vmcnt(2)
    v_pk_add_f32 v[88:89], v[88:89], v[48:49]
    v_pk_add_f32 v[90:91], v[90:91], v[50:51]
    s_waitcnt vmcnt(1)
    v_pk_add_f32 v[88:89], v[88:89], v[52:53]
    v_pk_add_f32 v[90:91], v[90:91], v[54:55]
    s_waitcnt vmcnt(0)
    v_pk_add_f32 v[88:89], v[88:89], v[56:57]
    v_pk_add_f32 v[90:91], v[90:91], v[58:59]
    s_nop 0
    v_permlane16_swap_b32 v88, v89
    v_permlane16_swap_b32 v90, v91
    v_add_f32 v88, v88, v89
    v_add_f32 v90, v90, v91
    s_nop 1
    v_permlane32_swap_b32 v88, v90
    v_add_f32 v88, v88, v90
    s_nop 1
    v_add_f32_dpp v88, v88, v88 row_ror:8 row_mask:0xf bank_mask:0xf
    v_cmp_u_f32 vcc, v88, v88
    v_fma_f32 v88, v88, v109, v111
    s_cbranch_vccnz F_h2_x
F_h2_d:
    v_mul_f32 v89, 0xbe38aa3b, v88
    v_exp_f32 v89, v89
    v_mul_f32 v88, v88, v112
    v_add_f32 v89, 1.0, v89
    v_rcp_f32 v89, v89
    s_mov_b32 exec_lo, 0x00ff00ff
    s_mov_b32 exec_hi, 0x00ff00ff
    v_fmac_f32 v110, v88, v89
    v_cvt_pk_bf16_f32 v110, v110, v110
    buffer_store_short v110, v113, s[20:23], s38 offen sc1
    s_cmp_lg_u32 s57, 0
    s_cbranch_scc1 L_fin
    s_mov_b64 exec, 1
    v_mov_b32 v108, 0
    v_mov_b32 v109, s33
    buffer_store_dword v109, v108, s[24:27], 0 offen sc1
    s_branch L_fin
F_own:
    s_cmp_lg_u32 s37, s33
    s_cbranch_scc1 F_noh
    v_lshrrev_b32 v108, 3, v2
    v_lshlrev_b32 v108, 12, v108
    v_and_b32 v109, 0x70, v126
    v_add_u32 v108, v108, v109
    s_mov_b32 s34, s49
    buffer_load_dwordx4 v[8:11], v108, s[24:27], s34 offen sc1
    s_add_u32 s34, s34, 32768
    buffer_load_dwordx4 v[12:15], v108, s[24:27], s34 offen sc1
    s_add_u32 s34, s34, 32768
    buffer_load_dwordx4 v[24:27], v108, s[24:27], s34 offen sc1
    s_add_u32 s34, s34, 32768
    buffer_load_dwordx4 v[28:31], v108, s[24:27], s34 offen sc1
    s_add_u32 s34, s34, 32768
    buffer_load_dwordx4 v[48:51], v108, s[24:27], s34 offen sc1
    s_add_u32 s34, s34, 32768
    buffer_load_dwordx4 v[52:55], v108, s[24:27], s34 offen sc1
    s_add_u32 s34, s34, 32768
    buffer_load_dwordx4 v[56:59], v108, s[24:27], s34 offen sc1
    s_mov_b32 s16, 1
    s_branch F_noh
F_eh:
    s_load_dwordx16 s[68:83], s[10:11], s48 glc
    s_load_dwordx16 s[84:99], s[10:11], s52 glc
    s_branch F_eh_r
F_h2_x:
    v_max3_u32 v89, v8, v9, v10
    v_max3_u32 v89, v89, v11, v12
    v_max3_u32 v89, v89, v13, v14
    v_max3_u32 v89, v89, v15, v24
    v_max3_u32 v89, v89, v25, v26
    v_max3_u32 v89, v89, v27, v28
    v_max3_u32 v89, v89, v29, v30
    v_max3_u32 v89, v89, v31, v48
    v_max3_u32 v89, v89, v49, v50
    v_max3_u32 v89, v89, v51, v52
    v_max3_u32 v89, v89, v53, v54
    v_max3_u32 v89, v89, v55, v56
    v_max3_u32 v89, v89, v57, v58
    v_max_u32 v89, v89, v59
    v_cmp_eq_u32 vcc, -1, v89
    s_add_u32 s62, s62, 1
    s_cbranch_vccz F_h2_d
    s_cmp_lt_u32 s62, 200000
    s_cbranch_scc1 F_h2
    s_branch F_h2_d
F_zero:
    s_mov_b32 exec_lo, 0x01010101
    s_mov_b32 exec_hi, 0x01010101
    s_nop 2
    v_mov_b32 v92, 0
    v_mov_b32 v93, 0
    v_mov_b32 v94, 0
    v_mov_b32 v95, 0
    s_mov_b64 exec, -1
    s_branch F_nz
F_second:
    ds_read_b128 v[60:63], v126 offset:53760
    ds_read_b128 v[64:67], v126 offset:54784
    s_mov_b32 s46, 0
    s_mul_i32 s34, s44, 16640
    s_add_u32 s50, s50, 8320
    s_sub_u32 s50, s50, s34
    v_add_u32 v113, 1, v3
    v_bfe_i32 v113, v113, 4, 1
    v_and_b32 v113, 0xc2000000, v113
    v_xor_b32 v124, v113, v124
    v_xor_b32 v32, 0x80000000, v32
    v_xor_b32 v33, 0x80000000, v33
    v_xor_b32 v34, 0x80000000, v34
    v_xor_b32 v35, 0x80000000, v35
    v_xor_b32 v36, 0x80000000, v36
    v_xor_b32 v37, 0x80000000, v37
    v_xor_b32 v38, 0x80000000, v38
    v_xor_b32 v39, 0x80000000, v39
    v_mul_f32 v116, s70, v124
    v_fmac_f32 v116, v112, v124
    v_mfma_f32_16x16x32_bf16 v[76:79], v[8:11], v[32:35], 0
    v_mfma_f32_16x16x32_bf16 v[80:83], v[12:15], v[32:35], 0
    v_mfma_f32_16x16x32_bf16 v[84:87], v[8:11], v[36:39], 0
    v_mfma_f32_16x16x32_bf16 v[88:91], v[12:15], v[36:39], 0
    v_mfma_f32_16x16x32_bf16 v[92:95], v[16:19], v[32:35], 0
    v_mfma_f32_16x16x32_bf16 v[96:99], v[20:23], v[32:35], 0
    v_mfma_f32_16x16x32_bf16 v[100:103], v[16:19], v[36:39], 0
    v_mfma_f32_16x16x32_bf16 v[104:107], v[20:23], v[36:39], 0
    s_nop 2
    v_pk_mul_f32 v[84:85], v[84:85], s[54:55] op_sel:[0,0] op_sel_hi:[1,0]
    v_pk_mul_f32 v[86:87], v[86:87], s[54:55] op_sel:[0,0] op_sel_hi:[1,0]
    v_pk_mul_f32 v[88:89], v[88:89], s[54:55] op_sel:[0,0] op_sel_hi:[1,0]
    v_pk_mul_f32 v[90:91], v[90:91], s[54:55] op_sel:[0,0] op_sel_hi:[1,0]
    s_waitcnt lgkmcnt(0)
    s_barrier
    s_branch F_pass
F_key:
    v_mov_b32 v115, s33
    v_lshlrev_b32 v108, 11, v2
    s_lshl3_add_u32 s35, s2, 8192
    s_mov_b32 exec_lo, 0xff
    s_mov_b32 exec_hi, 0x0
    buffer_store_dwordx2 v[114:115], v108, s[24:27], s35 offen sc1
    s_mov_b64 exec, -1
    s_mov_b32 s71, 1
    s_branch F_nokey
F_wkey:
    s_waitcnt vmcnt(2)
    s_branch F_wkey_r
M_entry:
    s_sub_u32 s28, s2, 256
    s_lshr_b32 s29, s28, 1
    s_xor_b32 s29, s29, s28
    s_and_b32 s29, s29, 8
    s_mul_i32 s29, s29, 3
    s_xor_b32 s28, s28, s29
    s_lshr_b32 s29, s28, 4
    s_bfe_u32 s30, s28, 0x20001
    s_lshl2_add_u32 s29, s29, s30
    s_and_b32 s30, s28, 1
    s_lshl_b32 s30, s30, 1
    s_bitcmp1_b32 s28, 3
    s_addc_u32 s30, s30, 0
    s_setprio 3
    v_mov_b32 v7, 1152
    s_mov_b32 s26, 268435456
    s_mov_b32 s27, 0x20000
    v_mov_b32 v8, 0
    v_mov_b32 v9, 0
    v_mov_b32 v10, 0
    v_mov_b32 v11, 0
    v_mov_b32 v114, 0
    ds_write_b128 v7, v[8:11]
    ds_write_b128 v7, v[8:11] offset:16
    ds_write_b128 v7, v[8:11] offset:32
    v_mov_b32 v8, 0x3f803f80
    v_mov_b32 v9, 0x3f803f80
    v_lshlrev_b32 v10, 3, v2
    ds_write_b64 v10, v[8:9] offset:512
    s_waitcnt lgkmcnt(0)
    s_load_dword s16, s[10:11], 0
    s_mul_i32 s12, s3, 320
    s_min_u32 s12, s12, 2048
    s_add_u32 s18, s12, 7872
    s_and_b32 s13, s28, 7
    s_lshl_b32 s13, s13, 11
    s_add_u32 s12, s12, s13
    s_add_u32 s12, s12, 7872
    s_add_u32 s12, s10, s12
    s_addc_u32 s13, s11, 0
    s_barrier
    s_waitcnt lgkmcnt(0)
    s_mul_i32 s16, s16, 0x9e3779b1
    s_add_u32 s16, s16, 0x7f4a7c15
    s_mul_i32 s15, s16, 40
    s_mov_b32 s17, 0
    s_sub_u32 s31, s3, 2
    s_cmp_lt_u32 s31, 4
    s_cbranch_scc1 M_pre
    v_mov_b32 v8, 1152
    s_mov_b32 s62, 0
M_pg:
    ds_read_b32 v9, v8
    s_waitcnt lgkmcnt(0)
    v_cmp_gt_u32 vcc, 8, v9
    s_add_u32 s62, s62, 1
    s_cbranch_vccz M_pg_d
    s_sleep 1
    s_cmp_lt_u32 s62, 1000000
    s_cbranch_scc1 M_pg
M_pg_d:
    s_branch M_scan0
M_pre:
    s_and_b32 s46, s28, 7
    s_lshl2_add_u32 s6, s46, s31
    s_lshl_b32 s6, s6, 6
    s_lshr_b32 s44, s28, 3
    s_lshr_b32 s34, s31, 1
    s_lshl1_add_u32 s44, s44, s34
    s_lshl4_add_u32 s44, s44, s46
    s_and_b32 s34, s31, 1
    s_lshl1_add_u32 s44, s44, s34
    s_lshl_b32 s44, s44, 7
    v_lshrrev_b32 v114, 5, v2
    v_mul_u32_u24 v114, 0x4800, v114
    v_xor_b32 v114, s44, v114
    v_and_b32 v115, 31, v2
    v_lshl_add_u32 v114, v115, 2, v114
    s_mov_b32 s44, 262144
    s_lshl2_add_u32 s45, s29, s30
    s_lshl_b32 s45, s45, 10
    s_lshl_b32 s34, s31, 8
    s_add_u32 s45, s45, s34
    s_add_u32 s45, s45, 491520
    s_lshl_b32 s34, s31, 6
    v_lshl_add_u32 v113, v2, 2, s34
    s_mov_b32 s7, s45
    v_bfe_u32 v8, v2, 2, 2
    v_lshl_add_u32 v9, v4, 2, v8
    v_and_b32 v10, 7, v9
    v_lshlrev_b32 v10, 1, v10
    v_bfe_u32 v11, v2, 1, 1
    s_lshl_b32 s34, s31, 2
    v_or_b32 v12, s34, v11
    v_xor_b32 v12, v12, v10
    v_lshlrev_b32 v12, 4, v12
    v_lshl_add_u32 v12, v9, 8, v12
    v_and_b32 v13, 1, v2
    v_lshl_add_u32 v12, v13, 3, v12
    v_xor_b32 v126, 32, v12
    s_lshl_b32 s34, s31, 3
    v_or_b32 v120, s34, v11
    v_xor_b32 v120, v120, v10
    v_lshlrev_b32 v120, 4, v120
    v_lshl_add_u32 v120, v9, 9, v120
    v_lshl_add_u32 v120, v13, 3, v120
    v_xor_b32 v121, 32, v120
    v_xor_b32 v122, 64, v120
    v_xor_b32 v123, 96, v120
    v_lshlrev_b32 v14, 4, v4
    v_and_b32 v15, 1, v2
    v_lshl_add_u32 v15, v15, 9, v14
    v_mov_b32 v8, 1152
    s_mov_b32 s62, 0
M_wg6:
    ds_read_b32 v9, v8
    s_waitcnt lgkmcnt(0)
    v_cmp_gt_u32 vcc, 6, v9
    s_add_u32 s62, s62, 1
    s_cbranch_vccz M_wg6_d
    s_sleep 1
    s_cmp_lt_u32 s62, 1000000
    s_cbranch_scc1 M_wg6
M_wg6_d:
    ds_read_b64_tr_b16 v[16:17], v12 offset:1280
    ds_read_b64_tr_b16 v[18:19], v12 offset:5376
    ds_read_b64_tr_b16 v[32:33], v126 offset:1280
    ds_read_b64_tr_b16 v[34:35], v126 offset:5376
    ds_read_b64_tr_b16 v[20:21], v12 offset:9472
    ds_read_b64_tr_b16 v[22:23], v12 offset:13568
    ds_read_b64_tr_b16 v[36:37], v126 offset:9472
    ds_read_b64_tr_b16 v[38:39], v126 offset:13568
    ds_read_b64_tr_b16 v[24:25], v12 offset:17664
    ds_read_b64_tr_b16 v[26:27], v12 offset:21760
    ds_read_b64_tr_b16 v[40:41], v126 offset:17664
    ds_read_b64_tr_b16 v[42:43], v126 offset:21760
    v_mov_b32 v8, 1
    s_waitcnt lgkmcnt(0)
    s_mov_b64 exec, 1
    ds_add_u32 v7, v8 offset:4
    s_mov_b64 exec, -1
    v_mov_b32 v8, 1152
    s_mov_b32 s62, 0
M_wg:
    ds_read_b32 v9, v8
    s_waitcnt lgkmcnt(0)
    v_cmp_gt_u32 vcc, 8, v9
    s_add_u32 s62, s62, 1
    s_cbranch_vccz M_wg_d
    s_sleep 1
    s_cmp_lt_u32 s62, 1000000
    s_cbranch_scc1 M_wg
M_wg_d:
    ds_read_b64_tr_b16 v[28:29], v12 offset:25856
    ds_read_b64_tr_b16 v[30:31], v12 offset:29952
    ds_read_b64_tr_b16 v[44:45], v126 offset:25856
    ds_read_b64_tr_b16 v[46:47], v126 offset:29952
M_scan0:
    s_lshl_b32 s15, s16, 3
    s_mov_b32 s19, 0
    v_mov_b32 v10, 0
    s_load_dwordx16 s[20:35], s[12:13], 0
    s_load_dwordx16 s[36:51], s[12:13], 64
    s_load_dwordx16 s[52:67], s[12:13], 128
    s_load_dwordx16 s[68:83], s[12:13], 192
    s_load_dwordx16 s[84:99], s[12:13], 256
    v_mov_b32 v8, 1
    s_mov_b64 exec, 1
    s_waitcnt lgkmcnt(0)
    ds_add_u32 v7, v8 offset:24
    s_mov_b64 exec, -1
    s_branch M_scan1
M_scan:
    s_waitcnt lgkmcnt(0)
M_scan1:
    s_add_u32 s14, s21, s23
    s_add_u32 s14, s14, s25
    s_add_u32 s14, s14, s27
    s_add_u32 s14, s14, s29
    s_add_u32 s14, s14, s31
    s_add_u32 s14, s14, s33
    s_add_u32 s14, s14, s35
    s_cmp_lg_u32 s14, s15
    s_cbranch_scc1 M_sec0
    v_max_u32 v10, s20, v10
    v_max_u32 v10, s22, v10
    v_max_u32 v10, s24, v10
    v_max_u32 v10, s26, v10
    v_max_u32 v10, s28, v10
    v_max_u32 v10, s30, v10
    v_max_u32 v10, s32, v10
    v_max_u32 v10, s34, v10
    s_bitset1_b32 s19, 0
    s_mov_b32 s21, 0
M_sec0:
    s_add_u32 s14, s37, s39
    s_add_u32 s14, s14, s41
    s_add_u32 s14, s14, s43
    s_add_u32 s14, s14, s45
    s_add_u32 s14, s14, s47
    s_add_u32 s14, s14, s49
    s_add_u32 s14, s14, s51
    s_cmp_lg_u32 s14, s15
    s_cbranch_scc1 M_sec1
    v_max_u32 v10, s36, v10
    v_max_u32 v10, s38, v10
    v_max_u32 v10, s40, v10
    v_max_u32 v10, s42, v10
    v_max_u32 v10, s44, v10
    v_max_u32 v10, s46, v10
    v_max_u32 v10, s48, v10
    v_max_u32 v10, s50, v10
    s_bitset1_b32 s19, 1
    s_mov_b32 s37, 0
M_sec1:
    s_add_u32 s14, s53, s55
    s_add_u32 s14, s14, s57
    s_add_u32 s14, s14, s59
    s_add_u32 s14, s14, s61
    s_add_u32 s14, s14, s63
    s_add_u32 s14, s14, s65
    s_add_u32 s14, s14, s67
    s_cmp_lg_u32 s14, s15
    s_cbranch_scc1 M_sec2
    v_max_u32 v10, s52, v10
    v_max_u32 v10, s54, v10
    v_max_u32 v10, s56, v10
    v_max_u32 v10, s58, v10
    v_max_u32 v10, s60, v10
    v_max_u32 v10, s62, v10
    v_max_u32 v10, s64, v10
    v_max_u32 v10, s66, v10
    s_bitset1_b32 s19, 2
    s_mov_b32 s53, 0
M_sec2:
    s_add_u32 s14, s69, s71
    s_add_u32 s14, s14, s73
    s_add_u32 s14, s14, s75
    s_add_u32 s14, s14, s77
    s_add_u32 s14, s14, s79
    s_add_u32 s14, s14, s81
    s_add_u32 s14, s14, s83
    s_cmp_lg_u32 s14, s15
    s_cbranch_scc1 M_sec3
    v_max_u32 v10, s68, v10
    v_max_u32 v10, s70, v10
    v_max_u32 v10, s72, v10
    v_max_u32 v10, s74, v10
    v_max_u32 v10, s76, v10
    v_max_u32 v10, s78, v10
    v_max_u32 v10, s80, v10
    v_max_u32 v10, s82, v10
    s_bitset1_b32 s19, 3
    s_mov_b32 s69, 0
M_sec3:
    s_add_u32 s14, s85, s87
    s_add_u32 s14, s14, s89
    s_add_u32 s14, s14, s91
    s_add_u32 s14, s14, s93
    s_add_u32 s14, s14, s95
    s_add_u32 s14, s14, s97
    s_add_u32 s14, s14, s99
    s_cmp_lg_u32 s14, s15
    s_cbranch_scc1 M_sec4
    v_max_u32 v10, s84, v10
    v_max_u32 v10, s86, v10
    v_max_u32 v10, s88, v10
    v_max_u32 v10, s90, v10
    v_max_u32 v10, s92, v10
    v_max_u32 v10, s94, v10
    v_max_u32 v10, s96, v10
    v_max_u32 v10, s98, v10
    s_bitset1_b32 s19, 4
    s_mov_b32 s85, 0
M_sec4:
    s_cmp_eq_u32 s19, 31
    s_cbranch_scc1 M_scan_d
    s_add_u32 s17, s17, 1
    s_add_u32 s14, s2, s17
    s_and_b32 s14, s14, 7
    s_lshl_b32 s14, s14, 11
    s_add_u32 s14, s14, s18
    s_add_u32 s12, s10, s14
    s_addc_u32 s13, s11, 0
    s_sleep 2
    s_cmp_ge_u32 s17, 8
    s_cbranch_scc1 M_scan_u
    s_bitcmp1_b32 s19, 0
    s_cbranch_scc1 M_rla0
    s_load_dwordx16 s[20:35], s[12:13], 0
M_rla0:
    s_bitcmp1_b32 s19, 1
    s_cbranch_scc1 M_rla1
    s_load_dwordx16 s[36:51], s[12:13], 64
M_rla1:
    s_bitcmp1_b32 s19, 2
    s_cbranch_scc1 M_rla2
    s_load_dwordx16 s[52:67], s[12:13], 128
M_rla2:
    s_bitcmp1_b32 s19, 3
    s_cbranch_scc1 M_rla3
    s_load_dwordx16 s[68:83], s[12:13], 192
M_rla3:
    s_bitcmp1_b32 s19, 4
    s_cbranch_scc1 M_rla4
    s_load_dwordx16 s[84:99], s[12:13], 256
M_rla4:
    s_branch M_scan
M_scan_u:
    s_bitcmp1_b32 s19, 0
    s_cbranch_scc1 M_rlb0
    s_load_dwordx16 s[20:35], s[12:13], 0 glc
M_rlb0:
    s_bitcmp1_b32 s19, 1
    s_cbranch_scc1 M_rlb1
    s_load_dwordx16 s[36:51], s[12:13], 64 glc
M_rlb1:
    s_bitcmp1_b32 s19, 2
    s_cbranch_scc1 M_rlb2
    s_load_dwordx16 s[52:67], s[12:13], 128 glc
M_rlb2:
    s_bitcmp1_b32 s19, 3
    s_cbranch_scc1 M_rlb3
    s_load_dwordx16 s[68:83], s[12:13], 192 glc
M_rlb3:
    s_bitcmp1_b32 s19, 4
    s_cbranch_scc1 M_rlb4
    s_load_dwordx16 s[84:99], s[12:13], 256 glc
M_rlb4:
    s_cmp_lt_u32 s17, 200000
    s_cbranch_scc1 M_scan
    s_waitcnt lgkmcnt(0)
M_scan_d:
    v_mov_b32 v8, 1
    s_mov_b64 exec, 1
    ds_max_u32 v7, v10 offset:16
    ds_add_u32 v7, v8 offset:20
    s_mov_b64 exec, -1
    s_sub_u32 s31, s3, 2
    s_cmp_lt_u32 s31, 4
    s_cbranch_scc1 M_comp
    s_mov_b32 s33, s16
    s_sub_u32 s28, s2, 256
    s_lshr_b32 s29, s28, 1
    s_xor_b32 s29, s29, s28
    s_and_b32 s29, s29, 8
    s_mul_i32 s29, s29, 3
    s_xor_b32 s28, s28, s29
    s_lshr_b32 s29, s28, 4
    s_bfe_u32 s30, s28, 0x20001
    s_lshl2_add_u32 s29, s29, s30
    s_and_b32 s30, s28, 1
    s_lshl_b32 s30, s30, 1
    s_bitcmp1_b32 s28, 3
    s_addc_u32 s30, s30, 0
    s_mov_b64 s[24:25], s[10:11]
    s_mov_b32 s26, 268435456
    s_mov_b32 s27, 0x20000
    s_cmp_ge_u32 s3, 6
    s_cbranch_scc1 M_agent
    s_cmp_ge_u32 s3, 6
    s_cbranch_scc1 L_fin
    s_cmp_eq_u32 s3, 1
    s_branch M_poller
M_agent:
    s_and_b32 s47, s28, 7
    s_lshl_b32 s47, s47, 8
    s_mov_b32 s49, 0
    s_mov_b32 s62, 0
M_ag:
    ds_read_b64 v[8:9], v7 offset:16
    s_waitcnt lgkmcnt(0)
    v_readfirstlane_b32 s48, v8
    v_readfirstlane_b32 s46, v9
    s_nop 0
    s_cmp_ge_u32 s46, 7
    s_cbranch_scc1 L_fin
    s_cmp_eq_u32 s48, s49
    s_cbranch_scc1 M_ag_n
    s_mov_b32 s49, s48
    s_and_b32 s34, s48, 2047
    s_lshl_b32 s34, s34, 11
    s_add_u32 s34, s34, s47
    s_load_dword s54, s[4:5], s34
    s_add_u32 s34, s34, 64
    s_load_dword s55, s[4:5], s34
    s_add_u32 s34, s34, 64
    s_load_dword s56, s[4:5], s34
    s_add_u32 s34, s34, 64
    s_load_dword s57, s[4:5], s34
    s_and_b32 s50, s48, 7
    s_bfe_u32 s34, s48, 0x40003
    s_lshl4_add_u32 s50, s50, s34
    s_bfe_u32 s34, s48, 0x40007
    s_lshl4_add_u32 s50, s50, s34
    s_lshl3_add_u32 s50, s50, 24576
    s_load_dwordx2 s[52:53], s[10:11], s50
M_ag_n:
    s_add_u32 s62, s62, 1
    s_cmp_lt_u32 s62, 1000000
    s_cbranch_scc1 M_ag
    s_branch L_fin
M_loader2:
    v_mov_b32 v7, 1152
    s_mov_b32 s26, 268435456
    s_mov_b32 s27, 0x20000
    v_xor_b32 v18, 128, v8
    s_lshr_b32 s29, s28, 4
    s_bfe_u32 s30, s28, 0x20001
    s_lshl2_add_u32 s29, s29, s30
    s_and_b32 s30, s28, 1
    s_lshl_b32 s30, s30, 1
    s_bitcmp1_b32 s28, 3
    s_addc_u32 s30, s30, 0
    s_mov_b64 s[24:25], s[10:11]
    s_mov_b32 s16, s40
    s_and_b32 s17, s41, 0xffff
    s_mov_b32 s18, 7340032
    s_mov_b32 s19, 0x20000
    s_mov_b32 s47, 3
    s_barrier
M_ld3:
    s_mov_b32 m0, s46
    s_add_u32 s46, s46, 1024
    buffer_load_dwordx4 v8, s[12:15], s45 offen nt lds
    s_add_u32 s45, s45, 28672
    s_waitcnt vmcnt(12)
    s_mov_b32 m0, s46
    s_add_u32 s46, s46, 1024
    buffer_load_dwordx4 v18, s[12:15], s45 offen nt lds
    s_add_u32 s45, s45, 28672
    s_waitcnt vmcnt(12)
    s_mov_b32 m0, s46
    s_add_u32 s46, s46, 1024
    buffer_load_dwordx4 v8, s[12:15], s45 offen nt lds
    s_add_u32 s45, s45, 28672
    s_waitcnt vmcnt(12)
    s_mov_b32 m0, s46
    s_add_u32 s46, s46, 1024
    buffer_load_dwordx4 v18, s[12:15], s45 offen nt lds
    s_add_u32 s45, s45, 28672
    s_waitcnt vmcnt(12)
    s_add_u32 s47, s47, 1
    s_getreg_b32 s35, hwreg(HW_REG_IB_STS)
    s_bfe_u32 s48, s35, 0x20016
    s_and_b32 s35, s35, 15
    s_lshl4_add_u32 s35, s48, s35
    s_add_u32 s35, s35, 3
    s_lshr_b32 s35, s35, 2
    s_sub_u32 s35, s47, s35
    v_mov_b32 v16, s35
    s_mov_b64 exec, 1
    ds_max_i32 v7, v16
    s_mov_b64 exec, -1
    s_cmp_lt_u32 s47, 5
    s_cbranch_scc1 M_ld3
M_ld5:
    s_mov_b32 m0, s46
    s_add_u32 s46, s46, 1024
    buffer_load_dwordx4 v8, s[12:15], s45 offen nt lds
    s_add_u32 s45, s45, 28672
    s_waitcnt vmcnt(28)
    s_mov_b32 m0, s46
    s_add_u32 s46, s46, 1024
    buffer_load_dwordx4 v18, s[12:15], s45 offen nt lds
    s_add_u32 s45, s45, 28672
    s_waitcnt vmcnt(28)
    s_mov_b32 m0, s46
    s_add_u32 s46, s46, 1024
    buffer_load_dwordx4 v8, s[12:15], s45 offen nt lds
    s_add_u32 s45, s45, 28672
    s_waitcnt vmcnt(28)
    s_mov_b32 m0, s46
    s_add_u32 s46, s46, 1024
    buffer_load_dwordx4 v18, s[12:15], s45 offen nt lds
    s_add_u32 s45, s45, 28672
    s_waitcnt vmcnt(28)
    s_add_u32 s47, s47, 1
    s_getreg_b32 s35, hwreg(HW_REG_IB_STS)
    s_bfe_u32 s48, s35, 0x20016
    s_and_b32 s35, s35, 15
    s_lshl4_add_u32 s35, s48, s35
    s_add_u32 s35, s35, 3
    s_lshr_b32 s35, s35, 2
    s_sub_u32 s35, s47, s35
    v_mov_b32 v16, s35
    s_mov_b64 exec, 1
    ds_max_i32 v7, v16
    s_mov_b64 exec, -1
    s_cmp_lt_u32 s47, 8
    s_cbranch_scc1 M_ld5
    s_mov_b32 s20, s42
    s_and_b32 s21, s43, 0xffff
    s_mov_b32 s22, 7340032
    s_mov_b32 s23, 0x20000
    v_lshrrev_b32 v9, 5, v2
    v_and_b32 v10, 31, v2
    v_add_u32 v11, 0, v9
    v_lshlrev_b32 v12, 1, v11
    v_xor_b32 v12, v12, v10
    v_lshlrev_b32 v12, 4, v12
    v_lshl_add_u32 v12, v11, 11, v12
    v_add_u32 v11, 2, v9
    v_lshlrev_b32 v13, 1, v11
    v_xor_b32 v13, v13, v10
    v_lshlrev_b32 v13, 4, v13
    v_lshl_add_u32 v13, v11, 11, v13
    v_add_u32 v11, 4, v9
    v_lshlrev_b32 v14, 1, v11
    v_xor_b32 v14, v14, v10
    v_lshlrev_b32 v14, 4, v14
    v_lshl_add_u32 v14, v11, 11, v14
    v_add_u32 v11, 6, v9
    v_lshlrev_b32 v15, 1, v11
    v_xor_b32 v15, v15, v10
    v_lshlrev_b32 v15, 4, v15
    v_lshl_add_u32 v15, v11, 11, v15
    s_lshl_b32 s44, s29, 17
    s_lshl_b32 s35, s30, 9
    s_add_u32 s44, s44, s35
    s_mov_b32 s46, 34048
    s_xor_b32 s45, s34, 512
M_ld8:
    s_mov_b32 m0, s46
    s_add_u32 s46, s46, 1024
    buffer_load_dwordx4 v8, s[16:19], s45 offen nt lds
    s_add_u32 s45, s45, 28672
    s_waitcnt vmcnt(28)
    s_mov_b32 m0, s46
    s_add_u32 s46, s46, 1024
    buffer_load_dwordx4 v18, s[16:19], s45 offen nt lds
    s_add_u32 s45, s45, 28672
    s_waitcnt vmcnt(28)
    s_mov_b32 m0, s46
    s_add_u32 s46, s46, 1024
    buffer_load_dwordx4 v8, s[16:19], s45 offen nt lds
    s_add_u32 s45, s45, 28672
    s_waitcnt vmcnt(28)
    s_mov_b32 m0, s46
    s_add_u32 s46, s46, 1024
    buffer_load_dwordx4 v18, s[16:19], s45 offen nt lds
    s_add_u32 s45, s45, 28672
    s_waitcnt vmcnt(28)
    s_add_u32 s47, s47, 1
    s_getreg_b32 s35, hwreg(HW_REG_IB_STS)
    s_bfe_u32 s48, s35, 0x20016
    s_and_b32 s35, s35, 15
    s_lshl4_add_u32 s35, s48, s35
    s_add_u32 s35, s35, 3
    s_lshr_b32 s35, s35, 2
    s_sub_u32 s35, s47, s35
    v_mov_b32 v16, s35
    s_mov_b64 exec, 1
    ds_max_i32 v7, v16
    s_mov_b64 exec, -1
    s_cmp_lt_u32 s47, 16
    s_cbranch_scc1 M_ld8
    v_mov_b32 v20, 1156
    s_mov_b32 s62, 0
M_wgc:
    ds_read_b32 v21, v20
    s_waitcnt lgkmcnt(0)
    v_cmp_gt_u32 vcc, 4, v21
    s_add_u32 s62, s62, 1
    s_cbranch_vccz M_wgc_d
    s_sleep 1
    s_cmp_lt_u32 s62, 1000000
    s_cbranch_scc1 M_wgc
M_wgc_d:
    s_mov_b32 s46, 1280
M_ld16:
    s_mov_b32 m0, s46
    s_add_u32 s46, s46, 1024
    buffer_load_dwordx4 v12, s[20:23], s44 offen nt lds
    s_waitcnt vmcnt(28)
    s_mov_b32 m0, s46
    s_add_u32 s46, s46, 1024
    buffer_load_dwordx4 v13, s[20:23], s44 offen nt lds
    s_waitcnt vmcnt(28)
    s_mov_b32 m0, s46
    s_add_u32 s46, s46, 1024
    buffer_load_dwordx4 v14, s[20:23], s44 offen nt lds
    s_waitcnt vmcnt(28)
    s_mov_b32 m0, s46
    s_add_u32 s46, s46, 1024
    buffer_load_dwordx4 v15, s[20:23], s44 offen nt lds
    s_waitcnt vmcnt(28)
    s_add_u32 s44, s44, 16384
    s_add_u32 s47, s47, 1
    s_getreg_b32 s35, hwreg(HW_REG_IB_STS)
    s_bfe_u32 s48, s35, 0x20016
    s_and_b32 s35, s35, 15
    s_lshl4_add_u32 s35, s48, s35
    s_add_u32 s35, s35, 3
    s_lshr_b32 s35, s35, 2
    s_sub_u32 s35, s47, s35
    v_mov_b32 v16, s35
    s_mov_b64 exec, 1
    ds_max_i32 v7, v16
    s_mov_b64 exec, -1
    s_cmp_lt_u32 s47, 22
    s_cbranch_scc1 M_ld16
    v_mov_b32 v20, 1176
    s_mov_b32 s62, 0
M_wgd:
    ds_read_b32 v21, v20
    s_waitcnt lgkmcnt(0)
    v_cmp_gt_u32 vcc, 7, v21
    s_add_u32 s62, s62, 1
    s_cbranch_vccz M_wgd_d
    s_sleep 1
    s_cmp_lt_u32 s62, 1000000
    s_cbranch_scc1 M_wgd
M_wgd_d:
M_ld22:
    s_mov_b32 m0, s46
    s_add_u32 s46, s46, 1024
    buffer_load_dwordx4 v12, s[20:23], s44 offen nt lds
    s_waitcnt vmcnt(28)
    s_mov_b32 m0, s46
    s_add_u32 s46, s46, 1024
    buffer_load_dwordx4 v13, s[20:23], s44 offen nt lds
    s_waitcnt vmcnt(28)
    s_mov_b32 m0, s46
    s_add_u32 s46, s46, 1024
    buffer_load_dwordx4 v14, s[20:23], s44 offen nt lds
    s_waitcnt vmcnt(28)
    s_mov_b32 m0, s46
    s_add_u32 s46, s46, 1024
    buffer_load_dwordx4 v15, s[20:23], s44 offen nt lds
    s_waitcnt vmcnt(28)
    s_add_u32 s44, s44, 16384
    s_add_u32 s47, s47, 1
    s_getreg_b32 s35, hwreg(HW_REG_IB_STS)
    s_bfe_u32 s48, s35, 0x20016
    s_and_b32 s35, s35, 15
    s_lshl4_add_u32 s35, s48, s35
    s_add_u32 s35, s35, 3
    s_lshr_b32 s35, s35, 2
    s_sub_u32 s35, s47, s35
    v_mov_b32 v16, s35
    s_mov_b64 exec, 1
    ds_max_i32 v7, v16
    s_mov_b64 exec, -1
    s_cmp_lt_u32 s47, 24
    s_cbranch_scc1 M_ld22
    s_mov_b64 exec, 1
    v_mov_b32 v16, 18
    s_waitcnt vmcnt(24)
    ds_max_i32 v7, v16
    v_mov_b32 v16, 19
    s_waitcnt vmcnt(20)
    ds_max_i32 v7, v16
    v_mov_b32 v16, 20
    s_waitcnt vmcnt(16)
    ds_max_i32 v7, v16
    v_mov_b32 v16, 21
    s_waitcnt vmcnt(12)
    ds_max_i32 v7, v16
    v_mov_b32 v16, 22
    s_waitcnt vmcnt(8)
    ds_max_i32 v7, v16
    v_mov_b32 v16, 23
    s_waitcnt vmcnt(4)
    ds_max_i32 v7, v16
    v_mov_b32 v16, 24
    s_waitcnt vmcnt(0)
    ds_write_b32 v7, v16
    s_waitcnt lgkmcnt(0)
    s_barrier
    s_branch L_fin
M_comp:
    s_mov_b32 s62, 0
M_box:
    ds_read_b64 v[8:9], v7 offset:16
    s_waitcnt lgkmcnt(0)
    v_cmp_gt_u32 vcc, 7, v9
    s_add_u32 s62, s62, 1
    s_cbranch_vccz M_box_d
    s_cmp_lt_u32 s62, 1000000
    s_cbranch_scc1 M_box
M_box_d:
    v_readfirstlane_b32 s48, v8
    s_nop 0
    s_and_b32 s34, s48, 2047
    s_lshl_b32 s34, s34, 11
    s_add_u32 s34, s34, s6
    s_load_dwordx16 s[64:79], s[4:5], s34
    s_and_b32 s50, s48, 7
    s_bfe_u32 s34, s48, 0x40003
    s_lshl4_add_u32 s50, s50, s34
    s_bfe_u32 s34, s48, 0x40007
    s_lshl4_add_u32 s50, s50, s34
    s_lshl3_add_u32 s50, s50, 24576
    s_load_dwordx2 s[52:53], s[10:11], s50
    s_mov_b32 s33, s16
    s_mov_b64 s[24:25], s[10:11]
    s_mov_b32 s26, 268435456
    s_mov_b32 s27, 0x20000
    s_mov_b32 s44, 262144
    s_mov_b32 s45, s7
    v_mov_b32 v8, 1
    s_waitcnt lgkmcnt(0)
    v_writelane_b32 v11, s64, 0
    v_writelane_b32 v11, s65, 1
    v_writelane_b32 v11, s66, 4
    v_writelane_b32 v11, s67, 5
    v_writelane_b32 v11, s68, 8
    v_writelane_b32 v11, s69, 9
    v_writelane_b32 v11, s70, 12
    v_writelane_b32 v11, s71, 13
    v_writelane_b32 v11, s72, 2
    v_writelane_b32 v11, s73, 3
    v_writelane_b32 v11, s74, 6
    v_writelane_b32 v11, s75, 7
    v_writelane_b32 v11, s76, 10
    v_writelane_b32 v11, s77, 11
    v_writelane_b32 v11, s78, 14
    v_writelane_b32 v11, s79, 15
    s_mov_b64 exec, 0xffff
    ds_write_b32 v113, v11 offset:0
    s_mov_b64 exec, 1
    ds_add_u32 v7, v8 offset:8
    s_mov_b64 exec, -1
    s_mov_b32 s62, 0
M_wx:
    ds_read_b128 v[8:11], v7
    s_waitcnt lgkmcnt(0)
    v_cmp_gt_u32 vcc, 4, v10
    s_add_u32 s62, s62, 1
    s_cbranch_vccz M_wx_d
    s_cmp_lt_u32 s62, 1000000
    s_cbranch_scc1 M_wx
M_wx_d:
    ds_read_b128 v[80:83], v15 offset:0
    ds_read_b128 v[84:87], v15 offset:64
    ds_read_b128 v[88:91], v15 offset:128
    ds_read_b128 v[92:95], v15 offset:192
    v_readfirstlane_b32 s56, v8
    s_nop 0
    s_cmp_ge_u32 s56, 10
    s_cbranch_scc1 M_wu0_k
    s_mov_b32 s62, 0
M_wu0:
    ds_read_b32 v8, v7
    s_waitcnt lgkmcnt(0)
    v_cmp_gt_u32 vcc, 10, v8
    s_add_u32 s62, s62, 1
    s_cbranch_vccz M_wu0_d
    s_sleep 1
    s_cmp_lt_u32 s62, 1000000
    s_cbranch_scc1 M_wu0
M_wu0_d:
    v_readfirstlane_b32 s56, v8
M_wu0_k:
    ds_read_b64_tr_b16 v[48:49], v12 offset:34048
    ds_read_b64_tr_b16 v[50:51], v12 offset:38144
    ds_read_b64_tr_b16 v[64:65], v126 offset:34048
    ds_read_b64_tr_b16 v[66:67], v126 offset:38144
    s_waitcnt lgkmcnt(4)
    v_mfma_f32_16x16x32_bf16 v[96:99], v[80:83], v[16:19], 0
    v_mfma_f32_16x16x32_bf16 v[104:107], v[80:83], v[32:35], 0
    v_mfma_f32_16x16x32_bf16 v[96:99], v[84:87], v[20:23], v[96:99]
    v_mfma_f32_16x16x32_bf16 v[104:107], v[84:87], v[36:39], v[104:107]
    v_mfma_f32_16x16x32_bf16 v[96:99], v[88:91], v[24:27], v[96:99]
    v_mfma_f32_16x16x32_bf16 v[104:107], v[88:91], v[40:43], v[104:107]
    v_mfma_f32_16x16x32_bf16 v[96:99], v[92:95], v[28:31], v[96:99]
    v_mfma_f32_16x16x32_bf16 v[104:107], v[92:95], v[44:47], v[104:107]
    s_mov_b32 s62, 0
M_sta:
    s_cmp_eq_u32 s53, s33
    s_cbranch_scc1 M_sta_d
    s_load_dwordx2 s[52:53], s[10:11], s50 glc
    s_add_u32 s62, s62, 1
    s_cmp_lt_u32 s62, 200000
    s_waitcnt lgkmcnt(0)
    s_cbranch_scc1 M_sta
M_sta_d:
    s_lshl_b32 s54, s52, 16
    s_and_b32 s52, s52, 0xffff0000
    v_mov_b32 v124, 0x3727c5ac
    v_add_f32 v124, s52, v124
    v_cvt_pk_bf16_f32 v124, v124, v124
    v_lshlrev_b32 v124, 16, v124
    v_sqrt_f32 v124, v124
    s_nop 0
    v_cvt_pk_bf16_f32 v124, v124, v124
    v_lshlrev_b32 v124, 16, v124
    v_rcp_f32 v124, v124
    s_cmp_ge_u32 s56, 12
    s_cbranch_scc1 M_wu1_k
    s_mov_b32 s62, 0
M_wu1:
    ds_read_b32 v8, v7
    s_waitcnt lgkmcnt(0)
    v_cmp_gt_u32 vcc, 12, v8
    s_add_u32 s62, s62, 1
    s_cbranch_vccz M_wu1_d
    s_sleep 1
    s_cmp_lt_u32 s62, 1000000
    s_cbranch_scc1 M_wu1
M_wu1_d:
    v_readfirstlane_b32 s56, v8
M_wu1_k:
    ds_read_b64_tr_b16 v[52:53], v12 offset:42240
    ds_read_b64_tr_b16 v[54:55], v12 offset:46336
    ds_read_b64_tr_b16 v[68:69], v126 offset:42240
    ds_read_b64_tr_b16 v[70:71], v126 offset:46336
    s_waitcnt lgkmcnt(4)
    v_mfma_f32_16x16x32_bf16 v[100:103], v[80:83], v[48:51], 0
    v_mfma_f32_16x16x32_bf16 v[108:111], v[80:83], v[64:67], 0
    s_cmp_ge_u32 s56, 14
    s_cbranch_scc1 M_wu2_k
    s_mov_b32 s62, 0
M_wu2:
    ds_read_b32 v8, v7
    s_waitcnt lgkmcnt(0)
    v_cmp_gt_u32 vcc, 14, v8
    s_add_u32 s62, s62, 1
    s_cbranch_vccz M_wu2_d
    s_sleep 1
    s_cmp_lt_u32 s62, 1000000
    s_cbranch_scc1 M_wu2
M_wu2_d:
    v_readfirstlane_b32 s56, v8
M_wu2_k:
    ds_read_b64_tr_b16 v[56:57], v12 offset:50432
    ds_read_b64_tr_b16 v[58:59], v12 offset:54528
    ds_read_b64_tr_b16 v[72:73], v126 offset:50432
    ds_read_b64_tr_b16 v[74:75], v126 offset:54528
    s_waitcnt lgkmcnt(4)
    v_mfma_f32_16x16x32_bf16 v[100:103], v[84:87], v[52:55], v[100:103]
    v_mfma_f32_16x16x32_bf16 v[108:111], v[84:87], v[68:71], v[108:111]
    s_cmp_ge_u32 s56, 16
    s_cbranch_scc1 M_wu3_k
    s_mov_b32 s62, 0
M_wu3:
    ds_read_b32 v8, v7
    s_waitcnt lgkmcnt(0)
    v_cmp_gt_u32 vcc, 16, v8
    s_add_u32 s62, s62, 1
    s_cbranch_vccz M_wu3_d
    s_cmp_lt_u32 s62, 1000000
    s_cbranch_scc1 M_wu3
M_wu3_d:
    v_readfirstlane_b32 s56, v8
M_wu3_k:
    ds_read_b64_tr_b16 v[60:61], v12 offset:58624
    ds_read_b64_tr_b16 v[62:63], v12 offset:62720
    ds_read_b64_tr_b16 v[76:77], v126 offset:58624
    ds_read_b64_tr_b16 v[78:79], v126 offset:62720
    s_waitcnt lgkmcnt(4)
    v_mfma_f32_16x16x32_bf16 v[100:103], v[88:91], v[56:59], v[100:103]
    v_mfma_f32_16x16x32_bf16 v[108:111], v[88:91], v[72:75], v[108:111]
    s_waitcnt lgkmcnt(2)
    v_mfma_f32_16x16x32_bf16 v[100:103], v[92:95], v[60:63], v[100:103]
    s_waitcnt lgkmcnt(0)
    v_mfma_f32_16x16x32_bf16 v[108:111], v[92:95], v[76:79], v[108:111]
    v_mov_b32 v9, 1
    v_mov_b32_dpp v96, v104 quad_perm:[0,1,2,3] row_mask:0x2 bank_mask:0xf
    v_mov_b32_dpp v97, v105 quad_perm:[0,1,2,3] row_mask:0x2 bank_mask:0xf
    s_nop 2
    v_mov_b32_dpp v96, v100 quad_perm:[0,1,2,3] row_mask:0x4 bank_mask:0xf
    v_mov_b32_dpp v97, v101 quad_perm:[0,1,2,3] row_mask:0x4 bank_mask:0xf
    s_nop 0
    v_mov_b32_dpp v96, v108 quad_perm:[0,1,2,3] row_mask:0x8 bank_mask:0xf
    v_mov_b32_dpp v97, v109 quad_perm:[0,1,2,3] row_mask:0x8 bank_mask:0xf
    v_fma_f32 v96, -v97, s54, v96
    v_mul_f32 v96, v96, v124
    buffer_store_dword v96, v114, s[24:27], s44 offen sc1
    s_mov_b64 exec, 1
    ds_add_u32 v7, v9 offset:12
    s_mov_b64 exec, -1
    v_mov_b32 v8, 1152
    s_mov_b32 s62, 0
M_wd0:
    ds_read_b32 v9, v8
    s_waitcnt lgkmcnt(0)
    v_cmp_gt_u32 vcc, 20, v9
    s_add_u32 s62, s62, 1
    s_cbranch_vccz M_wd0_d
    s_sleep 1
    s_cmp_lt_u32 s62, 1000000
    s_cbranch_scc1 M_wd0
M_wd0_d:
    ds_read_b64_tr_b16 v[16:17], v120 offset:1280
    ds_read_b64_tr_b16 v[18:19], v120 offset:9472
    ds_read_b64_tr_b16 v[24:25], v121 offset:1280
    ds_read_b64_tr_b16 v[26:27], v121 offset:9472
    ds_read_b64_tr_b16 v[32:33], v122 offset:1280
    ds_read_b64_tr_b16 v[34:35], v122 offset:9472
    ds_read_b64_tr_b16 v[40:41], v123 offset:1280
    ds_read_b64_tr_b16 v[42:43], v123 offset:9472
    v_mov_b32 v8, 1152
    s_mov_b32 s62, 0
M_wd1:
    ds_read_b32 v9, v8
    s_waitcnt lgkmcnt(0)
    v_cmp_gt_u32 vcc, 24, v9
    s_add_u32 s62, s62, 1
    s_cbranch_vccz M_wd1_d
    s_cmp_lt_u32 s62, 1000000
    s_cbranch_scc1 M_wd1
M_wd1_d:
    ds_read_b64_tr_b16 v[20:21], v120 offset:17664
    ds_read_b64_tr_b16 v[22:23], v120 offset:25856
    ds_read_b64_tr_b16 v[28:29], v121 offset:17664
    ds_read_b64_tr_b16 v[30:31], v121 offset:25856
    ds_read_b64_tr_b16 v[36:37], v122 offset:17664
    ds_read_b64_tr_b16 v[38:39], v122 offset:25856
    ds_read_b64_tr_b16 v[44:45], v123 offset:17664
    s_waitcnt lgkmcnt(4)
    ds_read_b64_tr_b16 v[46:47], v123 offset:25856
    v_lshlrev_b32 v8, 2, v2
    s_waitcnt lgkmcnt(0)
    s_barrier
    ds_read_b128 v[80:83], v14 offset:1024
    ds_read_b128 v[84:87], v14 offset:1088
    s_waitcnt lgkmcnt(1)
    v_mfma_f32_16x16x32_bf16 v[48:51], v[80:83], v[16:19], 0
    v_mfma_f32_16x16x32_bf16 v[52:55], v[80:83], v[24:27], 0
    v_mfma_f32_16x16x32_bf16 v[56:59], v[80:83], v[32:35], 0
    v_mfma_f32_16x16x32_bf16 v[60:63], v[80:83], v[40:43], 0
    s_waitcnt lgkmcnt(0)
    v_mfma_f32_16x16x32_bf16 v[48:51], v[84:87], v[20:23], v[48:51]
    v_mfma_f32_16x16x32_bf16 v[52:55], v[84:87], v[28:31], v[52:55]
    v_mfma_f32_16x16x32_bf16 v[56:59], v[84:87], v[36:39], v[56:59]
    v_mfma_f32_16x16x32_bf16 v[60:63], v[84:87], v[44:47], v[60:63]
    s_nop 5
    v_mov_b32_dpp v48, v52 quad_perm:[0,1,2,3] row_mask:0x2 bank_mask:0xf
    s_nop 1
    v_mov_b32_dpp v48, v56 quad_perm:[0,1,2,3] row_mask:0x4 bank_mask:0xf
    s_nop 1
    v_mov_b32_dpp v48, v60 quad_perm:[0,1,2,3] row_mask:0x8 bank_mask:0xf
    buffer_store_dword v48, v8, s[24:27], s45 offen sc1
    s_branch L_fin
M_poller:
    s_cmp_ge_u32 s28, 64
    s_cbranch_scc1 M_nores
    s_mov_b32 s62, 0
M_pbox:
    ds_read_b64 v[8:9], v7 offset:16
    s_waitcnt lgkmcnt(0)
    v_cmp_gt_u32 vcc, 7, v9
    s_add_u32 s62, s62, 1
    s_cbranch_vccz M_pbox_d
    s_cmp_lt_u32 s62, 1000000
    s_cbranch_scc1 M_pbox
M_pbox_d:
    v_readfirstlane_b32 s48, v8
    v_mov_b32 v9, s33
    v_mov_b32 v10, 0
    s_lshr_b32 s34, s28, 5
    s_add_u32 s34, s34, s28
    s_and_b32 s34, s34, 31
    s_lshl_b32 s34, s34, 7
    s_add_u32 s34, s34, 4096
    s_mov_b64 exec, 1
    buffer_store_dwordx2 v[8:9], v10, s[24:27], s34 offen sc1
    s_mov_b64 exec, -1
M_nores:
    v_lshlrev_b32 v9, 4, v2
    v_and_b32 v12, 8, v2
    v_lshl_add_u32 v12, v12, 2, v4
    v_and_b32 v11, 3, v2
    v_lshl_add_u32 v12, v11, 3, v12
    v_and_b32 v11, 4, v2
    v_add_lshl_u32 v12, v12, v11, 1
    s_lshl_b32 s44, s29, 12
    s_add_u32 s44, s44, 262144
    s_lshl2_add_u32 s46, s29, s30
    s_lshl_b32 s46, s46, 7
    s_add_u32 s46, s46, 720896
    s_lshl_b32 s47, s33, 4
    s_lshr_b32 s35, s28, 3
    s_cmp_ge_u32 s35, 14
    s_cselect_b32 s34, 18, 0
    s_add_u32 s35, s35, s34
    s_and_b32 s34, s28, 7
    s_lshl_b32 s34, s34, 8
    s_add_u32 s34, s34, s35
    s_lshl2_add_u32 s55, s34, 753664
    v_lshlrev_b32 v40, 8, v2
    v_mov_b32 v41, s33
    s_and_b32 s34, s28, 0xe8
    s_lshl_b32 s34, s34, 5
    s_bfe_u32 s35, s28, 0x10004
    s_lshl3_add_u32 s34, s35, s34
    s_and_b32 s35, s28, 7
    s_add_u32 s34, s34, s35
    s_lshl2_add_u32 s54, s34, 720896
    v_and_b32 v42, 8, v2
    v_add_lshl_u32 v42, v42, v2, 7
    v_mov_b32 v14, 1172
    s_mov_b32 s62, 0
M_pu:
    ds_read_b32 v15, v14
    s_waitcnt lgkmcnt(0)
    v_cmp_gt_u32 vcc, 7, v15
    s_add_u32 s62, s62, 1
    s_cbranch_vccz M_pu_d
    s_sleep 1
    s_cmp_lt_u32 s62, 1000000
    s_cbranch_scc1 M_pu
M_pu_d:
    v_mov_b32 v14, 1152
    s_mov_b32 s62, 0
M_pv:
    ds_read_b32 v15, v14
    s_waitcnt lgkmcnt(0)
    v_cmp_gt_u32 vcc, 14, v15
    s_add_u32 s62, s62, 1
    s_cbranch_vccz M_pv_d
    s_sleep 1
    s_cmp_lt_u32 s62, 1000000
    s_cbranch_scc1 M_pv
M_pv_d:
    s_mov_b64 exec, 0xffff
    buffer_store_dword v41, v42, s[24:27], s54 offen sc1
    s_mov_b64 exec, -1
    s_mov_b32 s62, 0
M_hint:
    s_load_dwordx16 s[64:79], s[10:11], s46 glc
    s_waitcnt lgkmcnt(0)
    s_add_u32 s64, s64, s65
    s_add_u32 s64, s64, s66
    s_add_u32 s64, s64, s67
    s_add_u32 s64, s64, s68
    s_add_u32 s64, s64, s69
    s_add_u32 s64, s64, s70
    s_add_u32 s64, s64, s71
    s_add_u32 s64, s64, s72
    s_add_u32 s64, s64, s73
    s_add_u32 s64, s64, s74
    s_add_u32 s64, s64, s75
    s_add_u32 s64, s64, s76
    s_add_u32 s64, s64, s77
    s_add_u32 s64, s64, s78
    s_add_u32 s64, s64, s79
    s_cmp_eq_u32 s64, s47
    s_cbranch_scc1 M_hint_d
    s_add_u32 s62, s62, 1
    s_cmp_lt_u32 s62, 200000
    s_cbranch_scc1 M_hint
M_hint_d:
    buffer_load_dwordx4 v[16:19], v9, s[24:27], s44 offen offset:0 sc1
    buffer_load_dwordx4 v[20:23], v9, s[24:27], s44 offen offset:1024 sc1
    buffer_load_dwordx4 v[24:27], v9, s[24:27], s44 offen offset:2048 sc1
    buffer_load_dwordx4 v[28:31], v9, s[24:27], s44 offen offset:3072 sc1
    v_mov_b32 v14, 1152
    s_mov_b32 s62, 0
M_pw:
    ds_read_b32 v15, v14
    s_waitcnt lgkmcnt(0)
    v_cmp_gt_u32 vcc, 20, v15
    s_add_u32 s62, s62, 1
    s_cbranch_vccz M_pw_d
    s_cmp_lt_u32 s62, 1000000
    s_cbranch_scc1 M_pw
M_pw_d:
    s_mov_b64 exec, 0xf
    buffer_store_dword v41, v40, s[24:27], s55 offen sc1
    s_mov_b64 exec, -1
    s_mov_b32 s62, 0
    s_waitcnt vmcnt(1)
    s_branch M_ph_c
    s_mov_b32 s62, 0
M_ph:
    buffer_load_dwordx4 v[16:19], v9, s[24:27], s44 offen offset:0 sc1
    buffer_load_dwordx4 v[20:23], v9, s[24:27], s44 offen offset:1024 sc1
    buffer_load_dwordx4 v[24:27], v9, s[24:27], s44 offen offset:2048 sc1
    buffer_load_dwordx4 v[28:31], v9, s[24:27], s44 offen offset:3072 sc1
    s_waitcnt vmcnt(0)
M_ph_c:
    v_pk_add_f32 v[32:33], v[16:17], v[20:21]
    v_pk_add_f32 v[34:35], v[18:19], v[22:23]
    v_pk_add_f32 v[36:37], v[24:25], v[28:29]
    v_pk_add_f32 v[38:39], v[26:27], v[30:31]
    v_permlane16_swap_b32 v32, v33
    v_permlane16_swap_b32 v34, v35
    v_permlane16_swap_b32 v36, v37
    v_permlane16_swap_b32 v38, v39
    v_add_f32 v32, v32, v33
    v_add_f32 v34, v34, v35
    v_add_f32 v36, v36, v37
    v_add_f32 v38, v38, v39
    v_permlane32_swap_b32 v32, v34
    s_nop 0
    v_permlane32_swap_b32 v36, v38
    v_add_f32 v32, v32, v34
    v_add_f32 v36, v36, v38
    v_cmp_u_f32 vcc, v32, v36
    v_mul_f32 v33, 0xbfb8aa3b, v32
    s_cbranch_vccz M_ph_d
    v_max_u32 v34, v16, v17
    v_max3_u32 v34, v34, v18, v19
    v_max3_u32 v34, v34, v20, v21
    v_max3_u32 v34, v34, v22, v23
    v_max3_u32 v34, v34, v24, v25
    v_max3_u32 v34, v34, v26, v27
    v_max3_u32 v34, v34, v28, v29
    v_max3_u32 v34, v34, v30, v31
    v_cmp_eq_u32 vcc, -1, v34
    s_add_u32 s62, s62, 1
    s_cbranch_vccz M_ph_d
    s_cmp_lt_u32 s62, 200000
    s_cbranch_scc1 M_ph
M_ph_d:
    v_exp_f32 v33, v33
    v_mul_f32 v16, v32, v36
    v_add_f32 v33, 1.0, v33
    v_rcp_f32 v33, v33
    s_nop 0
    v_mul_f32 v16, v16, v33
    v_cvt_pk_bf16_f32 v16, v16, v16
    ds_write_b16 v12, v16 offset:1024
    s_waitcnt lgkmcnt(0)
    s_barrier
L_fin:
L_end:
    s_endpgm
.section .rodata,"a"
.p2align 6
.amdhsa_kernel recurrent_scan__spectral_fnet__moe_arch_mod__prompt_kernel
  .amdhsa_next_free_vgpr 128
  .amdhsa_next_free_sgpr 102
  .amdhsa_accum_offset 128
  .amdhsa_group_segment_fixed_size 0
  .amdhsa_kernarg_size 104
  .amdhsa_user_sgpr_count 2
  .amdhsa_user_sgpr_kernarg_segment_ptr 1
  .amdhsa_system_sgpr_workgroup_id_x 1
.end_amdhsa_kernel
```
